```python
import torch

def _softmax(x, axis=-1):
    return torch.softmax(x, dim=axis)
def _gelu(x):
    return torch.nn.functional.gelu(x, approximate="tanh")
def _silu(x):
    return torch.nn.functional.silu(x)
def _sigmoid(x):
    return torch.sigmoid(x)
def _layernorm(x, axis=-1, eps=1e-5):
    m = x.mean(dim=axis, keepdim=True)
    v = x.var(dim=axis, keepdim=True, unbiased=False)
    return (x - m) / torch.sqrt(v + eps)
def _scatter_add(tgt, idx, src, axis=0):
    return tgt.clone().index_add_(axis, idx, src)
def _segment_sum(src, seg, n):
    out = torch.zeros((n,) + src.shape[1:], dtype=src.dtype)
    return out.index_add_(0, seg, src)
def _pad(x, pw):
    flat = tuple(v for pair in reversed(pw) for v in pair)
    return torch.nn.functional.pad(x, flat)

kernel_name = 'gated_mix__grouped_kv_mqa__mixer_token_mlp__prompt'

def setup_inputs():

    _w = (lambda a: (lambda t: t.to(torch.bfloat16) if t.is_floating_point() else t)(torch.as_tensor(a)))
    def _A_setup():
        B, S, D, H = 1, 2048, 1024, 32
        Dh = D // H
        return {
            "x": _w((lambda *s: torch.randn(*s, dtype=torch.bfloat16) * 0.05)(B, S, D)),
            "wq": _w((lambda *s: torch.randn(*s, dtype=torch.bfloat16) * 0.8)(D, H * Dh)),
            "wk": _w((lambda *s: torch.randn(*s, dtype=torch.bfloat16) * 0.8)(D, Dh)),
            "wv": _w((lambda *s: torch.randn(*s, dtype=torch.bfloat16) * 0.05)(D, Dh)),
            "wo": _w((lambda *s: torch.randn(*s, dtype=torch.bfloat16) * 0.05)(H * Dh, D)),
        }
    _A_in = _A_setup()

    def _B_setup():
        B, S, D, F = 1, 2048, 1024, 3584
        return {
            "x": _w((lambda *s: torch.randn(*s, dtype=torch.bfloat16) * 0.05)(B, S, D)),
            "w1": _w((lambda *s: torch.randn(*s, dtype=torch.bfloat16) * 0.4)(S, F) * (S ** -0.5)),
            "b1": _w((lambda *s: torch.randn(*s, dtype=torch.bfloat16) * 3.2)(F) * 0.02),
            "w2": _w((lambda *s: torch.randn(*s, dtype=torch.bfloat16) * 0.1)(F, S) * (F ** -0.5)),
            "b2": _w((lambda *s: torch.randn(*s, dtype=torch.bfloat16) * 0.4)(S) * 0.02),
        }
    _B_in = _B_setup()

    return {
        "A_x": _A_in["x"],
        "A_wq": _A_in["wq"],
        "A_wk": _A_in["wk"],
        "A_wv": _A_in["wv"],
        "A_wo": _A_in["wo"],
        "B_x": _B_in["x"],
        "B_w1": _B_in["w1"],
        "B_b1": _B_in["b1"],
        "B_w2": _B_in["w2"],
        "B_b2": _B_in["b2"],
        "gate_w": _w((lambda *s: torch.randn(*s, dtype=torch.bfloat16) * 0.05)(1024) * 16.0),
    }

def reference(A_x, A_wq, A_wk, A_wv, A_wo, B_x, B_w1, B_b1, B_w2, B_b2, gate_w):
    def _A_ref(x, wq, wk, wv, wo):
        B, S, D = x.shape
        H = 32
        Dh = D // H
        q = (lambda x, *d: x.permute(*d))((x @ wq).reshape(B, S, H, Dh), 0, 2, 1, 3)
        k = x @ wk
        v = x @ wv
        scores = torch.einsum("bhqd,bkd->bhqk", q, k) * (Dh ** -0.5)
        p = _softmax(scores, axis=-1)
        o = torch.einsum("bhqk,bkd->bhqd", p, v)
        return (lambda x, *d: x.permute(*d))(o, 0, 2, 1, 3).reshape(B, S, H * Dh) @ wo

    def _B_ref(x, w1, b1, w2, b2):
        B, S, D = x.shape
        h = _layernorm(x, axis=-1)
        u = torch.einsum("bsd,sf->bdf", h, w1) + b1
        u = _gelu(u)
        y = torch.einsum("bdf,fs->bds", u, w2) + b2
        return (lambda x, *d: x.permute(*d))(y, 0, 2, 1)

    x = A_x
    g = _sigmoid((x * gate_w).sum(-1, keepdims=True))
    a = _A_ref(x, A_wq, A_wk, A_wv, A_wo)
    b = _B_ref(x, B_w1, B_b1, B_w2, B_b2)
    return g * a + (1 - g) * b
```

```asm
; @launch grid=(256,1,1) block=(512,1,1) lds=163840
.amdgcn_target "amdgcn-amd-amdhsa--gfx950"
.text
.globl gated_mix__grouped_kv_mqa__mixer_token_mlp__prompt_kernel
.p2align 8
.type gated_mix__grouped_kv_mqa__mixer_token_mlp__prompt_kernel,@function
gated_mix__grouped_kv_mqa__mixer_token_mlp__prompt_kernel:
    s_cmp_ge_u32 s2, 256
    s_cbranch_scc1 MK_END
    s_load_dwordx16 s[64:79], s[0:1], 0
    s_load_dwordx8 s[80:87], s[0:1], 64
    s_load_dwordx4 s[88:91], s[0:1], 96
    v_lshrrev_b32 v2, 6, v0
    v_and_b32 v1, 63, v0
    v_readfirstlane_b32 s20, v2
    v_and_b32 v2, 15, v1
    v_lshrrev_b32 v3, 4, v1
    s_and_b32 s93, s2, 7
    s_lshr_b32 s98, s2, 3
    s_getpc_b64 s[4:5]
MK_PC:
    s_lshl_b32 s27, s98, 4
    v_add_u32 v4, s27, v2
    v_lshlrev_b32 v4, 7, v4
    v_min_u32 v4, MK_END-MK_PC, v4
    s_cmp_eq_u32 s20, 7
    s_cbranch_scc0 MK_NPC
    s_mov_b64 exec, 0xffff
    global_load_dword v254, v4, s[4:5]
    s_mov_b64 exec, -1
MK_NPC:
    s_mov_b32 s27, 17825792
    s_waitcnt lgkmcnt(0)
    s_load_dword s92, s[90:91], s27
    s_mov_b32 s12, s90
    s_and_b32 s13, s91, 0xffff
    s_mov_b32 s14, 0x3000000
    s_mov_b32 s15, 0x20000
    s_cmp_ge_u32 s98, 16
    s_cbranch_scc1 A_ROLE
    s_and_b32 s21, s93, 1
    s_lshl_b32 s21, s21, 2
    s_and_b32 s29, s98, 3
    s_add_u32 s21, s21, s29
    s_lshr_b32 s22, s93, 1
    s_lshl_b32 s22, s22, 2
    s_lshr_b32 s29, s98, 2
    s_add_u32 s22, s22, s29
    s_mov_b32 s8, s64
    s_and_b32 s9, s65, 0xffff
    s_mov_b32 s10, 0x400000
    s_mov_b32 s11, 0x20000
    s_and_b32 s26, s98, 1
    s_lshl_b32 s27, s93, 8
    s_lshl_b32 s28, s98, 4
    s_add_u32 s35, s27, s28
    s_and_b32 s34, s35, 0xffffffe0
    s_lshl_b32 s33, s93, 4
    s_add_u32 s33, s33, s98
    s_lshl_b32 s33, s33, 7
    v_lshlrev_b32_e64 v4, 4, v1
    s_cmp_ge_u32 s20, 4
    s_cbranch_scc1 GP_KV
    s_lshl_b32 s28, s20, 2
    s_add_u32 s36, s35, s28
    s_lshl_b32 s37, s36, 11
    s_add_u32 s38, s37, 4096
    buffer_load_dwordx4 v[8:11], v4, s[8:11], s37 offen offset:0 nt
    buffer_load_dwordx4 v[12:15], v4, s[8:11], s37 offen offset:1024 nt
    buffer_load_dwordx4 v[16:19], v4, s[8:11], s37 offen offset:2048 nt
    buffer_load_dwordx4 v[20:23], v4, s[8:11], s37 offen offset:3072 nt
    buffer_load_dwordx4 v[24:27], v4, s[8:11], s38 offen offset:0 nt
    buffer_load_dwordx4 v[28:31], v4, s[8:11], s38 offen offset:1024 nt
    buffer_load_dwordx4 v[32:35], v4, s[8:11], s38 offen offset:2048 nt
    buffer_load_dwordx4 v[36:39], v4, s[8:11], s38 offen offset:3072 nt
    s_mov_b32 s16, s84
    s_and_b32 s17, s85, 0xffff
    s_mov_b32 s18, 0x800
    s_mov_b32 s19, 0x20000
    s_mov_b32 s44, s78
    s_and_b32 s45, s79, 0xffff
    s_mov_b32 s46, 0x1c00
    s_mov_b32 s47, 0x20000
    s_lshr_b32 s27, s20, 1
    s_mul_i32 s29, s22, 14
    s_lshl_b32 s30, s27, 3
    s_add_u32 s30, s30, s29
    s_add_u32 s31, s29, 6
    s_add_u32 s31, s31, s27
    s_lshl_b32 s57, s30, 5
    s_lshl_b32 s58, s31, 5
    v_lshlrev_b32 v153, 3, v3
    s_lshl_b32 s28, s27, 5
    v_xor_b32 v144, s28, v4
    s_lshl_b32 s29, s20, 13
    s_add_u32 s29, s29, 131072
    v_add_u32 v144, s29, v144
    v_xor_b32 v145, 64, v144
    v_xor_b32 v146, 128, v144
    v_xor_b32 v147, 192, v144
    v_lshrrev_b32 v5, 2, v2
    v_and_b32 v6, 1, v3
    v_lshrrev_b32_e64 v7, 1, v3
    v_lshl_add_u32 v148, v6, 3, v5
    v_lshlrev_b32_e64 v148, 11, v148
    v_lshl_add_u32 v148, v5, 6, v148
    v_xor_b32_e64 v149, v6, v7
    v_lshl_add_u32 v148, v149, 5, v148
    v_and_b32_e64 v149, 3, v1
    v_lshl_add_u32 v148, v149, 3, v148
    s_lshl_b32 s28, s20, 9
    s_add_u32 s28, s28, 131072
    v_add_u32 v148, s28, v148
    v_xor_b32_e64 v149, 64, v148
    v_xor_b32 v150, 128, v148
    v_xor_b32 v151, 192, v148
    v_lshlrev_b32_e64 v152, 10, v7
    v_lshl_add_u32 v152, v6, 8, v152
    v_lshl_add_u32 v152, v2, 4, v152
    s_lshl_b32 s40, s20, 20
    s_lshr_b32 s29, s35, 5
    s_lshl_b32 s29, s29, 13
    s_add_u32 s40, s40, s29
    s_and_b32 s29, s35, 31
    s_lshl_b32 s29, s29, 5
    s_add_u32 s40, s40, s29
    s_add_u32 s40, s40, 0
    s_add_u32 s41, s40, 4096
    s_add_u32 s42, s40, 524288
    s_add_u32 s43, s42, 4096
    s_lshl_b32 s39, s36, 2
    s_add_u32 s39, s39, 17039360
    v_lshlrev_b32 v154, 2, v1
    s_waitcnt vmcnt(6)
    v_lshlrev_b32 v40, 16, v8
    v_and_b32 v41, 0xffff0000, v8
    v_lshlrev_b32_e64 v42, 16, v9
    v_and_b32 v43, 0xffff0000, v9
    v_lshlrev_b32_e64 v44, 16, v10
    v_and_b32 v45, 0xffff0000, v10
    v_lshlrev_b32_e64 v46, 16, v11
    v_and_b32 v47, 0xffff0000, v11
    v_lshlrev_b32_e64 v48, 16, v12
    v_and_b32 v49, 0xffff0000, v12
    v_lshlrev_b32_e64 v50, 16, v13
    v_and_b32 v51, 0xffff0000, v13
    v_lshlrev_b32_e64 v52, 16, v14
    v_and_b32 v53, 0xffff0000, v14
    v_lshlrev_b32_e64 v54, 16, v15
    v_and_b32 v55, 0xffff0000, v15
    s_waitcnt vmcnt(4)
    v_lshlrev_b32 v56, 16, v16
    v_and_b32 v57, 0xffff0000, v16
    v_lshlrev_b32_e64 v58, 16, v17
    v_and_b32 v59, 0xffff0000, v17
    v_lshlrev_b32_e64 v60, 16, v18
    v_and_b32 v61, 0xffff0000, v18
    v_lshlrev_b32_e64 v62, 16, v19
    v_and_b32 v63, 0xffff0000, v19
    v_lshlrev_b32_e64 v64, 16, v20
    v_and_b32 v65, 0xffff0000, v20
    v_lshlrev_b32_e64 v66, 16, v21
    v_and_b32 v67, 0xffff0000, v21
    v_lshlrev_b32_e64 v68, 16, v22
    v_and_b32 v69, 0xffff0000, v22
    v_lshlrev_b32_e64 v70, 16, v23
    v_and_b32 v71, 0xffff0000, v23
    s_waitcnt vmcnt(2)
    v_lshlrev_b32 v72, 16, v24
    v_and_b32 v73, 0xffff0000, v24
    v_lshlrev_b32_e64 v74, 16, v25
    v_and_b32 v75, 0xffff0000, v25
    v_lshlrev_b32_e64 v76, 16, v26
    v_and_b32 v77, 0xffff0000, v26
    v_lshlrev_b32_e64 v78, 16, v27
    v_and_b32 v79, 0xffff0000, v27
    v_lshlrev_b32_e64 v80, 16, v28
    v_and_b32 v81, 0xffff0000, v28
    v_lshlrev_b32_e64 v82, 16, v29
    v_and_b32 v83, 0xffff0000, v29
    v_lshlrev_b32_e64 v84, 16, v30
    v_and_b32 v85, 0xffff0000, v30
    v_lshlrev_b32_e64 v86, 16, v31
    v_and_b32 v87, 0xffff0000, v31
    s_waitcnt vmcnt(0)
    v_lshlrev_b32 v88, 16, v32
    v_and_b32 v89, 0xffff0000, v32
    v_lshlrev_b32_e64 v90, 16, v33
    v_and_b32 v91, 0xffff0000, v33
    v_lshlrev_b32_e64 v92, 16, v34
    v_and_b32 v93, 0xffff0000, v34
    v_lshlrev_b32_e64 v94, 16, v35
    v_and_b32 v95, 0xffff0000, v35
    v_lshlrev_b32_e64 v96, 16, v36
    v_and_b32 v97, 0xffff0000, v36
    v_lshlrev_b32_e64 v98, 16, v37
    v_and_b32 v99, 0xffff0000, v37
    v_lshlrev_b32_e64 v100, 16, v38
    v_and_b32 v101, 0xffff0000, v38
    v_lshlrev_b32_e64 v102, 16, v39
    v_and_b32 v103, 0xffff0000, v39
    v_pk_add_f32 v[104:105], v[40:41], v[42:43]
    v_pk_add_f32 v[106:107], v[56:57], v[58:59]
    v_pk_add_f32 v[108:109], v[72:73], v[74:75]
    v_pk_add_f32 v[110:111], v[88:89], v[90:91]
    v_pk_add_f32 v[104:105], v[104:105], v[44:45]
    v_pk_add_f32 v[106:107], v[106:107], v[60:61]
    v_pk_add_f32 v[108:109], v[108:109], v[76:77]
    v_pk_add_f32 v[110:111], v[110:111], v[92:93]
    v_pk_add_f32 v[104:105], v[104:105], v[46:47]
    v_pk_add_f32 v[106:107], v[106:107], v[62:63]
    v_pk_add_f32 v[108:109], v[108:109], v[78:79]
    v_pk_add_f32 v[110:111], v[110:111], v[94:95]
    v_pk_add_f32 v[104:105], v[104:105], v[48:49]
    v_pk_add_f32 v[106:107], v[106:107], v[64:65]
    v_pk_add_f32 v[108:109], v[108:109], v[80:81]
    v_pk_add_f32 v[110:111], v[110:111], v[96:97]
    v_pk_add_f32 v[104:105], v[104:105], v[50:51]
    v_pk_add_f32 v[106:107], v[106:107], v[66:67]
    v_pk_add_f32 v[108:109], v[108:109], v[82:83]
    v_pk_add_f32 v[110:111], v[110:111], v[98:99]
    v_pk_add_f32 v[104:105], v[104:105], v[52:53]
    v_pk_add_f32 v[106:107], v[106:107], v[68:69]
    v_pk_add_f32 v[108:109], v[108:109], v[84:85]
    v_pk_add_f32 v[110:111], v[110:111], v[100:101]
    v_pk_add_f32 v[104:105], v[104:105], v[54:55]
    v_pk_add_f32 v[106:107], v[106:107], v[70:71]
    v_pk_add_f32 v[108:109], v[108:109], v[86:87]
    v_pk_add_f32 v[110:111], v[110:111], v[102:103]
    v_add_f32 v104, v104, v105
    v_add_f32 v106, v106, v107
    v_add_f32 v108, v108, v109
    v_add_f32_e64 v110, v110, v111
    s_nop 1
    v_add_f32_dpp v104, v104, v104 row_shr:1 row_mask:0xf bank_mask:0xf
    v_add_f32_dpp v106, v106, v106 row_shr:1 row_mask:0xf bank_mask:0xf
    v_add_f32_dpp v108, v108, v108 row_shr:1 row_mask:0xf bank_mask:0xf
    v_add_f32_dpp v110, v110, v110 row_shr:1 row_mask:0xf bank_mask:0xf
    v_add_f32_dpp v104, v104, v104 row_shr:2 row_mask:0xf bank_mask:0xf
    v_add_f32_dpp v106, v106, v106 row_shr:2 row_mask:0xf bank_mask:0xf
    v_add_f32_dpp v108, v108, v108 row_shr:2 row_mask:0xf bank_mask:0xf
    v_add_f32_dpp v110, v110, v110 row_shr:2 row_mask:0xf bank_mask:0xf
    v_add_f32_dpp v104, v104, v104 row_shr:4 row_mask:0xf bank_mask:0xf
    v_add_f32_dpp v106, v106, v106 row_shr:4 row_mask:0xf bank_mask:0xf
    v_add_f32_dpp v108, v108, v108 row_shr:4 row_mask:0xf bank_mask:0xf
    v_add_f32_dpp v110, v110, v110 row_shr:4 row_mask:0xf bank_mask:0xf
    v_add_f32_dpp v104, v104, v104 row_shr:8 row_mask:0xf bank_mask:0xf
    v_add_f32_dpp v106, v106, v106 row_shr:8 row_mask:0xf bank_mask:0xf
    v_add_f32_dpp v108, v108, v108 row_shr:8 row_mask:0xf bank_mask:0xf
    v_add_f32_dpp v110, v110, v110 row_shr:8 row_mask:0xf bank_mask:0xf
    v_add_f32_dpp v104, v104, v104 row_bcast:15 row_mask:0xa bank_mask:0xf
    v_add_f32_dpp v106, v106, v106 row_bcast:15 row_mask:0xa bank_mask:0xf
    v_add_f32_dpp v108, v108, v108 row_bcast:15 row_mask:0xa bank_mask:0xf
    v_add_f32_dpp v110, v110, v110 row_bcast:15 row_mask:0xa bank_mask:0xf
    v_add_f32_dpp v104, v104, v104 row_bcast:31 row_mask:0xc bank_mask:0xf
    v_add_f32_dpp v106, v106, v106 row_bcast:31 row_mask:0xc bank_mask:0xf
    v_add_f32_dpp v108, v108, v108 row_bcast:31 row_mask:0xc bank_mask:0xf
    v_add_f32_dpp v110, v110, v110 row_bcast:31 row_mask:0xc bank_mask:0xf
    s_nop 0
    s_nop 0
    v_readlane_b32 s28, v104, 63
    v_readlane_b32 s29, v106, 63
    v_readlane_b32 s30, v108, 63
    v_readlane_b32 s31, v110, 63
    v_mov_b32 v5, 0xba800000
    s_nop 0
    v_mul_f32 v104, s28, v5
    v_mul_f32 v106, s29, v5
    v_mul_f32 v108, s30, v5
    v_mul_f32 v110, s31, v5
    v_mov_b32 v105, v104
    v_mov_b32 v107, v106
    v_mov_b32 v109, v108
    v_mov_b32_e64 v111, v110
    v_pk_add_f32 v[40:41], v[40:41], v[104:105]
    v_pk_add_f32 v[56:57], v[56:57], v[106:107]
    v_pk_add_f32 v[72:73], v[72:73], v[108:109]
    v_pk_add_f32 v[88:89], v[88:89], v[110:111]
    v_pk_add_f32 v[42:43], v[42:43], v[104:105]
    v_pk_add_f32 v[58:59], v[58:59], v[106:107]
    v_pk_add_f32 v[74:75], v[74:75], v[108:109]
    v_pk_add_f32 v[90:91], v[90:91], v[110:111]
    v_pk_add_f32 v[44:45], v[44:45], v[104:105]
    v_pk_add_f32 v[60:61], v[60:61], v[106:107]
    v_pk_add_f32 v[76:77], v[76:77], v[108:109]
    v_pk_add_f32 v[92:93], v[92:93], v[110:111]
    v_pk_add_f32 v[46:47], v[46:47], v[104:105]
    v_pk_add_f32 v[62:63], v[62:63], v[106:107]
    v_pk_add_f32 v[78:79], v[78:79], v[108:109]
    v_pk_add_f32 v[94:95], v[94:95], v[110:111]
    v_pk_add_f32 v[48:49], v[48:49], v[104:105]
    v_pk_add_f32 v[64:65], v[64:65], v[106:107]
    v_pk_add_f32 v[80:81], v[80:81], v[108:109]
    v_pk_add_f32 v[96:97], v[96:97], v[110:111]
    v_pk_add_f32 v[50:51], v[50:51], v[104:105]
    v_pk_add_f32 v[66:67], v[66:67], v[106:107]
    v_pk_add_f32 v[82:83], v[82:83], v[108:109]
    v_pk_add_f32 v[98:99], v[98:99], v[110:111]
    v_pk_add_f32 v[52:53], v[52:53], v[104:105]
    v_pk_add_f32 v[68:69], v[68:69], v[106:107]
    v_pk_add_f32 v[84:85], v[84:85], v[108:109]
    v_pk_add_f32 v[100:101], v[100:101], v[110:111]
    v_pk_add_f32 v[54:55], v[54:55], v[104:105]
    v_pk_add_f32 v[70:71], v[70:71], v[106:107]
    v_pk_add_f32 v[86:87], v[86:87], v[108:109]
    v_pk_add_f32 v[102:103], v[102:103], v[110:111]
    v_pk_mul_f32 v[104:105], v[40:41], v[40:41]
    v_pk_mul_f32 v[106:107], v[56:57], v[56:57]
    v_pk_mul_f32 v[108:109], v[72:73], v[72:73]
    v_pk_mul_f32 v[110:111], v[88:89], v[88:89]
    v_pk_fma_f32 v[104:105], v[42:43], v[42:43], v[104:105]
    v_pk_fma_f32 v[106:107], v[58:59], v[58:59], v[106:107]
    v_pk_fma_f32 v[108:109], v[74:75], v[74:75], v[108:109]
    v_pk_fma_f32 v[110:111], v[90:91], v[90:91], v[110:111]
    v_pk_fma_f32 v[104:105], v[44:45], v[44:45], v[104:105]
    v_pk_fma_f32 v[106:107], v[60:61], v[60:61], v[106:107]
    v_pk_fma_f32 v[108:109], v[76:77], v[76:77], v[108:109]
    v_pk_fma_f32 v[110:111], v[92:93], v[92:93], v[110:111]
    v_pk_fma_f32 v[104:105], v[46:47], v[46:47], v[104:105]
    v_pk_fma_f32 v[106:107], v[62:63], v[62:63], v[106:107]
    v_pk_fma_f32 v[108:109], v[78:79], v[78:79], v[108:109]
    v_pk_fma_f32 v[110:111], v[94:95], v[94:95], v[110:111]
    v_pk_fma_f32 v[104:105], v[48:49], v[48:49], v[104:105]
    v_pk_fma_f32 v[106:107], v[64:65], v[64:65], v[106:107]
    v_pk_fma_f32 v[108:109], v[80:81], v[80:81], v[108:109]
    v_pk_fma_f32 v[110:111], v[96:97], v[96:97], v[110:111]
    v_pk_fma_f32 v[104:105], v[50:51], v[50:51], v[104:105]
    v_pk_fma_f32 v[106:107], v[66:67], v[66:67], v[106:107]
    v_pk_fma_f32 v[108:109], v[82:83], v[82:83], v[108:109]
    v_pk_fma_f32 v[110:111], v[98:99], v[98:99], v[110:111]
    v_pk_fma_f32 v[104:105], v[52:53], v[52:53], v[104:105]
    v_pk_fma_f32 v[106:107], v[68:69], v[68:69], v[106:107]
    v_pk_fma_f32 v[108:109], v[84:85], v[84:85], v[108:109]
    v_pk_fma_f32 v[110:111], v[100:101], v[100:101], v[110:111]
    v_pk_fma_f32 v[104:105], v[54:55], v[54:55], v[104:105]
    v_pk_fma_f32 v[106:107], v[70:71], v[70:71], v[106:107]
    v_pk_fma_f32 v[108:109], v[86:87], v[86:87], v[108:109]
    v_pk_fma_f32 v[110:111], v[102:103], v[102:103], v[110:111]
    v_add_f32 v104, v104, v105
    v_add_f32 v106, v106, v107
    v_add_f32 v108, v108, v109
    v_add_f32_e64 v110, v110, v111
    s_nop 1
    v_add_f32_dpp v104, v104, v104 row_shr:1 row_mask:0xf bank_mask:0xf
    v_add_f32_dpp v106, v106, v106 row_shr:1 row_mask:0xf bank_mask:0xf
    v_add_f32_dpp v108, v108, v108 row_shr:1 row_mask:0xf bank_mask:0xf
    v_add_f32_dpp v110, v110, v110 row_shr:1 row_mask:0xf bank_mask:0xf
    v_add_f32_dpp v104, v104, v104 row_shr:2 row_mask:0xf bank_mask:0xf
    v_add_f32_dpp v106, v106, v106 row_shr:2 row_mask:0xf bank_mask:0xf
    v_add_f32_dpp v108, v108, v108 row_shr:2 row_mask:0xf bank_mask:0xf
    v_add_f32_dpp v110, v110, v110 row_shr:2 row_mask:0xf bank_mask:0xf
    v_add_f32_dpp v104, v104, v104 row_shr:4 row_mask:0xf bank_mask:0xf
    v_add_f32_dpp v106, v106, v106 row_shr:4 row_mask:0xf bank_mask:0xf
    v_add_f32_dpp v108, v108, v108 row_shr:4 row_mask:0xf bank_mask:0xf
    v_add_f32_dpp v110, v110, v110 row_shr:4 row_mask:0xf bank_mask:0xf
    v_add_f32_dpp v104, v104, v104 row_shr:8 row_mask:0xf bank_mask:0xf
    v_add_f32_dpp v106, v106, v106 row_shr:8 row_mask:0xf bank_mask:0xf
    v_add_f32_dpp v108, v108, v108 row_shr:8 row_mask:0xf bank_mask:0xf
    v_add_f32_dpp v110, v110, v110 row_shr:8 row_mask:0xf bank_mask:0xf
    v_add_f32_dpp v104, v104, v104 row_bcast:15 row_mask:0xa bank_mask:0xf
    v_add_f32_dpp v106, v106, v106 row_bcast:15 row_mask:0xa bank_mask:0xf
    v_add_f32_dpp v108, v108, v108 row_bcast:15 row_mask:0xa bank_mask:0xf
    v_add_f32_dpp v110, v110, v110 row_bcast:15 row_mask:0xa bank_mask:0xf
    v_add_f32_dpp v104, v104, v104 row_bcast:31 row_mask:0xc bank_mask:0xf
    v_add_f32_dpp v106, v106, v106 row_bcast:31 row_mask:0xc bank_mask:0xf
    v_add_f32_dpp v108, v108, v108 row_bcast:31 row_mask:0xc bank_mask:0xf
    v_add_f32_dpp v110, v110, v110 row_bcast:31 row_mask:0xc bank_mask:0xf
    s_nop 0
    s_nop 0
    v_readlane_b32 s28, v104, 63
    v_readlane_b32 s29, v106, 63
    v_readlane_b32 s30, v108, 63
    v_readlane_b32 s31, v110, 63
    v_mov_b32 v5, 0x3a800000
    v_mov_b32 v6, 0x3727c5ac
    v_fma_f32 v104, s28, v5, v6
    v_fma_f32 v106, s29, v5, v6
    v_fma_f32 v108, s30, v5, v6
    v_fma_f32 v110, s31, v5, v6
    v_rsq_f32 v104, v104
    v_rsq_f32 v106, v106
    v_rsq_f32 v108, v108
    v_rsq_f32 v110, v110
    v_mov_b32 v105, v104
    v_mov_b32 v107, v106
    v_mov_b32 v109, v108
    v_mov_b32 v111, v110
    v_pk_mul_f32 v[40:41], v[40:41], v[104:105]
    v_pk_mul_f32 v[42:43], v[42:43], v[104:105]
    v_pk_mul_f32 v[44:45], v[44:45], v[104:105]
    v_pk_mul_f32 v[46:47], v[46:47], v[104:105]
    v_pk_mul_f32 v[48:49], v[48:49], v[104:105]
    v_pk_mul_f32 v[50:51], v[50:51], v[104:105]
    v_pk_mul_f32 v[52:53], v[52:53], v[104:105]
    v_pk_mul_f32 v[54:55], v[54:55], v[104:105]
    v_cvt_pk_bf16_f32 v112, v40, v41
    v_cvt_pk_bf16_f32 v113, v42, v43
    v_cvt_pk_bf16_f32 v114, v44, v45
    v_cvt_pk_bf16_f32 v115, v46, v47
    v_cvt_pk_bf16_f32 v116, v48, v49
    v_cvt_pk_bf16_f32 v117, v50, v51
    v_cvt_pk_bf16_f32 v118, v52, v53
    v_cvt_pk_bf16_f32 v119, v54, v55
    ds_write_b128 v144, v[112:115] offset:0
    ds_write_b128 v144, v[116:119] offset:1024
    v_pk_mul_f32 v[56:57], v[56:57], v[106:107]
    v_pk_mul_f32 v[58:59], v[58:59], v[106:107]
    v_pk_mul_f32 v[60:61], v[60:61], v[106:107]
    v_pk_mul_f32 v[62:63], v[62:63], v[106:107]
    v_pk_mul_f32 v[64:65], v[64:65], v[106:107]
    v_pk_mul_f32 v[66:67], v[66:67], v[106:107]
    v_pk_mul_f32 v[68:69], v[68:69], v[106:107]
    v_pk_mul_f32 v[70:71], v[70:71], v[106:107]
    v_cvt_pk_bf16_f32 v120, v56, v57
    v_cvt_pk_bf16_f32 v121, v58, v59
    v_cvt_pk_bf16_f32 v122, v60, v61
    v_cvt_pk_bf16_f32 v123, v62, v63
    v_cvt_pk_bf16_f32 v124, v64, v65
    v_cvt_pk_bf16_f32 v125, v66, v67
    v_cvt_pk_bf16_f32 v126, v68, v69
    v_cvt_pk_bf16_f32 v127, v70, v71
    ds_write_b128 v145, v[120:123] offset:2048
    ds_write_b128 v145, v[124:127] offset:3072
    v_pk_mul_f32 v[72:73], v[72:73], v[108:109]
    v_pk_mul_f32 v[74:75], v[74:75], v[108:109]
    v_pk_mul_f32 v[76:77], v[76:77], v[108:109]
    v_pk_mul_f32 v[78:79], v[78:79], v[108:109]
    v_pk_mul_f32 v[80:81], v[80:81], v[108:109]
    v_pk_mul_f32 v[82:83], v[82:83], v[108:109]
    v_pk_mul_f32 v[84:85], v[84:85], v[108:109]
    v_pk_mul_f32 v[86:87], v[86:87], v[108:109]
    v_cvt_pk_bf16_f32 v128, v72, v73
    v_cvt_pk_bf16_f32 v129, v74, v75
    v_cvt_pk_bf16_f32 v130, v76, v77
    v_cvt_pk_bf16_f32 v131, v78, v79
    v_cvt_pk_bf16_f32 v132, v80, v81
    v_cvt_pk_bf16_f32 v133, v82, v83
    v_cvt_pk_bf16_f32 v134, v84, v85
    v_cvt_pk_bf16_f32 v135, v86, v87
    ds_write_b128 v146, v[128:131] offset:4096
    ds_write_b128 v146, v[132:135] offset:5120
    v_pk_mul_f32 v[88:89], v[88:89], v[110:111]
    v_pk_mul_f32 v[90:91], v[90:91], v[110:111]
    v_pk_mul_f32 v[92:93], v[92:93], v[110:111]
    v_pk_mul_f32 v[94:95], v[94:95], v[110:111]
    v_pk_mul_f32 v[96:97], v[96:97], v[110:111]
    v_pk_mul_f32 v[98:99], v[98:99], v[110:111]
    v_pk_mul_f32 v[100:101], v[100:101], v[110:111]
    v_pk_mul_f32 v[102:103], v[102:103], v[110:111]
    v_cvt_pk_bf16_f32 v136, v88, v89
    v_cvt_pk_bf16_f32 v137, v90, v91
    v_cvt_pk_bf16_f32 v138, v92, v93
    v_cvt_pk_bf16_f32 v139, v94, v95
    v_cvt_pk_bf16_f32 v140, v96, v97
    v_cvt_pk_bf16_f32 v141, v98, v99
    v_cvt_pk_bf16_f32 v142, v100, v101
    v_cvt_pk_bf16_f32 v143, v102, v103
    ds_write_b128 v147, v[136:139] offset:6144
    ds_write_b128 v147, v[140:143] offset:7168
    s_waitcnt lgkmcnt(0)
    s_mul_i32 s92, s92, 1664525
    s_add_u32 s92, s92, 1013904223
    s_barrier
    ds_read_b64_tr_b16 v[112:113], v148 offset:0
    ds_read_b64_tr_b16 v[114:115], v148 offset:8192
    ds_read_b64_tr_b16 v[116:117], v149 offset:0
    ds_read_b64_tr_b16 v[118:119], v149 offset:8192
    ds_read_b64_tr_b16 v[120:121], v150 offset:0
    ds_read_b64_tr_b16 v[122:123], v150 offset:8192
    ds_read_b64_tr_b16 v[124:125], v151 offset:0
    ds_read_b64_tr_b16 v[126:127], v151 offset:8192
    ds_read_b64_tr_b16 v[128:129], v148 offset:256
    ds_read_b64_tr_b16 v[130:131], v148 offset:8448
    ds_read_b64_tr_b16 v[132:133], v149 offset:256
    ds_read_b64_tr_b16 v[134:135], v149 offset:8448
    ds_read_b64_tr_b16 v[136:137], v150 offset:256
    ds_read_b64_tr_b16 v[138:139], v150 offset:8448
    ds_read_b64_tr_b16 v[140:141], v151 offset:256
    ds_read_b64_tr_b16 v[142:143], v151 offset:8448
    buffer_load_dwordx4 v[156:159], v4, s[16:19], 0 offen
    buffer_load_dwordx4 v[160:163], v4, s[16:19], 0 offen offset:1024
    s_waitcnt lgkmcnt(14)
    buffer_store_dwordx4 v[112:115], v152, s[12:15], s40 offen offset:0 sc1
    s_waitcnt lgkmcnt(12)
    buffer_store_dwordx4 v[116:119], v152, s[12:15], s40 offen offset:2048 sc1
    s_waitcnt lgkmcnt(10)
    buffer_store_dwordx4 v[120:123], v152, s[12:15], s41 offen offset:0 sc1
    s_waitcnt lgkmcnt(8)
    buffer_store_dwordx4 v[124:127], v152, s[12:15], s41 offen offset:2048 sc1
    s_waitcnt lgkmcnt(6)
    buffer_store_dwordx4 v[128:131], v152, s[12:15], s42 offen offset:0 sc1
    s_waitcnt lgkmcnt(4)
    buffer_store_dwordx4 v[132:135], v152, s[12:15], s42 offen offset:2048 sc1
    s_waitcnt lgkmcnt(2)
    buffer_store_dwordx4 v[136:139], v152, s[12:15], s43 offen offset:0 sc1
    s_waitcnt lgkmcnt(0)
    buffer_store_dwordx4 v[140:143], v152, s[12:15], s43 offen offset:2048 sc1
    buffer_load_dwordx2 v[240:241], v153, s[44:47], s57 offen offset:0
    buffer_load_dwordx2 v[242:243], v153, s[44:47], s57 offen offset:32
    buffer_load_dwordx2 v[244:245], v153, s[44:47], s57 offen offset:64
    buffer_load_dwordx2 v[246:247], v153, s[44:47], s57 offen offset:96
    buffer_load_dwordx2 v[248:249], v153, s[44:47], s57 offen offset:128
    buffer_load_dwordx2 v[250:251], v153, s[44:47], s57 offen offset:160
    buffer_load_dwordx2 v[252:253], v153, s[44:47], s58 offen
    s_waitcnt vmcnt(0)
    s_barrier
    s_cmp_eq_u32 s20, 0
    s_cbranch_scc0 GP_NR
    v_add_u32 v5, 65536, v4
    ds_read_b128 v[40:43], v5 offset:0
    ds_read_b128 v[44:47], v5 offset:1024
    ds_read_b128 v[48:51], v5 offset:2048
    ds_read_b128 v[52:55], v5 offset:3072
    ds_read_b128 v[56:59], v5 offset:16384
    ds_read_b128 v[60:63], v5 offset:17408
    ds_read_b128 v[64:67], v5 offset:18432
    ds_read_b128 v[68:71], v5 offset:19456
    ds_read_b128 v[72:75], v5 offset:32768
    ds_read_b128 v[76:79], v5 offset:33792
    ds_read_b128 v[80:83], v5 offset:34816
    ds_read_b128 v[84:87], v5 offset:35840
    ds_read_b128 v[88:91], v5 offset:49152
    ds_read_b128 v[92:95], v5 offset:50176
    ds_read_b128 v[96:99], v5 offset:51200
    ds_read_b128 v[100:103], v5 offset:52224
    s_lshr_b32 s28, s34, 5
    s_lshl_b32 s29, s28, 12
    s_lshl_b32 s30, s26, 11
    s_add_u32 s29, s29, s30
    s_add_u32 s29, s29, 16777216
    s_nop 0
    s_waitcnt lgkmcnt(0)
    v_pk_add_f32 v[40:41], v[40:41], v[56:57]
    v_pk_add_f32 v[42:43], v[42:43], v[58:59]
    v_pk_add_f32 v[44:45], v[44:45], v[60:61]
    v_pk_add_f32 v[46:47], v[46:47], v[62:63]
    v_pk_add_f32 v[48:49], v[48:49], v[64:65]
    v_pk_add_f32 v[50:51], v[50:51], v[66:67]
    v_pk_add_f32 v[52:53], v[52:53], v[68:69]
    v_pk_add_f32 v[54:55], v[54:55], v[70:71]
    v_pk_add_f32 v[72:73], v[72:73], v[88:89]
    v_pk_add_f32 v[74:75], v[74:75], v[90:91]
    v_pk_add_f32 v[76:77], v[76:77], v[92:93]
    v_pk_add_f32 v[78:79], v[78:79], v[94:95]
    v_pk_add_f32 v[80:81], v[80:81], v[96:97]
    v_pk_add_f32 v[82:83], v[82:83], v[98:99]
    v_pk_add_f32 v[84:85], v[84:85], v[100:101]
    v_pk_add_f32 v[86:87], v[86:87], v[102:103]
    v_pk_add_f32 v[40:41], v[40:41], v[72:73]
    v_pk_add_f32 v[42:43], v[42:43], v[74:75]
    v_pk_add_f32 v[44:45], v[44:45], v[76:77]
    v_pk_add_f32 v[46:47], v[46:47], v[78:79]
    v_pk_add_f32 v[48:49], v[48:49], v[80:81]
    v_pk_add_f32 v[50:51], v[50:51], v[82:83]
    v_pk_add_f32 v[52:53], v[52:53], v[84:85]
    v_pk_add_f32 v[54:55], v[54:55], v[86:87]
    v_cvt_pk_bf16_f32 v112, v40, v41
    v_cvt_pk_bf16_f32 v113, v42, v43
    v_cvt_pk_bf16_f32 v114, v44, v45
    v_cvt_pk_bf16_f32 v115, v46, v47
    v_cvt_pk_bf16_f32 v116, v48, v49
    v_cvt_pk_bf16_f32 v117, v50, v51
    v_cvt_pk_bf16_f32 v118, v52, v53
    v_cvt_pk_bf16_f32 v119, v54, v55
    buffer_store_dwordx4 v[112:115], v4, s[12:15], s29 offen sc1
    buffer_store_dwordx4 v[116:119], v4, s[12:15], s29 offen offset:1024 sc1
    s_cmp_eq_u32 s26, 1
    s_cbranch_scc1 GP_NK
    v_mov_b32_e64 v6, 0
    v_dot2_f32_bf16 v6, v112, v112, v6
    v_dot2_f32_bf16 v6, v113, v113, v6
    v_dot2_f32_bf16 v6, v114, v114, v6
    v_dot2_f32_bf16 v6, v115, v115, v6
    v_dot2_f32_bf16 v6, v116, v116, v6
    v_dot2_f32_bf16 v6, v117, v117, v6
    v_dot2_f32_bf16 v6, v118, v118, v6
    v_dot2_f32_bf16 v6, v119, v119, v6
    s_nop 2
    v_mov_b32 v7, v6
    s_nop 1
    v_permlane32_swap_b32 v6, v7
    v_add_f32 v6, v6, v7
    s_nop 1
    v_max_f32_dpp v6, v6, v6 row_shr:1 row_mask:0xf bank_mask:0xf
    s_nop 1
    v_max_f32_dpp v6, v6, v6 row_shr:2 row_mask:0xf bank_mask:0xf
    s_nop 1
    v_max_f32_dpp v6, v6, v6 row_shr:4 row_mask:0xf bank_mask:0xf
    s_nop 1
    v_max_f32_dpp v6, v6, v6 row_shr:8 row_mask:0xf bank_mask:0xf
    s_nop 1
    v_max_f32_dpp v6, v6, v6 row_bcast:15 row_mask:0xa bank_mask:0xf
    s_nop 1
    v_max_f32_dpp v6, v6, v6 row_bcast:31 row_mask:0xc bank_mask:0xf
    s_nop 1
    s_nop 0
    v_readlane_b32 s30, v6, 63
    s_lshl_b32 s28, s28, 7
    s_add_u32 s28, s28, 17047552
    v_mov_b32 v6, s30
    s_mov_b32 exec_hi, 0
    buffer_store_dword v6, v154, s[12:15], s28 offen sc1
    s_mov_b32 exec_hi, -1
GP_NK:
    s_barrier
    s_add_u32 s28, s33, 17956864
    s_waitcnt vmcnt(0)
    v_mov_b32 v7, s92
    v_lshlrev_b32 v6, 2, v1
    s_mov_b32 exec_hi, 0
    buffer_store_dword v7, v6, s[12:15], s28 offen sc1
    s_mov_b32 exec_hi, -1
    s_branch GP_G
GP_NR:
    s_barrier
GP_G:
    v_lshlrev_b32 v40, 16, v156
    v_and_b32 v41, 0xffff0000, v156
    v_lshlrev_b32_e64 v42, 16, v157
    v_and_b32 v43, 0xffff0000, v157
    v_lshlrev_b32_e64 v44, 16, v158
    v_and_b32 v45, 0xffff0000, v158
    v_lshlrev_b32_e64 v46, 16, v159
    v_and_b32 v47, 0xffff0000, v159
    v_lshlrev_b32_e64 v48, 16, v160
    v_and_b32 v49, 0xffff0000, v160
    v_lshlrev_b32_e64 v50, 16, v161
    v_and_b32 v51, 0xffff0000, v161
    v_lshlrev_b32_e64 v52, 16, v162
    v_and_b32 v53, 0xffff0000, v162
    v_lshlrev_b32_e64 v54, 16, v163
    v_and_b32 v55, 0xffff0000, v163
    v_lshlrev_b32_e64 v56, 16, v8
    v_and_b32 v57, 0xffff0000, v8
    v_lshlrev_b32_e64 v58, 16, v9
    v_and_b32 v59, 0xffff0000, v9
    v_lshlrev_b32_e64 v60, 16, v10
    v_and_b32 v61, 0xffff0000, v10
    v_lshlrev_b32_e64 v62, 16, v11
    v_and_b32 v63, 0xffff0000, v11
    v_lshlrev_b32_e64 v64, 16, v12
    v_and_b32 v65, 0xffff0000, v12
    v_lshlrev_b32_e64 v66, 16, v13
    v_and_b32 v67, 0xffff0000, v13
    v_lshlrev_b32_e64 v68, 16, v14
    v_and_b32 v69, 0xffff0000, v14
    v_lshlrev_b32_e64 v70, 16, v15
    v_and_b32 v71, 0xffff0000, v15
    v_pk_mul_f32 v[104:105], v[56:57], v[40:41]
    v_pk_fma_f32 v[104:105], v[58:59], v[42:43], v[104:105]
    v_pk_fma_f32 v[104:105], v[60:61], v[44:45], v[104:105]
    v_pk_fma_f32 v[104:105], v[62:63], v[46:47], v[104:105]
    v_pk_fma_f32 v[104:105], v[64:65], v[48:49], v[104:105]
    v_pk_fma_f32 v[104:105], v[66:67], v[50:51], v[104:105]
    v_pk_fma_f32 v[104:105], v[68:69], v[52:53], v[104:105]
    v_pk_fma_f32 v[104:105], v[70:71], v[54:55], v[104:105]
    v_lshlrev_b32_e64 v72, 16, v16
    v_and_b32 v73, 0xffff0000, v16
    v_lshlrev_b32_e64 v74, 16, v17
    v_and_b32 v75, 0xffff0000, v17
    v_lshlrev_b32_e64 v76, 16, v18
    v_and_b32 v77, 0xffff0000, v18
    v_lshlrev_b32_e64 v78, 16, v19
    v_and_b32 v79, 0xffff0000, v19
    v_lshlrev_b32_e64 v80, 16, v20
    v_and_b32 v81, 0xffff0000, v20
    v_lshlrev_b32_e64 v82, 16, v21
    v_and_b32 v83, 0xffff0000, v21
    v_lshlrev_b32_e64 v84, 16, v22
    v_and_b32 v85, 0xffff0000, v22
    v_lshlrev_b32_e64 v86, 16, v23
    v_and_b32 v87, 0xffff0000, v23
    v_pk_mul_f32 v[106:107], v[72:73], v[40:41]
    v_pk_fma_f32 v[106:107], v[74:75], v[42:43], v[106:107]
    v_pk_fma_f32 v[106:107], v[76:77], v[44:45], v[106:107]
    v_pk_fma_f32 v[106:107], v[78:79], v[46:47], v[106:107]
    v_pk_fma_f32 v[106:107], v[80:81], v[48:49], v[106:107]
    v_pk_fma_f32 v[106:107], v[82:83], v[50:51], v[106:107]
    v_pk_fma_f32 v[106:107], v[84:85], v[52:53], v[106:107]
    v_pk_fma_f32 v[106:107], v[86:87], v[54:55], v[106:107]
    v_lshlrev_b32_e64 v56, 16, v24
    v_and_b32 v57, 0xffff0000, v24
    v_lshlrev_b32_e64 v58, 16, v25
    v_and_b32 v59, 0xffff0000, v25
    v_lshlrev_b32_e64 v60, 16, v26
    v_and_b32 v61, 0xffff0000, v26
    v_lshlrev_b32_e64 v62, 16, v27
    v_and_b32 v63, 0xffff0000, v27
    v_lshlrev_b32_e64 v64, 16, v28
    v_and_b32 v65, 0xffff0000, v28
    v_lshlrev_b32_e64 v66, 16, v29
    v_and_b32 v67, 0xffff0000, v29
    v_lshlrev_b32_e64 v68, 16, v30
    v_and_b32 v69, 0xffff0000, v30
    v_lshlrev_b32_e64 v70, 16, v31
    v_and_b32 v71, 0xffff0000, v31
    v_pk_mul_f32 v[108:109], v[56:57], v[40:41]
    v_pk_fma_f32 v[108:109], v[58:59], v[42:43], v[108:109]
    v_pk_fma_f32 v[108:109], v[60:61], v[44:45], v[108:109]
    v_pk_fma_f32 v[108:109], v[62:63], v[46:47], v[108:109]
    v_pk_fma_f32 v[108:109], v[64:65], v[48:49], v[108:109]
    v_pk_fma_f32 v[108:109], v[66:67], v[50:51], v[108:109]
    v_pk_fma_f32 v[108:109], v[68:69], v[52:53], v[108:109]
    v_pk_fma_f32 v[108:109], v[70:71], v[54:55], v[108:109]
    v_lshlrev_b32_e64 v72, 16, v32
    v_and_b32 v73, 0xffff0000, v32
    v_lshlrev_b32_e64 v74, 16, v33
    v_and_b32 v75, 0xffff0000, v33
    v_lshlrev_b32_e64 v76, 16, v34
    v_and_b32 v77, 0xffff0000, v34
    v_lshlrev_b32_e64 v78, 16, v35
    v_and_b32 v79, 0xffff0000, v35
    v_lshlrev_b32_e64 v80, 16, v36
    v_and_b32 v81, 0xffff0000, v36
    v_lshlrev_b32_e64 v82, 16, v37
    v_and_b32 v83, 0xffff0000, v37
    v_lshlrev_b32_e64 v84, 16, v38
    v_and_b32 v85, 0xffff0000, v38
    v_lshlrev_b32_e64 v86, 16, v39
    v_and_b32 v87, 0xffff0000, v39
    v_pk_mul_f32 v[110:111], v[72:73], v[40:41]
    v_pk_fma_f32 v[110:111], v[74:75], v[42:43], v[110:111]
    v_pk_fma_f32 v[110:111], v[76:77], v[44:45], v[110:111]
    v_pk_fma_f32 v[110:111], v[78:79], v[46:47], v[110:111]
    v_pk_fma_f32 v[110:111], v[80:81], v[48:49], v[110:111]
    v_pk_fma_f32 v[110:111], v[82:83], v[50:51], v[110:111]
    v_pk_fma_f32 v[110:111], v[84:85], v[52:53], v[110:111]
    v_pk_fma_f32 v[110:111], v[86:87], v[54:55], v[110:111]
    v_add_f32 v104, v104, v105
    v_add_f32 v106, v106, v107
    v_add_f32 v108, v108, v109
    v_add_f32_e64 v110, v110, v111
    s_nop 1
    v_add_f32_dpp v104, v104, v104 row_shr:1 row_mask:0xf bank_mask:0xf
    v_add_f32_dpp v106, v106, v106 row_shr:1 row_mask:0xf bank_mask:0xf
    v_add_f32_dpp v108, v108, v108 row_shr:1 row_mask:0xf bank_mask:0xf
    v_add_f32_dpp v110, v110, v110 row_shr:1 row_mask:0xf bank_mask:0xf
    v_add_f32_dpp v104, v104, v104 row_shr:2 row_mask:0xf bank_mask:0xf
    v_add_f32_dpp v106, v106, v106 row_shr:2 row_mask:0xf bank_mask:0xf
    v_add_f32_dpp v108, v108, v108 row_shr:2 row_mask:0xf bank_mask:0xf
    v_add_f32_dpp v110, v110, v110 row_shr:2 row_mask:0xf bank_mask:0xf
    v_add_f32_dpp v104, v104, v104 row_shr:4 row_mask:0xf bank_mask:0xf
    v_add_f32_dpp v106, v106, v106 row_shr:4 row_mask:0xf bank_mask:0xf
    v_add_f32_dpp v108, v108, v108 row_shr:4 row_mask:0xf bank_mask:0xf
    v_add_f32_dpp v110, v110, v110 row_shr:4 row_mask:0xf bank_mask:0xf
    v_add_f32_dpp v104, v104, v104 row_shr:8 row_mask:0xf bank_mask:0xf
    v_add_f32_dpp v106, v106, v106 row_shr:8 row_mask:0xf bank_mask:0xf
    v_add_f32_dpp v108, v108, v108 row_shr:8 row_mask:0xf bank_mask:0xf
    v_add_f32_dpp v110, v110, v110 row_shr:8 row_mask:0xf bank_mask:0xf
    v_add_f32_dpp v104, v104, v104 row_bcast:15 row_mask:0xa bank_mask:0xf
    v_add_f32_dpp v106, v106, v106 row_bcast:15 row_mask:0xa bank_mask:0xf
    v_add_f32_dpp v108, v108, v108 row_bcast:15 row_mask:0xa bank_mask:0xf
    v_add_f32_dpp v110, v110, v110 row_bcast:15 row_mask:0xa bank_mask:0xf
    v_add_f32_dpp v104, v104, v104 row_bcast:31 row_mask:0xc bank_mask:0xf
    v_add_f32_dpp v106, v106, v106 row_bcast:31 row_mask:0xc bank_mask:0xf
    v_add_f32_dpp v108, v108, v108 row_bcast:31 row_mask:0xc bank_mask:0xf
    v_add_f32_dpp v110, v110, v110 row_bcast:31 row_mask:0xc bank_mask:0xf
    s_nop 0
    s_nop 0
    v_readlane_b32 s28, v104, 63
    v_readlane_b32 s29, v106, 63
    v_readlane_b32 s30, v108, 63
    v_readlane_b32 s31, v110, 63
    v_mov_b32 v5, 0
    s_nop 0
    v_writelane_b32 v5, s28, 0
    v_writelane_b32 v5, s29, 1
    v_writelane_b32 v5, s30, 2
    v_writelane_b32 v5, s31, 3
    v_mul_f32 v5, 0xbfb8aa3b, v5
    v_exp_f32 v5, v5
    s_nop 0
    v_add_f32 v5, 1.0, v5
    v_rcp_f32_e64 v5, v5
    s_mov_b64 exec, 15
    buffer_store_dword v5, v154, s[12:15], s39 offen sc1
    s_mov_b64 exec, -1
    s_branch GP_DONE
GP_KV:
    s_cmp_eq_u32 s26, 1
    s_cselect_b32 s44, s70, s68
    s_cselect_b32 s45, s71, s69
    s_and_b32 s45, s45, 0xffff
    s_mov_b32 s46, 0x10000
    s_mov_b32 s47, 0x20000
    s_and_b32 s52, s20, 3
    s_lshr_b32 s28, s98, 1
    s_lshl_b32 s28, s28, 2
    s_add_u32 s28, s28, s52
    s_lshl_b32 s28, s28, 11
    v_lshlrev_b32 v5, 7, v1
    s_mov_b32 s16, s84
    s_and_b32 s17, s85, 0xffff
    s_mov_b32 s18, 0x800
    s_mov_b32 s19, 0x20000
    s_mov_b32 s48, s78
    s_and_b32 s49, s79, 0xffff
    s_mov_b32 s50, 0x1c00
    s_mov_b32 s51, 0x20000
    s_lshl_b32 s29, s52, 9
    s_mul_i32 s30, s22, 448
    s_lshl_b32 s31, s52, 7
    s_add_u32 s30, s30, s31
    s_mov_b64 exec, 0xffff
    buffer_load_dword v254, v5, s[44:47], s28 offen
    s_mov_b64 exec, 15
    buffer_load_dword v254, v5, s[16:19], s29 offen
    s_mov_b64 exec, 1
    buffer_load_dword v254, v5, s[48:51], s30 offen
    s_mov_b64 exec, -1
    s_mov_b32 s48, s76
    s_and_b32 s49, s77, 0xffff
    s_mov_b32 s50, 0xe00000
    s_mov_b32 s51, 0x20000
    s_and_b32 s52, s20, 3
    v_lshrrev_b32 v5, 3, v1
    v_and_b32 v6, 7, v1
    v_and_b32 v7, 2, v5
    v_xor_b32 v6, v6, v7
    s_movk_i32 s28, 7168
    v_mul_lo_u32 v5, v5, s28
    s_mul_i32 s28, s22, 448
    s_and_b32 s29, s22, 1
    s_lshl_b32 s29, s29, 6
    s_sub_u32 s28, s28, s29
    s_lshl_b32 s29, s52, 7
    s_add_u32 s28, s28, s29
    v_add_u32 v5, s28, v5
    v_lshl_add_u32 v7, v6, 4, v5
    v_xor_b32_e64 v6, 4, v6
    v_lshl_add_u32 v6, v6, 4, v5
    v_add_u32_e64 v200, 0, v7
    v_add_u32 v201, 56320, v6
    v_add_u32 v202, 112640, v7
    v_add_u32 v203, 168960, v6
    v_add_u32 v204, 229376, v7
    v_add_u32 v205, 285696, v6
    v_add_u32 v206, 342016, v7
    v_add_u32 v207, 398336, v6
    s_lshl_b32 s28, s21, 19
    s_lshl_b32 s29, s52, 12
    s_add_u32 s28, s28, s29
    s_add_u32 s28, s28, 0
    v_lshl_add_u32 v208, v1, 4, s28
    s_lshl_b32 s28, s98, 2
    s_add_u32 s28, s28, s52
    s_lshl_b32 s28, s28, 2
    v_add_u32_e64 v5, s28, v3
    s_movk_i32 s28, 7168
    v_mul_lo_u32 v5, v5, s28
    v_min_u32_e64 v6, 13, v2
    v_lshl_add_u32 v5, v6, 7, v5
    s_lshr_b32 s28, s93, 1
    s_mul_i32 s28, s28, 1792
    v_add_u32_e64 v209, s28, v5
    s_lshl_b32 s54, s52, 13
    s_add_u32 s55, s29, 32768
    s_lshl_b32 s39, s52, 14
    s_lshl_b32 s38, s52, 9
    v_add_u32 v5, s34, v3
    v_lshlrev_b32 v5, 11, v5
    v_add_u32 v5, s38, v5
    v_xor_b32 v6, v2, v3
    v_xor_b32_e64 v7, 0, v6
    v_lshl_add_u32 v128, v7, 4, v5
    v_add_u32 v128, 0, v128
    v_xor_b32 v7, 4, v6
    v_lshl_add_u32 v129, v7, 4, v5
    v_add_u32 v129, 7168, v129
    v_xor_b32_e64 v7, 8, v6
    v_lshl_add_u32 v130, v7, 4, v5
    v_add_u32 v130, 14336, v130
    v_xor_b32_e64 v7, 12, v6
    v_lshl_add_u32 v131, v7, 4, v5
    v_add_u32 v131, 21504, v131
    v_xor_b32_e64 v7, 0, v6
    v_lshl_add_u32 v132, v7, 4, v5
    v_add_u32 v132, 32768, v132
    v_xor_b32_e64 v7, 4, v6
    v_lshl_add_u32 v133, v7, 4, v5
    v_add_u32 v133, 39936, v133
    v_xor_b32_e64 v7, 8, v6
    v_lshl_add_u32 v134, v7, 4, v5
    v_add_u32 v134, 47104, v134
    v_xor_b32_e64 v7, 12, v6
    v_lshl_add_u32 v135, v7, 4, v5
    v_add_u32 v135, 54272, v135
    v_and_b32 v5, 31, v1
    v_lshrrev_b32 v6, 5, v1
    v_xor_b32 v6, v6, v2
    v_lshlrev_b32 v5, 8, v5
    v_lshl_add_u32 v5, v6, 4, v5
    s_add_u32 s31, s39, 65536
    v_add_u32 v5, s31, v5
    v_xor_b32 v136, 0, v5
    v_xor_b32 v137, 32, v5
    v_xor_b32 v138, 64, v5
    v_xor_b32 v139, 96, v5
    v_xor_b32 v140, 128, v5
    v_xor_b32 v141, 160, v5
    v_xor_b32 v142, 192, v5
    v_xor_b32 v143, 224, v5
    v_lshrrev_b32 v5, 2, v2
    v_lshrrev_b32 v7, 1, v3
    v_lshl_add_u32 v150, v7, 3, v5
    v_lshlrev_b32 v150, 6, v150
    v_and_b32 v6, 1, v3
    v_lshl_add_u32 v150, v6, 5, v150
    v_and_b32_e64 v6, 3, v1
    v_lshl_add_u32 v150, v6, 3, v150
    v_add_u32 v150, s39, v150
    v_add_u32 v151, s31, v4
    s_movk_i32 s41, 256
    s_mov_b32 s40, s39
    s_mov_b32 s42, 1835008
    s_waitcnt vmcnt(0) lgkmcnt(0)
    s_mul_i32 s92, s92, 1664525
    s_add_u32 s92, s92, 1013904223
    s_nop 0
    s_add_u32 m0, s40, 0
    s_nop 0
    buffer_load_dwordx4 v4, s[44:47], s40 offen offset:0 lds
    buffer_load_dwordx4 v4, s[44:47], s40 offen offset:1024 lds
    buffer_load_dwordx4 v4, s[44:47], s40 offen offset:2048 lds
    buffer_load_dwordx4 v4, s[44:47], s40 offen offset:3072 lds
    s_add_u32 s40, s40, 4096
    s_add_u32 m0, s40, 0
    s_nop 0
    buffer_load_dwordx4 v4, s[44:47], s40 offen offset:0 lds
    buffer_load_dwordx4 v4, s[44:47], s40 offen offset:1024 lds
    buffer_load_dwordx4 v4, s[44:47], s40 offen offset:2048 lds
    buffer_load_dwordx4 v4, s[44:47], s40 offen offset:3072 lds
    s_add_u32 s40, s40, 4096
    s_add_u32 m0, s40, 0
    s_nop 0
    buffer_load_dwordx4 v4, s[44:47], s40 offen offset:0 lds
    buffer_load_dwordx4 v4, s[44:47], s40 offen offset:1024 lds
    buffer_load_dwordx4 v4, s[44:47], s40 offen offset:2048 lds
    buffer_load_dwordx4 v4, s[44:47], s40 offen offset:3072 lds
    s_add_u32 s40, s40, 4096
    s_add_u32 m0, s40, 0
    s_nop 0
    buffer_load_dwordx4 v4, s[44:47], s40 offen offset:0 lds
    buffer_load_dwordx4 v4, s[44:47], s40 offen offset:1024 lds
    buffer_load_dwordx4 v4, s[44:47], s40 offen offset:2048 lds
    buffer_load_dwordx4 v4, s[44:47], s40 offen offset:3072 lds
    s_add_u32 s40, s40, 4096
    s_add_u32 m0, s31, 0
    s_nop 0
    buffer_load_dwordx4 v128, s[8:11], 0 offen offset:0 lds
    buffer_load_dwordx4 v129, s[8:11], 0 offen offset:1024 lds
    buffer_load_dwordx4 v130, s[8:11], 0 offen offset:2048 lds
    buffer_load_dwordx4 v131, s[8:11], 0 offen offset:3072 lds
    s_add_u32 m0, s31, 4096
    s_nop 0
    s_nop 0
    buffer_load_dwordx4 v132, s[8:11], 0 offen offset:0 lds
    buffer_load_dwordx4 v133, s[8:11], 0 offen offset:1024 lds
    buffer_load_dwordx4 v134, s[8:11], 0 offen offset:2048 lds
    buffer_load_dwordx4 v135, s[8:11], 0 offen offset:3072 lds
    s_add_u32 m0, s31, 8192
    s_nop 0
    s_nop 0
    buffer_load_dwordx4 v128, s[8:11], s41 offen offset:0 lds
    buffer_load_dwordx4 v129, s[8:11], s41 offen offset:1024 lds
    buffer_load_dwordx4 v130, s[8:11], s41 offen offset:2048 lds
    buffer_load_dwordx4 v131, s[8:11], s41 offen offset:3072 lds
    s_add_u32 m0, s31, 12288
    s_nop 0
    s_nop 0
    buffer_load_dwordx4 v132, s[8:11], s41 offen offset:0 lds
    buffer_load_dwordx4 v133, s[8:11], s41 offen offset:1024 lds
    buffer_load_dwordx4 v134, s[8:11], s41 offen offset:2048 lds
    buffer_load_dwordx4 v135, s[8:11], s41 offen offset:3072 lds
    s_barrier
    s_waitcnt vmcnt(0)
    ds_read_b128 v[96:99], v136 offset:0
    ds_read_b64_tr_b16 v[32:33], v150 offset:0
    ds_read_b64_tr_b16 v[34:35], v150 offset:256
    ds_read_b128 v[100:103], v137 offset:0
    ds_read_b64_tr_b16 v[36:37], v150 offset:1024
    ds_read_b64_tr_b16 v[38:39], v150 offset:1280
    ds_read_b128 v[104:107], v138 offset:0
    ds_read_b64_tr_b16 v[40:41], v150 offset:2048
    ds_read_b64_tr_b16 v[42:43], v150 offset:2304
    ds_read_b128 v[108:111], v139 offset:0
    ds_read_b64_tr_b16 v[44:45], v150 offset:3072
    ds_read_b64_tr_b16 v[46:47], v150 offset:3328
    ds_read_b128 v[112:115], v140 offset:0
    ds_read_b64_tr_b16 v[48:49], v150 offset:4096
    ds_read_b64_tr_b16 v[50:51], v150 offset:4352
    ds_read_b128 v[116:119], v141 offset:0
    ds_read_b64_tr_b16 v[52:53], v150 offset:5120
    ds_read_b64_tr_b16 v[54:55], v150 offset:5376
    ds_read_b128 v[120:123], v142 offset:0
    ds_read_b64_tr_b16 v[56:57], v150 offset:6144
    ds_read_b64_tr_b16 v[58:59], v150 offset:6400
    ds_read_b128 v[124:127], v143 offset:0
    ds_read_b64_tr_b16 v[60:61], v150 offset:7168
    ds_read_b64_tr_b16 v[62:63], v150 offset:7424
    s_cmp_eq_u32 s26, 1
    s_waitcnt lgkmcnt(0)
    s_cbranch_scc1 GP_V0
    s_nop 0
    v_mfma_f32_32x32x16_bf16 v[64:79], v[32:35], v[96:99], 0
    v_mfma_f32_32x32x16_bf16 v[64:79], v[36:39], v[100:103], v[64:79]
    v_mfma_f32_32x32x16_bf16 v[64:79], v[40:43], v[104:107], v[64:79]
    v_mfma_f32_32x32x16_bf16 v[64:79], v[44:47], v[108:111], v[64:79]
    v_mfma_f32_32x32x16_bf16 v[64:79], v[48:51], v[112:115], v[64:79]
    v_mfma_f32_32x32x16_bf16 v[64:79], v[52:55], v[116:119], v[64:79]
    v_mfma_f32_32x32x16_bf16 v[64:79], v[56:59], v[120:123], v[64:79]
    v_mfma_f32_32x32x16_bf16 v[64:79], v[60:63], v[124:127], v[64:79]
    s_branch GP_J0
GP_V0:
    s_nop 0
    v_mfma_f32_32x32x16_bf16 v[64:79], v[96:99], v[32:35], 0
    v_mfma_f32_32x32x16_bf16 v[64:79], v[100:103], v[36:39], v[64:79]
    v_mfma_f32_32x32x16_bf16 v[64:79], v[104:107], v[40:43], v[64:79]
    v_mfma_f32_32x32x16_bf16 v[64:79], v[108:111], v[44:47], v[64:79]
    v_mfma_f32_32x32x16_bf16 v[64:79], v[112:115], v[48:51], v[64:79]
    v_mfma_f32_32x32x16_bf16 v[64:79], v[116:119], v[52:55], v[64:79]
    v_mfma_f32_32x32x16_bf16 v[64:79], v[120:123], v[56:59], v[64:79]
    v_mfma_f32_32x32x16_bf16 v[64:79], v[124:127], v[60:63], v[64:79]
GP_J0:
    ds_read_b128 v[96:99], v136 offset:8192
    ds_read_b64_tr_b16 v[32:33], v150 offset:8192
    ds_read_b64_tr_b16 v[34:35], v150 offset:8448
    ds_read_b128 v[100:103], v137 offset:8192
    ds_read_b64_tr_b16 v[36:37], v150 offset:9216
    ds_read_b64_tr_b16 v[38:39], v150 offset:9472
    ds_read_b128 v[104:107], v138 offset:8192
    ds_read_b64_tr_b16 v[40:41], v150 offset:10240
    ds_read_b64_tr_b16 v[42:43], v150 offset:10496
    ds_read_b128 v[108:111], v139 offset:8192
    ds_read_b64_tr_b16 v[44:45], v150 offset:11264
    ds_read_b64_tr_b16 v[46:47], v150 offset:11520
    ds_read_b128 v[112:115], v140 offset:8192
    ds_read_b64_tr_b16 v[48:49], v150 offset:12288
    ds_read_b64_tr_b16 v[50:51], v150 offset:12544
    ds_read_b128 v[116:119], v141 offset:8192
    ds_read_b64_tr_b16 v[52:53], v150 offset:13312
    ds_read_b64_tr_b16 v[54:55], v150 offset:13568
    ds_read_b128 v[120:123], v142 offset:8192
    ds_read_b64_tr_b16 v[56:57], v150 offset:14336
    ds_read_b64_tr_b16 v[58:59], v150 offset:14592
    ds_read_b128 v[124:127], v143 offset:8192
    ds_read_b64_tr_b16 v[60:61], v150 offset:15360
    ds_read_b64_tr_b16 v[62:63], v150 offset:15616
    s_cmp_eq_u32 s26, 1
    s_waitcnt lgkmcnt(0)
    s_cbranch_scc1 GP_V1
    s_nop 0
    v_mfma_f32_32x32x16_bf16 v[64:79], v[32:35], v[96:99], v[64:79]
    v_mfma_f32_32x32x16_bf16 v[64:79], v[36:39], v[100:103], v[64:79]
    v_mfma_f32_32x32x16_bf16 v[64:79], v[40:43], v[104:107], v[64:79]
    v_mfma_f32_32x32x16_bf16 v[64:79], v[44:47], v[108:111], v[64:79]
    v_mfma_f32_32x32x16_bf16 v[64:79], v[48:51], v[112:115], v[64:79]
    v_mfma_f32_32x32x16_bf16 v[64:79], v[52:55], v[116:119], v[64:79]
    v_mfma_f32_32x32x16_bf16 v[64:79], v[56:59], v[120:123], v[64:79]
    v_mfma_f32_32x32x16_bf16 v[64:79], v[60:63], v[124:127], v[64:79]
    s_branch GP_J1
GP_V1:
    s_nop 0
    v_mfma_f32_32x32x16_bf16 v[64:79], v[96:99], v[32:35], v[64:79]
    v_mfma_f32_32x32x16_bf16 v[64:79], v[100:103], v[36:39], v[64:79]
    v_mfma_f32_32x32x16_bf16 v[64:79], v[104:107], v[40:43], v[64:79]
    v_mfma_f32_32x32x16_bf16 v[64:79], v[108:111], v[44:47], v[64:79]
    v_mfma_f32_32x32x16_bf16 v[64:79], v[112:115], v[48:51], v[64:79]
    v_mfma_f32_32x32x16_bf16 v[64:79], v[116:119], v[52:55], v[64:79]
    v_mfma_f32_32x32x16_bf16 v[64:79], v[120:123], v[56:59], v[64:79]
    v_mfma_f32_32x32x16_bf16 v[64:79], v[124:127], v[60:63], v[64:79]
GP_J1:
    s_nop 0
    s_nop 11
    ds_write_b128 v151, v[64:67] offset:0
    ds_write_b128 v151, v[68:71] offset:1024
    ds_write_b128 v151, v[72:75] offset:2048
    ds_write_b128 v151, v[76:79] offset:3072
    s_waitcnt lgkmcnt(0)
    s_barrier
    s_cmp_eq_u32 s20, 4
    s_cbranch_scc0 GP_NF
    s_add_u32 s28, s33, 17891328
    v_mov_b32 v7, s92
    v_lshlrev_b32_e64 v6, 2, v1
    s_mov_b32 exec_hi, 0
    buffer_store_dword v7, v6, s[12:15], s28 offen sc1
    s_mov_b32 exec_hi, -1
GP_NF:
    s_barrier
    buffer_load_dword v254, v209, s[48:51], 0 offen
    buffer_load_dword v254, v209, s[48:51], s42 offen
GP_DONE:
    s_cmp_ge_u32 s20, 4
    s_cbranch_scc1 G_LOADER
    s_lshr_b32 s27, s20, 1
    s_and_b32 s28, s20, 1
    s_mul_i32 s29, s22, 14
    s_lshl_b32 s30, s27, 3
    s_add_u32 s30, s30, s29
    s_add_u32 s31, s29, 6
    s_add_u32 s31, s31, s27
    v_lshrrev_b32 v5, 2, v2
    v_lshl_add_u32 v6, v3, 3, v5
    v_lshlrev_b32 v6, 7, v6
    v_and_b32 v7, 3, v1
    v_lshl_add_u32 v6, v7, 3, v6
    v_lshrrev_b32 v5, 1, v5
    v_and_b32 v7, 1, v3
    v_lshl_add_u32 v5, v7, 1, v5
    v_lshl_add_u32 v6, v5, 5, v6
    s_and_b32 s34, s22, 1
    s_lshl_b32 s34, s34, 1
    s_lshl_b32 s35, s27, 3
    s_add_u32 s35, s35, s34
    s_add_u32 s36, s34, 6
    s_add_u32 s36, s36, s27
    s_add_u32 s37, s35, 0
    s_and_b32 s38, s37, 3
    s_lshl_b32 s38, s38, 5
    s_lshr_b32 s37, s37, 2
    s_lshl_b32 s37, s37, 13
    v_xor_b32 v10, s38, v6
    v_add_u32 v10, s37, v10
    s_add_u32 s37, s35, 1
    s_and_b32 s38, s37, 3
    s_lshl_b32 s38, s38, 5
    s_lshr_b32 s37, s37, 2
    s_lshl_b32 s37, s37, 13
    v_xor_b32 v11, s38, v6
    v_add_u32 v11, s37, v11
    s_add_u32 s37, s35, 2
    s_and_b32 s38, s37, 3
    s_lshl_b32 s38, s38, 5
    s_lshr_b32 s37, s37, 2
    s_lshl_b32 s37, s37, 13
    v_xor_b32 v12, s38, v6
    v_add_u32 v12, s37, v12
    s_add_u32 s37, s35, 3
    s_and_b32 s38, s37, 3
    s_lshl_b32 s38, s38, 5
    s_lshr_b32 s37, s37, 2
    s_lshl_b32 s37, s37, 13
    v_xor_b32 v13, s38, v6
    v_add_u32 v13, s37, v13
    s_mov_b32 s37, s36
    s_and_b32 s38, s37, 3
    s_lshl_b32 s38, s38, 5
    s_lshr_b32 s37, s37, 2
    s_lshl_b32 s37, s37, 13
    v_xor_b32 v14, s38, v6
    v_add_u32 v14, s37, v14
    s_lshl_b32 s37, s28, 12
    s_add_u32 s37, s37, 32768
    v_lshl_add_u32 v15, v1, 4, s37
    v_lshlrev_b32_e64 v128, 16, v240
    v_and_b32 v129, 0xffff0000, v240
    v_lshlrev_b32_e64 v130, 16, v241
    v_and_b32 v131, 0xffff0000, v241
    v_mov_b32 v132, v128
    v_mov_b32 v133, v129
    v_mov_b32 v134, v130
    v_mov_b32 v135, v131
    v_mov_b32 v136, v128
    v_mov_b32 v137, v129
    v_mov_b32 v138, v130
    v_mov_b32 v139, v131
    v_mov_b32 v140, v128
    v_mov_b32 v141, v129
    v_mov_b32 v142, v130
    v_mov_b32 v143, v131
    v_lshlrev_b32_e64 v144, 16, v242
    v_and_b32 v145, 0xffff0000, v242
    v_lshlrev_b32_e64 v146, 16, v243
    v_and_b32 v147, 0xffff0000, v243
    v_mov_b32 v148, v144
    v_mov_b32 v149, v145
    v_mov_b32 v150, v146
    v_mov_b32 v151, v147
    v_mov_b32 v152, v144
    v_mov_b32 v153, v145
    v_mov_b32 v154, v146
    v_mov_b32 v155, v147
    v_mov_b32 v156, v144
    v_mov_b32 v157, v145
    v_mov_b32 v158, v146
    v_mov_b32 v159, v147
    v_lshlrev_b32_e64 v160, 16, v244
    v_and_b32 v161, 0xffff0000, v244
    v_lshlrev_b32_e64 v162, 16, v245
    v_and_b32 v163, 0xffff0000, v245
    v_mov_b32 v164, v160
    v_mov_b32 v165, v161
    v_mov_b32 v166, v162
    v_mov_b32 v167, v163
    v_mov_b32 v168, v160
    v_mov_b32 v169, v161
    v_mov_b32 v170, v162
    v_mov_b32 v171, v163
    v_mov_b32 v172, v160
    v_mov_b32 v173, v161
    v_mov_b32 v174, v162
    v_mov_b32 v175, v163
    v_lshlrev_b32_e64 v176, 16, v246
    v_and_b32 v177, 0xffff0000, v246
    v_lshlrev_b32_e64 v178, 16, v247
    v_and_b32 v179, 0xffff0000, v247
    v_mov_b32 v180, v176
    v_mov_b32 v181, v177
    v_mov_b32 v182, v178
    v_mov_b32 v183, v179
    v_mov_b32 v184, v176
    v_mov_b32 v185, v177
    v_mov_b32 v186, v178
    v_mov_b32 v187, v179
    v_mov_b32 v188, v176
    v_mov_b32 v189, v177
    v_mov_b32 v190, v178
    v_mov_b32 v191, v179
    v_lshlrev_b32_e64 v192, 16, v248
    v_and_b32 v193, 0xffff0000, v248
    v_lshlrev_b32_e64 v194, 16, v249
    v_and_b32 v195, 0xffff0000, v249
    v_mov_b32 v196, v192
    v_mov_b32 v197, v193
    v_mov_b32 v198, v194
    v_mov_b32 v199, v195
    v_mov_b32 v200, v192
    v_mov_b32 v201, v193
    v_mov_b32 v202, v194
    v_mov_b32 v203, v195
    v_mov_b32 v204, v192
    v_mov_b32 v205, v193
    v_mov_b32 v206, v194
    v_mov_b32 v207, v195
    v_lshlrev_b32_e64 v208, 16, v250
    v_and_b32 v209, 0xffff0000, v250
    v_lshlrev_b32_e64 v210, 16, v251
    v_and_b32 v211, 0xffff0000, v251
    v_mov_b32 v212, v208
    v_mov_b32 v213, v209
    v_mov_b32 v214, v210
    v_mov_b32 v215, v211
    v_mov_b32 v216, v208
    v_mov_b32 v217, v209
    v_mov_b32 v218, v210
    v_mov_b32 v219, v211
    v_mov_b32 v220, v208
    v_mov_b32 v221, v209
    v_mov_b32 v222, v210
    v_mov_b32 v223, v211
    v_lshlrev_b32_e64 v224, 16, v252
    v_and_b32 v225, 0xffff0000, v252
    v_lshlrev_b32_e64 v226, 16, v253
    v_and_b32 v227, 0xffff0000, v253
    v_mov_b32 v228, v224
    v_mov_b32 v229, v225
    v_mov_b32 v230, v226
    v_mov_b32 v231, v227
    v_mov_b32 v232, v224
    v_mov_b32 v233, v225
    v_mov_b32 v234, v226
    v_mov_b32 v235, v227
    v_mov_b32 v236, v224
    v_mov_b32 v237, v225
    v_mov_b32 v238, v226
    v_mov_b32 v239, v227
    v_mov_b32 v4, v10
    v_mov_b32 v5, v11
    v_mov_b32 v6, v12
    v_mov_b32 v7, v13
    v_mov_b32 v8, v14
    v_mov_b32 v9, v15
    s_mov_b32 s24, 0
    s_mov_b32 s16, s82
    s_and_b32 s17, s83, 0xffff
    s_mov_b32 s18, 0x1000
    s_mov_b32 s19, 0x20000
    s_lshl_b32 s60, s22, 7
    s_lshl_b32 s61, s28, 6
    s_add_u32 s60, s60, s61
    v_add_u32 v124, s60, v2
    v_lshlrev_b32 v125, 1, v124
    v_lshlrev_b32 v124, 2, v124
    buffer_load_ushort v120, v125, s[16:19], 0 offen offset:0
    buffer_load_ushort v121, v125, s[16:19], 0 offen offset:32
    buffer_load_ushort v122, v125, s[16:19], 0 offen offset:64
    buffer_load_ushort v123, v125, s[16:19], 0 offen offset:96
    s_cmp_eq_u32 s20, 1
    s_cbranch_scc0 M1_NP
    s_mov_b32 s60, 17891328
    s_mov_b32 s61, 17899520
    v_lshlrev_b32_e64 v16, 7, v1
    s_mov_b32 s99, 0x40000
M1P_1_P:
    buffer_load_dword v17, v16, s[12:15], s60 offen offset:0 sc1
    buffer_load_dword v18, v16, s[12:15], s61 offen offset:0 sc1
    s_waitcnt vmcnt(0)
    v_xor_b32 v17, s92, v17
    v_xor_b32 v18, s92, v18
    v_or_b32 v17, v17, v18
    v_cmp_ne_u32_e64 vcc, 0, v17
    s_sub_u32 s99, s99, 1
    s_cbranch_vccz M1P_1_D
    s_sleep 4
    s_cmp_lg_u32 s99, 0
    s_cbranch_scc1 M1P_1_P
M1P_1_D:
M1_NP:
    s_barrier
    s_waitcnt vmcnt(0)
    s_barrier
    ds_read_b128 v[44:47], v9 offset:0
    ds_read_b128 v[48:51], v9 offset:1024
    ds_read_b128 v[52:55], v9 offset:2048
    ds_read_b128 v[56:59], v9 offset:3072
    ds_read_b64_tr_b16 v[16:17], v4 offset:0
    ds_read_b64_tr_b16 v[18:19], v4 offset:512
    ds_read_b64_tr_b16 v[20:21], v5 offset:0
    ds_read_b64_tr_b16 v[22:23], v5 offset:512
    ds_read_b64_tr_b16 v[24:25], v6 offset:0
    ds_read_b64_tr_b16 v[26:27], v6 offset:512
    ds_read_b64_tr_b16 v[28:29], v7 offset:0
    ds_read_b64_tr_b16 v[30:31], v7 offset:512
    ds_read_b64_tr_b16 v[32:33], v4 offset:8192
    ds_read_b64_tr_b16 v[34:35], v4 offset:8704
    ds_read_b64_tr_b16 v[36:37], v5 offset:8192
    ds_read_b64_tr_b16 v[38:39], v5 offset:8704
    ds_read_b64_tr_b16 v[40:41], v8 offset:0
    ds_read_b64_tr_b16 v[42:43], v8 offset:512
    s_mov_b32 s23, 15
    s_waitcnt lgkmcnt(0)
.p2align 6
M1_CL:
    v_mfma_f32_16x16x32_bf16 v[128:131], v[16:19], v[44:47], v[128:131]
    ds_read_b128 v[88:91], v9 offset:8192
    v_mfma_f32_16x16x32_bf16 v[132:135], v[16:19], v[48:51], v[132:135]
    ds_read_b128 v[92:95], v9 offset:9216
    v_mfma_f32_16x16x32_bf16 v[148:151], v[20:23], v[48:51], v[148:151]
    ds_read_b128 v[96:99], v9 offset:10240
    v_mfma_f32_16x16x32_bf16 v[144:147], v[20:23], v[44:47], v[144:147]
    ds_read_b128 v[100:103], v9 offset:11264
    v_mfma_f32_16x16x32_bf16 v[160:163], v[24:27], v[44:47], v[160:163]
    ds_read_b64_tr_b16 v[60:61], v4 offset:4096
    v_mfma_f32_16x16x32_bf16 v[164:167], v[24:27], v[48:51], v[164:167]
    ds_read_b64_tr_b16 v[62:63], v4 offset:4608
    v_mfma_f32_16x16x32_bf16 v[180:183], v[28:31], v[48:51], v[180:183]
    ds_read_b64_tr_b16 v[64:65], v5 offset:4096
    v_mfma_f32_16x16x32_bf16 v[176:179], v[28:31], v[44:47], v[176:179]
    ds_read_b64_tr_b16 v[66:67], v5 offset:4608
    v_mfma_f32_16x16x32_bf16 v[192:195], v[32:35], v[44:47], v[192:195]
    ds_read_b64_tr_b16 v[68:69], v6 offset:4096
    v_mfma_f32_16x16x32_bf16 v[196:199], v[32:35], v[48:51], v[196:199]
    ds_read_b64_tr_b16 v[70:71], v6 offset:4608
    v_mfma_f32_16x16x32_bf16 v[212:215], v[36:39], v[48:51], v[212:215]
    ds_read_b64_tr_b16 v[72:73], v7 offset:4096
    v_mfma_f32_16x16x32_bf16 v[208:211], v[36:39], v[44:47], v[208:211]
    ds_read_b64_tr_b16 v[74:75], v7 offset:4608
    v_mfma_f32_16x16x32_bf16 v[224:227], v[40:43], v[44:47], v[224:227]
    ds_read_b64_tr_b16 v[76:77], v4 offset:12288
    v_mfma_f32_16x16x32_bf16 v[228:231], v[40:43], v[48:51], v[228:231]
    ds_read_b64_tr_b16 v[78:79], v4 offset:12800
    v_mfma_f32_16x16x32_bf16 v[232:235], v[40:43], v[52:55], v[232:235]
    ds_read_b64_tr_b16 v[80:81], v5 offset:12288
    v_mfma_f32_16x16x32_bf16 v[236:239], v[40:43], v[56:59], v[236:239]
    ds_read_b64_tr_b16 v[82:83], v5 offset:12800
    v_mfma_f32_16x16x32_bf16 v[220:223], v[36:39], v[56:59], v[220:223]
    ds_read_b64_tr_b16 v[84:85], v8 offset:4096
    v_mfma_f32_16x16x32_bf16 v[216:219], v[36:39], v[52:55], v[216:219]
    ds_read_b64_tr_b16 v[86:87], v8 offset:4608
    v_mfma_f32_16x16x32_bf16 v[200:203], v[32:35], v[52:55], v[200:203]
    s_add_u32 s24, s24, 49152
    v_mfma_f32_16x16x32_bf16 v[204:207], v[32:35], v[56:59], v[204:207]
    s_cmp_eq_u32 s24, 147456
    v_mfma_f32_16x16x32_bf16 v[188:191], v[28:31], v[56:59], v[188:191]
    s_cselect_b32 s24, 0, s24
    v_mfma_f32_16x16x32_bf16 v[184:187], v[28:31], v[52:55], v[184:187]
    v_add_u32 v4, s24, v10
    v_mfma_f32_16x16x32_bf16 v[168:171], v[24:27], v[52:55], v[168:171]
    v_add_u32_e64 v5, s24, v11
    v_mfma_f32_16x16x32_bf16 v[172:175], v[24:27], v[56:59], v[172:175]
    v_add_u32_e64 v6, s24, v12
    v_mfma_f32_16x16x32_bf16 v[156:159], v[20:23], v[56:59], v[156:159]
    v_add_u32_e64 v7, s24, v13
    v_mfma_f32_16x16x32_bf16 v[152:155], v[20:23], v[52:55], v[152:155]
    v_add_u32_e64 v8, s24, v14
    v_mfma_f32_16x16x32_bf16 v[136:139], v[16:19], v[52:55], v[136:139]
    v_add_u32_e64 v9, s24, v15
    v_mfma_f32_16x16x32_bf16 v[140:143], v[16:19], v[56:59], v[140:143]
    s_waitcnt lgkmcnt(0)
    s_barrier
    v_mfma_f32_16x16x32_bf16 v[128:131], v[60:63], v[88:91], v[128:131]
    ds_read_b128 v[44:47], v9 offset:0
    v_mfma_f32_16x16x32_bf16 v[132:135], v[60:63], v[92:95], v[132:135]
    ds_read_b128 v[48:51], v9 offset:1024
    v_mfma_f32_16x16x32_bf16 v[148:151], v[64:67], v[92:95], v[148:151]
    ds_read_b128 v[52:55], v9 offset:2048
    v_mfma_f32_16x16x32_bf16 v[144:147], v[64:67], v[88:91], v[144:147]
    ds_read_b128 v[56:59], v9 offset:3072
    v_mfma_f32_16x16x32_bf16 v[160:163], v[68:71], v[88:91], v[160:163]
    ds_read_b64_tr_b16 v[16:17], v4 offset:0
    v_mfma_f32_16x16x32_bf16 v[164:167], v[68:71], v[92:95], v[164:167]
    ds_read_b64_tr_b16 v[18:19], v4 offset:512
    v_mfma_f32_16x16x32_bf16 v[180:183], v[72:75], v[92:95], v[180:183]
    ds_read_b64_tr_b16 v[20:21], v5 offset:0
    v_mfma_f32_16x16x32_bf16 v[176:179], v[72:75], v[88:91], v[176:179]
    ds_read_b64_tr_b16 v[22:23], v5 offset:512
    v_mfma_f32_16x16x32_bf16 v[192:195], v[76:79], v[88:91], v[192:195]
    ds_read_b64_tr_b16 v[24:25], v6 offset:0
    v_mfma_f32_16x16x32_bf16 v[196:199], v[76:79], v[92:95], v[196:199]
    v_mfma_f32_16x16x32_bf16 v[212:215], v[80:83], v[92:95], v[212:215]
    ds_read_b64_tr_b16 v[26:27], v6 offset:512
    v_mfma_f32_16x16x32_bf16 v[208:211], v[80:83], v[88:91], v[208:211]
    ds_read_b64_tr_b16 v[28:29], v7 offset:0
    v_mfma_f32_16x16x32_bf16 v[224:227], v[84:87], v[88:91], v[224:227]
    ds_read_b64_tr_b16 v[30:31], v7 offset:512
    v_mfma_f32_16x16x32_bf16 v[228:231], v[84:87], v[92:95], v[228:231]
    ds_read_b64_tr_b16 v[32:33], v4 offset:8192
    v_mfma_f32_16x16x32_bf16 v[232:235], v[84:87], v[96:99], v[232:235]
    ds_read_b64_tr_b16 v[34:35], v4 offset:8704
    v_mfma_f32_16x16x32_bf16 v[236:239], v[84:87], v[100:103], v[236:239]
    ds_read_b64_tr_b16 v[36:37], v5 offset:8192
    v_mfma_f32_16x16x32_bf16 v[220:223], v[80:83], v[100:103], v[220:223]
    ds_read_b64_tr_b16 v[38:39], v5 offset:8704
    v_mfma_f32_16x16x32_bf16 v[216:219], v[80:83], v[96:99], v[216:219]
    ds_read_b64_tr_b16 v[40:41], v8 offset:0
    v_mfma_f32_16x16x32_bf16 v[200:203], v[76:79], v[96:99], v[200:203]
    ds_read_b64_tr_b16 v[42:43], v8 offset:512
    v_mfma_f32_16x16x32_bf16 v[204:207], v[76:79], v[100:103], v[204:207]
    v_mfma_f32_16x16x32_bf16 v[188:191], v[72:75], v[100:103], v[188:191]
    v_mfma_f32_16x16x32_bf16 v[184:187], v[72:75], v[96:99], v[184:187]
    v_mfma_f32_16x16x32_bf16 v[168:171], v[68:71], v[96:99], v[168:171]
    v_mfma_f32_16x16x32_bf16 v[172:175], v[68:71], v[100:103], v[172:175]
    v_mfma_f32_16x16x32_bf16 v[156:159], v[64:67], v[100:103], v[156:159]
    v_mfma_f32_16x16x32_bf16 v[152:155], v[64:67], v[96:99], v[152:155]
    v_mfma_f32_16x16x32_bf16 v[136:139], v[60:63], v[96:99], v[136:139]
    v_mfma_f32_16x16x32_bf16 v[140:143], v[60:63], v[100:103], v[140:143]
    s_nop 0
    s_waitcnt lgkmcnt(0)
    v_mfma_f32_16x16x32_bf16 v[128:131], v[16:19], v[44:47], v[128:131]
    ds_read_b128 v[88:91], v9 offset:8192
    v_mfma_f32_16x16x32_bf16 v[132:135], v[16:19], v[48:51], v[132:135]
    ds_read_b128 v[92:95], v9 offset:9216
    v_mfma_f32_16x16x32_bf16 v[148:151], v[20:23], v[48:51], v[148:151]
    ds_read_b128 v[96:99], v9 offset:10240
    v_mfma_f32_16x16x32_bf16 v[144:147], v[20:23], v[44:47], v[144:147]
    ds_read_b128 v[100:103], v9 offset:11264
    v_mfma_f32_16x16x32_bf16 v[160:163], v[24:27], v[44:47], v[160:163]
    ds_read_b64_tr_b16 v[60:61], v4 offset:4096
    v_mfma_f32_16x16x32_bf16 v[164:167], v[24:27], v[48:51], v[164:167]
    ds_read_b64_tr_b16 v[62:63], v4 offset:4608
    v_mfma_f32_16x16x32_bf16 v[180:183], v[28:31], v[48:51], v[180:183]
    ds_read_b64_tr_b16 v[64:65], v5 offset:4096
    v_mfma_f32_16x16x32_bf16 v[176:179], v[28:31], v[44:47], v[176:179]
    ds_read_b64_tr_b16 v[66:67], v5 offset:4608
    v_mfma_f32_16x16x32_bf16 v[192:195], v[32:35], v[44:47], v[192:195]
    ds_read_b64_tr_b16 v[68:69], v6 offset:4096
    v_mfma_f32_16x16x32_bf16 v[196:199], v[32:35], v[48:51], v[196:199]
    ds_read_b64_tr_b16 v[70:71], v6 offset:4608
    v_mfma_f32_16x16x32_bf16 v[212:215], v[36:39], v[48:51], v[212:215]
    ds_read_b64_tr_b16 v[72:73], v7 offset:4096
    v_mfma_f32_16x16x32_bf16 v[208:211], v[36:39], v[44:47], v[208:211]
    ds_read_b64_tr_b16 v[74:75], v7 offset:4608
    v_mfma_f32_16x16x32_bf16 v[224:227], v[40:43], v[44:47], v[224:227]
    ds_read_b64_tr_b16 v[76:77], v4 offset:12288
    v_mfma_f32_16x16x32_bf16 v[228:231], v[40:43], v[48:51], v[228:231]
    ds_read_b64_tr_b16 v[78:79], v4 offset:12800
    v_mfma_f32_16x16x32_bf16 v[232:235], v[40:43], v[52:55], v[232:235]
    ds_read_b64_tr_b16 v[80:81], v5 offset:12288
    v_mfma_f32_16x16x32_bf16 v[236:239], v[40:43], v[56:59], v[236:239]
    ds_read_b64_tr_b16 v[82:83], v5 offset:12800
    v_mfma_f32_16x16x32_bf16 v[220:223], v[36:39], v[56:59], v[220:223]
    ds_read_b64_tr_b16 v[84:85], v8 offset:4096
    v_mfma_f32_16x16x32_bf16 v[216:219], v[36:39], v[52:55], v[216:219]
    ds_read_b64_tr_b16 v[86:87], v8 offset:4608
    v_mfma_f32_16x16x32_bf16 v[200:203], v[32:35], v[52:55], v[200:203]
    s_add_u32 s24, s24, 49152
    v_mfma_f32_16x16x32_bf16 v[204:207], v[32:35], v[56:59], v[204:207]
    s_cmp_eq_u32 s24, 147456
    v_mfma_f32_16x16x32_bf16 v[188:191], v[28:31], v[56:59], v[188:191]
    s_cselect_b32 s24, 0, s24
    v_mfma_f32_16x16x32_bf16 v[184:187], v[28:31], v[52:55], v[184:187]
    v_add_u32 v4, s24, v10
    v_mfma_f32_16x16x32_bf16 v[168:171], v[24:27], v[52:55], v[168:171]
    v_add_u32_e64 v5, s24, v11
    v_mfma_f32_16x16x32_bf16 v[172:175], v[24:27], v[56:59], v[172:175]
    v_add_u32_e64 v6, s24, v12
    v_mfma_f32_16x16x32_bf16 v[156:159], v[20:23], v[56:59], v[156:159]
    v_add_u32_e64 v7, s24, v13
    v_mfma_f32_16x16x32_bf16 v[152:155], v[20:23], v[52:55], v[152:155]
    v_add_u32_e64 v8, s24, v14
    v_mfma_f32_16x16x32_bf16 v[136:139], v[16:19], v[52:55], v[136:139]
    v_add_u32_e64 v9, s24, v15
    v_mfma_f32_16x16x32_bf16 v[140:143], v[16:19], v[56:59], v[140:143]
    s_waitcnt lgkmcnt(0)
    s_barrier
    v_mfma_f32_16x16x32_bf16 v[128:131], v[60:63], v[88:91], v[128:131]
    ds_read_b128 v[44:47], v9 offset:0
    v_mfma_f32_16x16x32_bf16 v[132:135], v[60:63], v[92:95], v[132:135]
    ds_read_b128 v[48:51], v9 offset:1024
    v_mfma_f32_16x16x32_bf16 v[148:151], v[64:67], v[92:95], v[148:151]
    ds_read_b128 v[52:55], v9 offset:2048
    v_mfma_f32_16x16x32_bf16 v[144:147], v[64:67], v[88:91], v[144:147]
    ds_read_b128 v[56:59], v9 offset:3072
    v_mfma_f32_16x16x32_bf16 v[160:163], v[68:71], v[88:91], v[160:163]
    ds_read_b64_tr_b16 v[16:17], v4 offset:0
    v_mfma_f32_16x16x32_bf16 v[164:167], v[68:71], v[92:95], v[164:167]
    ds_read_b64_tr_b16 v[18:19], v4 offset:512
    v_mfma_f32_16x16x32_bf16 v[180:183], v[72:75], v[92:95], v[180:183]
    ds_read_b64_tr_b16 v[20:21], v5 offset:0
    v_mfma_f32_16x16x32_bf16 v[176:179], v[72:75], v[88:91], v[176:179]
    ds_read_b64_tr_b16 v[22:23], v5 offset:512
    v_mfma_f32_16x16x32_bf16 v[192:195], v[76:79], v[88:91], v[192:195]
    ds_read_b64_tr_b16 v[24:25], v6 offset:0
    v_mfma_f32_16x16x32_bf16 v[196:199], v[76:79], v[92:95], v[196:199]
    v_mfma_f32_16x16x32_bf16 v[212:215], v[80:83], v[92:95], v[212:215]
    ds_read_b64_tr_b16 v[26:27], v6 offset:512
    v_mfma_f32_16x16x32_bf16 v[208:211], v[80:83], v[88:91], v[208:211]
    ds_read_b64_tr_b16 v[28:29], v7 offset:0
    v_mfma_f32_16x16x32_bf16 v[224:227], v[84:87], v[88:91], v[224:227]
    ds_read_b64_tr_b16 v[30:31], v7 offset:512
    v_mfma_f32_16x16x32_bf16 v[228:231], v[84:87], v[92:95], v[228:231]
    ds_read_b64_tr_b16 v[32:33], v4 offset:8192
    v_mfma_f32_16x16x32_bf16 v[232:235], v[84:87], v[96:99], v[232:235]
    ds_read_b64_tr_b16 v[34:35], v4 offset:8704
    v_mfma_f32_16x16x32_bf16 v[236:239], v[84:87], v[100:103], v[236:239]
    ds_read_b64_tr_b16 v[36:37], v5 offset:8192
    v_mfma_f32_16x16x32_bf16 v[220:223], v[80:83], v[100:103], v[220:223]
    ds_read_b64_tr_b16 v[38:39], v5 offset:8704
    v_mfma_f32_16x16x32_bf16 v[216:219], v[80:83], v[96:99], v[216:219]
    ds_read_b64_tr_b16 v[40:41], v8 offset:0
    v_mfma_f32_16x16x32_bf16 v[200:203], v[76:79], v[96:99], v[200:203]
    ds_read_b64_tr_b16 v[42:43], v8 offset:512
    v_mfma_f32_16x16x32_bf16 v[204:207], v[76:79], v[100:103], v[204:207]
    v_mfma_f32_16x16x32_bf16 v[188:191], v[72:75], v[100:103], v[188:191]
    v_mfma_f32_16x16x32_bf16 v[184:187], v[72:75], v[96:99], v[184:187]
    v_mfma_f32_16x16x32_bf16 v[168:171], v[68:71], v[96:99], v[168:171]
    v_mfma_f32_16x16x32_bf16 v[172:175], v[68:71], v[100:103], v[172:175]
    v_mfma_f32_16x16x32_bf16 v[156:159], v[64:67], v[100:103], v[156:159]
    v_mfma_f32_16x16x32_bf16 v[152:155], v[64:67], v[96:99], v[152:155]
    v_mfma_f32_16x16x32_bf16 v[136:139], v[60:63], v[96:99], v[136:139]
    v_mfma_f32_16x16x32_bf16 v[140:143], v[60:63], v[100:103], v[140:143]
    s_waitcnt lgkmcnt(0)
    s_sub_u32 s23, s23, 1
    s_cmp_lg_u32 s23, 0
    s_cbranch_scc1 M1_CL
    v_mfma_f32_16x16x32_bf16 v[128:131], v[16:19], v[44:47], v[128:131]
    ds_read_b128 v[88:91], v9 offset:8192
    v_mfma_f32_16x16x32_bf16 v[132:135], v[16:19], v[48:51], v[132:135]
    ds_read_b128 v[92:95], v9 offset:9216
    v_mfma_f32_16x16x32_bf16 v[148:151], v[20:23], v[48:51], v[148:151]
    ds_read_b128 v[96:99], v9 offset:10240
    v_mfma_f32_16x16x32_bf16 v[144:147], v[20:23], v[44:47], v[144:147]
    ds_read_b128 v[100:103], v9 offset:11264
    v_mfma_f32_16x16x32_bf16 v[160:163], v[24:27], v[44:47], v[160:163]
    ds_read_b64_tr_b16 v[60:61], v4 offset:4096
    v_mfma_f32_16x16x32_bf16 v[164:167], v[24:27], v[48:51], v[164:167]
    ds_read_b64_tr_b16 v[62:63], v4 offset:4608
    v_mfma_f32_16x16x32_bf16 v[180:183], v[28:31], v[48:51], v[180:183]
    ds_read_b64_tr_b16 v[64:65], v5 offset:4096
    v_mfma_f32_16x16x32_bf16 v[176:179], v[28:31], v[44:47], v[176:179]
    ds_read_b64_tr_b16 v[66:67], v5 offset:4608
    v_mfma_f32_16x16x32_bf16 v[192:195], v[32:35], v[44:47], v[192:195]
    ds_read_b64_tr_b16 v[68:69], v6 offset:4096
    v_mfma_f32_16x16x32_bf16 v[196:199], v[32:35], v[48:51], v[196:199]
    ds_read_b64_tr_b16 v[70:71], v6 offset:4608
    v_mfma_f32_16x16x32_bf16 v[212:215], v[36:39], v[48:51], v[212:215]
    ds_read_b64_tr_b16 v[72:73], v7 offset:4096
    v_mfma_f32_16x16x32_bf16 v[208:211], v[36:39], v[44:47], v[208:211]
    ds_read_b64_tr_b16 v[74:75], v7 offset:4608
    v_mfma_f32_16x16x32_bf16 v[224:227], v[40:43], v[44:47], v[224:227]
    ds_read_b64_tr_b16 v[76:77], v4 offset:12288
    v_mfma_f32_16x16x32_bf16 v[228:231], v[40:43], v[48:51], v[228:231]
    ds_read_b64_tr_b16 v[78:79], v4 offset:12800
    v_mfma_f32_16x16x32_bf16 v[232:235], v[40:43], v[52:55], v[232:235]
    ds_read_b64_tr_b16 v[80:81], v5 offset:12288
    v_mfma_f32_16x16x32_bf16 v[236:239], v[40:43], v[56:59], v[236:239]
    ds_read_b64_tr_b16 v[82:83], v5 offset:12800
    v_mfma_f32_16x16x32_bf16 v[220:223], v[36:39], v[56:59], v[220:223]
    ds_read_b64_tr_b16 v[84:85], v8 offset:4096
    v_mfma_f32_16x16x32_bf16 v[216:219], v[36:39], v[52:55], v[216:219]
    ds_read_b64_tr_b16 v[86:87], v8 offset:4608
    v_mfma_f32_16x16x32_bf16 v[200:203], v[32:35], v[52:55], v[200:203]
    s_add_u32 s24, s24, 49152
    v_mfma_f32_16x16x32_bf16 v[204:207], v[32:35], v[56:59], v[204:207]
    s_cmp_eq_u32 s24, 147456
    v_mfma_f32_16x16x32_bf16 v[188:191], v[28:31], v[56:59], v[188:191]
    s_cselect_b32 s24, 0, s24
    v_mfma_f32_16x16x32_bf16 v[184:187], v[28:31], v[52:55], v[184:187]
    v_add_u32 v4, s24, v10
    v_mfma_f32_16x16x32_bf16 v[168:171], v[24:27], v[52:55], v[168:171]
    v_add_u32_e64 v5, s24, v11
    v_mfma_f32_16x16x32_bf16 v[172:175], v[24:27], v[56:59], v[172:175]
    v_add_u32_e64 v6, s24, v12
    v_mfma_f32_16x16x32_bf16 v[156:159], v[20:23], v[56:59], v[156:159]
    v_add_u32_e64 v7, s24, v13
    v_mfma_f32_16x16x32_bf16 v[152:155], v[20:23], v[52:55], v[152:155]
    v_add_u32_e64 v8, s24, v14
    v_mfma_f32_16x16x32_bf16 v[136:139], v[16:19], v[52:55], v[136:139]
    v_add_u32_e64 v9, s24, v15
    v_mfma_f32_16x16x32_bf16 v[140:143], v[16:19], v[56:59], v[140:143]
    s_waitcnt lgkmcnt(0)
    s_barrier
    v_mfma_f32_16x16x32_bf16 v[128:131], v[60:63], v[88:91], v[128:131]
    ds_read_b128 v[44:47], v9 offset:0
    v_mfma_f32_16x16x32_bf16 v[132:135], v[60:63], v[92:95], v[132:135]
    ds_read_b128 v[48:51], v9 offset:1024
    v_mfma_f32_16x16x32_bf16 v[148:151], v[64:67], v[92:95], v[148:151]
    ds_read_b128 v[52:55], v9 offset:2048
    v_mfma_f32_16x16x32_bf16 v[144:147], v[64:67], v[88:91], v[144:147]
    ds_read_b128 v[56:59], v9 offset:3072
    v_mfma_f32_16x16x32_bf16 v[160:163], v[68:71], v[88:91], v[160:163]
    ds_read_b64_tr_b16 v[16:17], v4 offset:0
    v_mfma_f32_16x16x32_bf16 v[164:167], v[68:71], v[92:95], v[164:167]
    ds_read_b64_tr_b16 v[18:19], v4 offset:512
    v_mfma_f32_16x16x32_bf16 v[180:183], v[72:75], v[92:95], v[180:183]
    ds_read_b64_tr_b16 v[20:21], v5 offset:0
    v_mfma_f32_16x16x32_bf16 v[176:179], v[72:75], v[88:91], v[176:179]
    ds_read_b64_tr_b16 v[22:23], v5 offset:512
    v_mfma_f32_16x16x32_bf16 v[192:195], v[76:79], v[88:91], v[192:195]
    ds_read_b64_tr_b16 v[24:25], v6 offset:0
    v_mfma_f32_16x16x32_bf16 v[196:199], v[76:79], v[92:95], v[196:199]
    v_mfma_f32_16x16x32_bf16 v[212:215], v[80:83], v[92:95], v[212:215]
    ds_read_b64_tr_b16 v[26:27], v6 offset:512
    v_mfma_f32_16x16x32_bf16 v[208:211], v[80:83], v[88:91], v[208:211]
    ds_read_b64_tr_b16 v[28:29], v7 offset:0
    v_mfma_f32_16x16x32_bf16 v[224:227], v[84:87], v[88:91], v[224:227]
    ds_read_b64_tr_b16 v[30:31], v7 offset:512
    v_mfma_f32_16x16x32_bf16 v[228:231], v[84:87], v[92:95], v[228:231]
    ds_read_b64_tr_b16 v[32:33], v4 offset:8192
    v_mfma_f32_16x16x32_bf16 v[232:235], v[84:87], v[96:99], v[232:235]
    ds_read_b64_tr_b16 v[34:35], v4 offset:8704
    v_mfma_f32_16x16x32_bf16 v[236:239], v[84:87], v[100:103], v[236:239]
    ds_read_b64_tr_b16 v[36:37], v5 offset:8192
    v_mfma_f32_16x16x32_bf16 v[220:223], v[80:83], v[100:103], v[220:223]
    ds_read_b64_tr_b16 v[38:39], v5 offset:8704
    v_mfma_f32_16x16x32_bf16 v[216:219], v[80:83], v[96:99], v[216:219]
    ds_read_b64_tr_b16 v[40:41], v8 offset:0
    v_mfma_f32_16x16x32_bf16 v[200:203], v[76:79], v[96:99], v[200:203]
    ds_read_b64_tr_b16 v[42:43], v8 offset:512
    v_mfma_f32_16x16x32_bf16 v[204:207], v[76:79], v[100:103], v[204:207]
    v_mfma_f32_16x16x32_bf16 v[188:191], v[72:75], v[100:103], v[188:191]
    v_mfma_f32_16x16x32_bf16 v[184:187], v[72:75], v[96:99], v[184:187]
    v_mfma_f32_16x16x32_bf16 v[168:171], v[68:71], v[96:99], v[168:171]
    v_mfma_f32_16x16x32_bf16 v[172:175], v[68:71], v[100:103], v[172:175]
    v_mfma_f32_16x16x32_bf16 v[156:159], v[64:67], v[100:103], v[156:159]
    v_mfma_f32_16x16x32_bf16 v[152:155], v[64:67], v[96:99], v[152:155]
    v_mfma_f32_16x16x32_bf16 v[136:139], v[60:63], v[96:99], v[136:139]
    v_mfma_f32_16x16x32_bf16 v[140:143], v[60:63], v[100:103], v[140:143]
    s_nop 0
    s_waitcnt lgkmcnt(0)
    v_mfma_f32_16x16x32_bf16 v[128:131], v[16:19], v[44:47], v[128:131]
    ds_read_b128 v[88:91], v9 offset:8192
    v_mfma_f32_16x16x32_bf16 v[132:135], v[16:19], v[48:51], v[132:135]
    ds_read_b128 v[92:95], v9 offset:9216
    v_mfma_f32_16x16x32_bf16 v[148:151], v[20:23], v[48:51], v[148:151]
    ds_read_b128 v[96:99], v9 offset:10240
    v_mfma_f32_16x16x32_bf16 v[144:147], v[20:23], v[44:47], v[144:147]
    ds_read_b128 v[100:103], v9 offset:11264
    v_mfma_f32_16x16x32_bf16 v[160:163], v[24:27], v[44:47], v[160:163]
    ds_read_b64_tr_b16 v[60:61], v4 offset:4096
    v_mfma_f32_16x16x32_bf16 v[164:167], v[24:27], v[48:51], v[164:167]
    ds_read_b64_tr_b16 v[62:63], v4 offset:4608
    v_mfma_f32_16x16x32_bf16 v[180:183], v[28:31], v[48:51], v[180:183]
    ds_read_b64_tr_b16 v[64:65], v5 offset:4096
    v_mfma_f32_16x16x32_bf16 v[176:179], v[28:31], v[44:47], v[176:179]
    ds_read_b64_tr_b16 v[66:67], v5 offset:4608
    v_mfma_f32_16x16x32_bf16 v[192:195], v[32:35], v[44:47], v[192:195]
    ds_read_b64_tr_b16 v[68:69], v6 offset:4096
    v_mfma_f32_16x16x32_bf16 v[196:199], v[32:35], v[48:51], v[196:199]
    v_mfma_f32_16x16x32_bf16 v[212:215], v[36:39], v[48:51], v[212:215]
    ds_read_b64_tr_b16 v[70:71], v6 offset:4608
    v_mfma_f32_16x16x32_bf16 v[208:211], v[36:39], v[44:47], v[208:211]
    ds_read_b64_tr_b16 v[72:73], v7 offset:4096
    v_mfma_f32_16x16x32_bf16 v[224:227], v[40:43], v[44:47], v[224:227]
    ds_read_b64_tr_b16 v[74:75], v7 offset:4608
    v_mfma_f32_16x16x32_bf16 v[228:231], v[40:43], v[48:51], v[228:231]
    ds_read_b64_tr_b16 v[76:77], v4 offset:12288
    v_mfma_f32_16x16x32_bf16 v[232:235], v[40:43], v[52:55], v[232:235]
    ds_read_b64_tr_b16 v[78:79], v4 offset:12800
    v_mfma_f32_16x16x32_bf16 v[236:239], v[40:43], v[56:59], v[236:239]
    ds_read_b64_tr_b16 v[80:81], v5 offset:12288
    v_mfma_f32_16x16x32_bf16 v[220:223], v[36:39], v[56:59], v[220:223]
    ds_read_b64_tr_b16 v[82:83], v5 offset:12800
    v_mfma_f32_16x16x32_bf16 v[216:219], v[36:39], v[52:55], v[216:219]
    ds_read_b64_tr_b16 v[84:85], v8 offset:4096
    v_mfma_f32_16x16x32_bf16 v[200:203], v[32:35], v[52:55], v[200:203]
    ds_read_b64_tr_b16 v[86:87], v8 offset:4608
    v_mfma_f32_16x16x32_bf16 v[204:207], v[32:35], v[56:59], v[204:207]
    v_mfma_f32_16x16x32_bf16 v[188:191], v[28:31], v[56:59], v[188:191]
    v_mfma_f32_16x16x32_bf16 v[184:187], v[28:31], v[52:55], v[184:187]
    v_mfma_f32_16x16x32_bf16 v[168:171], v[24:27], v[52:55], v[168:171]
    v_mfma_f32_16x16x32_bf16 v[172:175], v[24:27], v[56:59], v[172:175]
    v_mfma_f32_16x16x32_bf16 v[156:159], v[20:23], v[56:59], v[156:159]
    v_mfma_f32_16x16x32_bf16 v[152:155], v[20:23], v[52:55], v[152:155]
    v_mfma_f32_16x16x32_bf16 v[136:139], v[16:19], v[52:55], v[136:139]
    v_mfma_f32_16x16x32_bf16 v[140:143], v[16:19], v[56:59], v[140:143]
    s_waitcnt lgkmcnt(0)
    s_barrier
    v_mfma_f32_16x16x32_bf16 v[128:131], v[60:63], v[88:91], v[128:131]
    v_mfma_f32_16x16x32_bf16 v[132:135], v[60:63], v[92:95], v[132:135]
    v_mfma_f32_16x16x32_bf16 v[148:151], v[64:67], v[92:95], v[148:151]
    v_mfma_f32_16x16x32_bf16 v[144:147], v[64:67], v[88:91], v[144:147]
    v_mfma_f32_16x16x32_bf16 v[160:163], v[68:71], v[88:91], v[160:163]
    v_mfma_f32_16x16x32_bf16 v[164:167], v[68:71], v[92:95], v[164:167]
    v_mfma_f32_16x16x32_bf16 v[180:183], v[72:75], v[92:95], v[180:183]
    v_mfma_f32_16x16x32_bf16 v[176:179], v[72:75], v[88:91], v[176:179]
    v_mfma_f32_16x16x32_bf16 v[192:195], v[76:79], v[88:91], v[192:195]
    v_mfma_f32_16x16x32_bf16 v[196:199], v[76:79], v[92:95], v[196:199]
    v_mfma_f32_16x16x32_bf16 v[212:215], v[80:83], v[92:95], v[212:215]
    v_mfma_f32_16x16x32_bf16 v[208:211], v[80:83], v[88:91], v[208:211]
    v_mfma_f32_16x16x32_bf16 v[224:227], v[84:87], v[88:91], v[224:227]
    v_mfma_f32_16x16x32_bf16 v[228:231], v[84:87], v[92:95], v[228:231]
    v_mfma_f32_16x16x32_bf16 v[232:235], v[84:87], v[96:99], v[232:235]
    v_mfma_f32_16x16x32_bf16 v[236:239], v[84:87], v[100:103], v[236:239]
    v_mfma_f32_16x16x32_bf16 v[220:223], v[80:83], v[100:103], v[220:223]
    v_mfma_f32_16x16x32_bf16 v[216:219], v[80:83], v[96:99], v[216:219]
    v_mfma_f32_16x16x32_bf16 v[200:203], v[76:79], v[96:99], v[200:203]
    v_mfma_f32_16x16x32_bf16 v[204:207], v[76:79], v[100:103], v[204:207]
    v_mfma_f32_16x16x32_bf16 v[188:191], v[72:75], v[100:103], v[188:191]
    v_mfma_f32_16x16x32_bf16 v[184:187], v[72:75], v[96:99], v[184:187]
    v_mfma_f32_16x16x32_bf16 v[168:171], v[68:71], v[96:99], v[168:171]
    v_mfma_f32_16x16x32_bf16 v[172:175], v[68:71], v[100:103], v[172:175]
    v_mfma_f32_16x16x32_bf16 v[156:159], v[64:67], v[100:103], v[156:159]
    v_mfma_f32_16x16x32_bf16 v[152:155], v[64:67], v[96:99], v[152:155]
    v_mfma_f32_16x16x32_bf16 v[136:139], v[60:63], v[96:99], v[136:139]
    v_mfma_f32_16x16x32_bf16 v[140:143], v[60:63], v[100:103], v[140:143]
    v_mov_b32 v4, 0xc0135761
    v_mov_b32 v5, 0xc0135761
    v_mov_b32 v6, 0xbdd2d3e8
    v_mov_b32 v7, 0xbdd2d3e8
    s_mul_i32 s32, s21, 917504
    s_lshl_b32 s33, s28, 12
    s_add_u32 s32, s32, s33
    s_add_u32 s32, s32, 4194304
    s_lshr_b32 s33, s30, 1
    s_lshl_b32 s33, s33, 13
    s_add_u32 s33, s33, s32
    s_lshr_b32 s34, s31, 1
    s_lshl_b32 s34, s34, 13
    s_add_u32 s34, s34, s32
    s_lshl_b32 s35, s27, 9
    s_add_u32 s34, s34, s35
    v_lshlrev_b32 v8, 4, v1
    v_lshrrev_b32 v11, 1, v3
    v_lshlrev_b32_e64 v11, 8, v11
    v_lshl_add_u32 v11, v2, 4, v11
    v_and_b32_e64 v12, 1, v3
    v_lshl_add_u32 v11, v12, 3, v11
    s_nop 0
    s_lshl_b32 s35, s22, 2
    s_add_u32 s35, s35, s20
    s_lshl_b32 s35, s35, 7
    s_lshl_b32 s36, s21, 13
    s_add_u32 s35, s35, s36
    s_add_u32 s35, s35, 18350080
    s_add_u32 s36, s35, 65536
    s_mov_b32 s60, 17039360
    buffer_load_dword v116, v124, s[12:15], s60 offen offset:0 sc1
    buffer_load_dword v117, v124, s[12:15], s60 offen offset:64 sc1
    buffer_load_dword v118, v124, s[12:15], s60 offen offset:128 sc1
    buffer_load_dword v119, v124, s[12:15], s60 offen offset:192 sc1
    v_pk_mul_f32 v[16:17], v[128:129], v[128:129]
    v_pk_mul_f32 v[18:19], v[130:131], v[130:131]
    v_pk_mul_f32 v[20:21], v[144:145], v[144:145]
    v_pk_mul_f32 v[22:23], v[146:147], v[146:147]
    v_pk_mul_f32 v[24:25], v[132:133], v[132:133]
    v_pk_mul_f32 v[26:27], v[134:135], v[134:135]
    v_pk_mul_f32 v[28:29], v[148:149], v[148:149]
    v_pk_mul_f32 v[30:31], v[150:151], v[150:151]
    v_pk_fma_f32 v[16:17], v[16:17], v[6:7], v[4:5]
    v_pk_fma_f32 v[18:19], v[18:19], v[6:7], v[4:5]
    v_pk_fma_f32 v[20:21], v[20:21], v[6:7], v[4:5]
    v_pk_fma_f32 v[22:23], v[22:23], v[6:7], v[4:5]
    v_pk_fma_f32 v[24:25], v[24:25], v[6:7], v[4:5]
    v_pk_fma_f32 v[26:27], v[26:27], v[6:7], v[4:5]
    v_pk_fma_f32 v[28:29], v[28:29], v[6:7], v[4:5]
    v_pk_fma_f32 v[30:31], v[30:31], v[6:7], v[4:5]
    v_pk_mul_f32 v[16:17], v[16:17], v[128:129]
    v_pk_mul_f32 v[18:19], v[18:19], v[130:131]
    v_pk_mul_f32 v[20:21], v[20:21], v[144:145]
    v_pk_mul_f32 v[22:23], v[22:23], v[146:147]
    v_pk_mul_f32 v[24:25], v[24:25], v[132:133]
    v_pk_mul_f32 v[26:27], v[26:27], v[134:135]
    v_pk_mul_f32 v[28:29], v[28:29], v[148:149]
    v_pk_mul_f32 v[30:31], v[30:31], v[150:151]
    v_exp_f32 v16, v16
    v_exp_f32 v17, v17
    v_exp_f32 v18, v18
    v_exp_f32 v19, v19
    v_exp_f32 v20, v20
    v_exp_f32 v21, v21
    v_exp_f32 v22, v22
    v_exp_f32 v23, v23
    v_exp_f32 v24, v24
    v_exp_f32 v25, v25
    v_exp_f32 v26, v26
    v_exp_f32 v27, v27
    v_exp_f32 v28, v28
    v_exp_f32 v29, v29
    v_exp_f32 v30, v30
    v_exp_f32 v31, v31
    v_pk_add_f32 v[16:17], v[16:17], 1.0 op_sel_hi:[1,0]
    v_pk_add_f32 v[18:19], v[18:19], 1.0 op_sel_hi:[1,0]
    v_pk_add_f32 v[20:21], v[20:21], 1.0 op_sel_hi:[1,0]
    v_pk_add_f32 v[22:23], v[22:23], 1.0 op_sel_hi:[1,0]
    v_pk_add_f32 v[24:25], v[24:25], 1.0 op_sel_hi:[1,0]
    v_pk_add_f32 v[26:27], v[26:27], 1.0 op_sel_hi:[1,0]
    v_pk_add_f32 v[28:29], v[28:29], 1.0 op_sel_hi:[1,0]
    v_pk_add_f32 v[30:31], v[30:31], 1.0 op_sel_hi:[1,0]
    v_rcp_f32 v16, v16
    v_rcp_f32 v17, v17
    v_rcp_f32 v18, v18
    v_rcp_f32 v19, v19
    v_rcp_f32 v20, v20
    v_rcp_f32 v21, v21
    v_rcp_f32 v22, v22
    v_rcp_f32 v23, v23
    v_rcp_f32 v24, v24
    v_rcp_f32 v25, v25
    v_rcp_f32 v26, v26
    v_rcp_f32 v27, v27
    v_rcp_f32 v28, v28
    v_rcp_f32 v29, v29
    v_rcp_f32 v30, v30
    v_rcp_f32 v31, v31
    v_pk_mul_f32 v[16:17], v[16:17], v[128:129]
    v_pk_mul_f32 v[18:19], v[18:19], v[130:131]
    v_pk_mul_f32 v[20:21], v[20:21], v[144:145]
    v_pk_mul_f32 v[22:23], v[22:23], v[146:147]
    v_pk_mul_f32 v[24:25], v[24:25], v[132:133]
    v_pk_mul_f32 v[26:27], v[26:27], v[134:135]
    v_pk_mul_f32 v[28:29], v[28:29], v[148:149]
    v_pk_mul_f32 v[30:31], v[30:31], v[150:151]
    v_cvt_pk_bf16_f32 v48, v16, v17
    v_cvt_pk_bf16_f32 v49, v18, v19
    v_cvt_pk_bf16_f32 v50, v20, v21
    v_cvt_pk_bf16_f32 v51, v22, v23
    v_cvt_pk_bf16_f32 v52, v24, v25
    v_cvt_pk_bf16_f32 v53, v26, v27
    v_cvt_pk_bf16_f32 v54, v28, v29
    v_cvt_pk_bf16_f32 v55, v30, v31
    buffer_store_dwordx4 v[48:51], v8, s[12:15], s33 offen offset:0 sc1
    buffer_store_dwordx4 v[52:55], v8, s[12:15], s33 offen offset:1024 sc1
    v_pk_mul_f32 v[16:17], v[136:137], v[136:137]
    v_pk_mul_f32 v[18:19], v[138:139], v[138:139]
    v_pk_mul_f32 v[20:21], v[152:153], v[152:153]
    v_pk_mul_f32 v[22:23], v[154:155], v[154:155]
    v_pk_mul_f32 v[24:25], v[140:141], v[140:141]
    v_pk_mul_f32 v[26:27], v[142:143], v[142:143]
    v_pk_mul_f32 v[28:29], v[156:157], v[156:157]
    v_pk_mul_f32 v[30:31], v[158:159], v[158:159]
    v_pk_fma_f32 v[16:17], v[16:17], v[6:7], v[4:5]
    v_pk_fma_f32 v[18:19], v[18:19], v[6:7], v[4:5]
    v_pk_fma_f32 v[20:21], v[20:21], v[6:7], v[4:5]
    v_pk_fma_f32 v[22:23], v[22:23], v[6:7], v[4:5]
    v_pk_fma_f32 v[24:25], v[24:25], v[6:7], v[4:5]
    v_pk_fma_f32 v[26:27], v[26:27], v[6:7], v[4:5]
    v_pk_fma_f32 v[28:29], v[28:29], v[6:7], v[4:5]
    v_pk_fma_f32 v[30:31], v[30:31], v[6:7], v[4:5]
    v_pk_mul_f32 v[16:17], v[16:17], v[136:137]
    v_pk_mul_f32 v[18:19], v[18:19], v[138:139]
    v_pk_mul_f32 v[20:21], v[20:21], v[152:153]
    v_pk_mul_f32 v[22:23], v[22:23], v[154:155]
    v_pk_mul_f32 v[24:25], v[24:25], v[140:141]
    v_pk_mul_f32 v[26:27], v[26:27], v[142:143]
    v_pk_mul_f32 v[28:29], v[28:29], v[156:157]
    v_pk_mul_f32 v[30:31], v[30:31], v[158:159]
    v_exp_f32 v16, v16
    v_exp_f32 v17, v17
    v_exp_f32 v18, v18
    v_exp_f32 v19, v19
    v_exp_f32 v20, v20
    v_exp_f32 v21, v21
    v_exp_f32 v22, v22
    v_exp_f32 v23, v23
    v_exp_f32 v24, v24
    v_exp_f32 v25, v25
    v_exp_f32 v26, v26
    v_exp_f32 v27, v27
    v_exp_f32 v28, v28
    v_exp_f32 v29, v29
    v_exp_f32 v30, v30
    v_exp_f32 v31, v31
    v_pk_add_f32 v[16:17], v[16:17], 1.0 op_sel_hi:[1,0]
    v_pk_add_f32 v[18:19], v[18:19], 1.0 op_sel_hi:[1,0]
    v_pk_add_f32 v[20:21], v[20:21], 1.0 op_sel_hi:[1,0]
    v_pk_add_f32 v[22:23], v[22:23], 1.0 op_sel_hi:[1,0]
    v_pk_add_f32 v[24:25], v[24:25], 1.0 op_sel_hi:[1,0]
    v_pk_add_f32 v[26:27], v[26:27], 1.0 op_sel_hi:[1,0]
    v_pk_add_f32 v[28:29], v[28:29], 1.0 op_sel_hi:[1,0]
    v_pk_add_f32 v[30:31], v[30:31], 1.0 op_sel_hi:[1,0]
    v_rcp_f32 v16, v16
    v_rcp_f32 v17, v17
    v_rcp_f32 v18, v18
    v_rcp_f32 v19, v19
    v_rcp_f32 v20, v20
    v_rcp_f32 v21, v21
    v_rcp_f32 v22, v22
    v_rcp_f32 v23, v23
    v_rcp_f32 v24, v24
    v_rcp_f32 v25, v25
    v_rcp_f32 v26, v26
    v_rcp_f32 v27, v27
    v_rcp_f32 v28, v28
    v_rcp_f32 v29, v29
    v_rcp_f32 v30, v30
    v_rcp_f32 v31, v31
    v_pk_mul_f32 v[16:17], v[16:17], v[136:137]
    v_pk_mul_f32 v[18:19], v[18:19], v[138:139]
    v_pk_mul_f32 v[20:21], v[20:21], v[152:153]
    v_pk_mul_f32 v[22:23], v[22:23], v[154:155]
    v_pk_mul_f32 v[24:25], v[24:25], v[140:141]
    v_pk_mul_f32 v[26:27], v[26:27], v[142:143]
    v_pk_mul_f32 v[28:29], v[28:29], v[156:157]
    v_pk_mul_f32 v[30:31], v[30:31], v[158:159]
    v_cvt_pk_bf16_f32 v56, v16, v17
    v_cvt_pk_bf16_f32 v57, v18, v19
    v_cvt_pk_bf16_f32 v58, v20, v21
    v_cvt_pk_bf16_f32 v59, v22, v23
    v_cvt_pk_bf16_f32 v60, v24, v25
    v_cvt_pk_bf16_f32 v61, v26, v27
    v_cvt_pk_bf16_f32 v62, v28, v29
    v_cvt_pk_bf16_f32 v63, v30, v31
    buffer_store_dwordx4 v[56:59], v8, s[12:15], s33 offen offset:2048 sc1
    buffer_store_dwordx4 v[60:63], v8, s[12:15], s33 offen offset:3072 sc1
    s_add_u32 s33, s33, 8192
    v_pk_mul_f32 v[16:17], v[160:161], v[160:161]
    v_pk_mul_f32 v[18:19], v[162:163], v[162:163]
    v_pk_mul_f32 v[20:21], v[176:177], v[176:177]
    v_pk_mul_f32 v[22:23], v[178:179], v[178:179]
    v_pk_mul_f32 v[24:25], v[164:165], v[164:165]
    v_pk_mul_f32 v[26:27], v[166:167], v[166:167]
    v_pk_mul_f32 v[28:29], v[180:181], v[180:181]
    v_pk_mul_f32 v[30:31], v[182:183], v[182:183]
    v_pk_fma_f32 v[16:17], v[16:17], v[6:7], v[4:5]
    v_pk_fma_f32 v[18:19], v[18:19], v[6:7], v[4:5]
    v_pk_fma_f32 v[20:21], v[20:21], v[6:7], v[4:5]
    v_pk_fma_f32 v[22:23], v[22:23], v[6:7], v[4:5]
    v_pk_fma_f32 v[24:25], v[24:25], v[6:7], v[4:5]
    v_pk_fma_f32 v[26:27], v[26:27], v[6:7], v[4:5]
    v_pk_fma_f32 v[28:29], v[28:29], v[6:7], v[4:5]
    v_pk_fma_f32 v[30:31], v[30:31], v[6:7], v[4:5]
    v_pk_mul_f32 v[16:17], v[16:17], v[160:161]
    v_pk_mul_f32 v[18:19], v[18:19], v[162:163]
    v_pk_mul_f32 v[20:21], v[20:21], v[176:177]
    v_pk_mul_f32 v[22:23], v[22:23], v[178:179]
    v_pk_mul_f32 v[24:25], v[24:25], v[164:165]
    v_pk_mul_f32 v[26:27], v[26:27], v[166:167]
    v_pk_mul_f32 v[28:29], v[28:29], v[180:181]
    v_pk_mul_f32 v[30:31], v[30:31], v[182:183]
    v_exp_f32 v16, v16
    v_exp_f32 v17, v17
    v_exp_f32 v18, v18
    v_exp_f32 v19, v19
    v_exp_f32 v20, v20
    v_exp_f32 v21, v21
    v_exp_f32 v22, v22
    v_exp_f32 v23, v23
    v_exp_f32 v24, v24
    v_exp_f32 v25, v25
    v_exp_f32 v26, v26
    v_exp_f32 v27, v27
    v_exp_f32 v28, v28
    v_exp_f32 v29, v29
    v_exp_f32 v30, v30
    v_exp_f32 v31, v31
    v_pk_add_f32 v[16:17], v[16:17], 1.0 op_sel_hi:[1,0]
    v_pk_add_f32 v[18:19], v[18:19], 1.0 op_sel_hi:[1,0]
    v_pk_add_f32 v[20:21], v[20:21], 1.0 op_sel_hi:[1,0]
    v_pk_add_f32 v[22:23], v[22:23], 1.0 op_sel_hi:[1,0]
    v_pk_add_f32 v[24:25], v[24:25], 1.0 op_sel_hi:[1,0]
    v_pk_add_f32 v[26:27], v[26:27], 1.0 op_sel_hi:[1,0]
    v_pk_add_f32 v[28:29], v[28:29], 1.0 op_sel_hi:[1,0]
    v_pk_add_f32 v[30:31], v[30:31], 1.0 op_sel_hi:[1,0]
    v_rcp_f32 v16, v16
    v_rcp_f32 v17, v17
    v_rcp_f32 v18, v18
    v_rcp_f32 v19, v19
    v_rcp_f32 v20, v20
    v_rcp_f32 v21, v21
    v_rcp_f32 v22, v22
    v_rcp_f32 v23, v23
    v_rcp_f32 v24, v24
    v_rcp_f32 v25, v25
    v_rcp_f32 v26, v26
    v_rcp_f32 v27, v27
    v_rcp_f32 v28, v28
    v_rcp_f32 v29, v29
    v_rcp_f32 v30, v30
    v_rcp_f32 v31, v31
    v_pk_mul_f32 v[16:17], v[16:17], v[160:161]
    v_pk_mul_f32 v[18:19], v[18:19], v[162:163]
    v_pk_mul_f32 v[20:21], v[20:21], v[176:177]
    v_pk_mul_f32 v[22:23], v[22:23], v[178:179]
    v_pk_mul_f32 v[24:25], v[24:25], v[164:165]
    v_pk_mul_f32 v[26:27], v[26:27], v[166:167]
    v_pk_mul_f32 v[28:29], v[28:29], v[180:181]
    v_pk_mul_f32 v[30:31], v[30:31], v[182:183]
    v_cvt_pk_bf16_f32 v64, v16, v17
    v_cvt_pk_bf16_f32 v65, v18, v19
    v_cvt_pk_bf16_f32 v66, v20, v21
    v_cvt_pk_bf16_f32 v67, v22, v23
    v_cvt_pk_bf16_f32 v68, v24, v25
    v_cvt_pk_bf16_f32 v69, v26, v27
    v_cvt_pk_bf16_f32 v70, v28, v29
    v_cvt_pk_bf16_f32 v71, v30, v31
    buffer_store_dwordx4 v[64:67], v8, s[12:15], s33 offen offset:0 sc1
    buffer_store_dwordx4 v[68:71], v8, s[12:15], s33 offen offset:1024 sc1
    v_pk_mul_f32 v[16:17], v[168:169], v[168:169]
    v_pk_mul_f32 v[18:19], v[170:171], v[170:171]
    v_pk_mul_f32 v[20:21], v[184:185], v[184:185]
    v_pk_mul_f32 v[22:23], v[186:187], v[186:187]
    v_pk_mul_f32 v[24:25], v[172:173], v[172:173]
    v_pk_mul_f32 v[26:27], v[174:175], v[174:175]
    v_pk_mul_f32 v[28:29], v[188:189], v[188:189]
    v_pk_mul_f32 v[30:31], v[190:191], v[190:191]
    v_pk_fma_f32 v[16:17], v[16:17], v[6:7], v[4:5]
    v_pk_fma_f32 v[18:19], v[18:19], v[6:7], v[4:5]
    v_pk_fma_f32 v[20:21], v[20:21], v[6:7], v[4:5]
    v_pk_fma_f32 v[22:23], v[22:23], v[6:7], v[4:5]
    v_pk_fma_f32 v[24:25], v[24:25], v[6:7], v[4:5]
    v_pk_fma_f32 v[26:27], v[26:27], v[6:7], v[4:5]
    v_pk_fma_f32 v[28:29], v[28:29], v[6:7], v[4:5]
    v_pk_fma_f32 v[30:31], v[30:31], v[6:7], v[4:5]
    v_pk_mul_f32 v[16:17], v[16:17], v[168:169]
    v_pk_mul_f32 v[18:19], v[18:19], v[170:171]
    v_pk_mul_f32 v[20:21], v[20:21], v[184:185]
    v_pk_mul_f32 v[22:23], v[22:23], v[186:187]
    v_pk_mul_f32 v[24:25], v[24:25], v[172:173]
    v_pk_mul_f32 v[26:27], v[26:27], v[174:175]
    v_pk_mul_f32 v[28:29], v[28:29], v[188:189]
    v_pk_mul_f32 v[30:31], v[30:31], v[190:191]
    v_exp_f32 v16, v16
    v_exp_f32 v17, v17
    v_exp_f32 v18, v18
    v_exp_f32 v19, v19
    v_exp_f32 v20, v20
    v_exp_f32 v21, v21
    v_exp_f32 v22, v22
    v_exp_f32 v23, v23
    v_exp_f32 v24, v24
    v_exp_f32 v25, v25
    v_exp_f32 v26, v26
    v_exp_f32 v27, v27
    v_exp_f32 v28, v28
    v_exp_f32 v29, v29
    v_exp_f32 v30, v30
    v_exp_f32 v31, v31
    v_pk_add_f32 v[16:17], v[16:17], 1.0 op_sel_hi:[1,0]
    v_pk_add_f32 v[18:19], v[18:19], 1.0 op_sel_hi:[1,0]
    v_pk_add_f32 v[20:21], v[20:21], 1.0 op_sel_hi:[1,0]
    v_pk_add_f32 v[22:23], v[22:23], 1.0 op_sel_hi:[1,0]
    v_pk_add_f32 v[24:25], v[24:25], 1.0 op_sel_hi:[1,0]
    v_pk_add_f32 v[26:27], v[26:27], 1.0 op_sel_hi:[1,0]
    v_pk_add_f32 v[28:29], v[28:29], 1.0 op_sel_hi:[1,0]
    v_pk_add_f32 v[30:31], v[30:31], 1.0 op_sel_hi:[1,0]
    v_rcp_f32 v16, v16
    v_rcp_f32 v17, v17
    v_rcp_f32 v18, v18
    v_rcp_f32 v19, v19
    v_rcp_f32 v20, v20
    v_rcp_f32 v21, v21
    v_rcp_f32 v22, v22
    v_rcp_f32 v23, v23
    v_rcp_f32 v24, v24
    v_rcp_f32 v25, v25
    v_rcp_f32 v26, v26
    v_rcp_f32 v27, v27
    v_rcp_f32 v28, v28
    v_rcp_f32 v29, v29
    v_rcp_f32 v30, v30
    v_rcp_f32 v31, v31
    v_pk_mul_f32 v[16:17], v[16:17], v[168:169]
    v_pk_mul_f32 v[18:19], v[18:19], v[170:171]
    v_pk_mul_f32 v[20:21], v[20:21], v[184:185]
    v_pk_mul_f32 v[22:23], v[22:23], v[186:187]
    v_pk_mul_f32 v[24:25], v[24:25], v[172:173]
    v_pk_mul_f32 v[26:27], v[26:27], v[174:175]
    v_pk_mul_f32 v[28:29], v[28:29], v[188:189]
    v_pk_mul_f32 v[30:31], v[30:31], v[190:191]
    v_cvt_pk_bf16_f32 v72, v16, v17
    v_cvt_pk_bf16_f32 v73, v18, v19
    v_cvt_pk_bf16_f32 v74, v20, v21
    v_cvt_pk_bf16_f32 v75, v22, v23
    v_cvt_pk_bf16_f32 v76, v24, v25
    v_cvt_pk_bf16_f32 v77, v26, v27
    v_cvt_pk_bf16_f32 v78, v28, v29
    v_cvt_pk_bf16_f32 v79, v30, v31
    s_waitcnt vmcnt(2)
    v_mov_b32 v10, s92
    v_lshlrev_b32 v9, 2, v1
    s_mov_b32 exec_hi, 0
    buffer_store_dword v10, v9, s[12:15], s35 offen sc1
    s_nop 0
    s_mov_b32 exec_hi, -1
    buffer_store_dwordx4 v[72:75], v8, s[12:15], s33 offen offset:2048 sc1
    buffer_store_dwordx4 v[76:79], v8, s[12:15], s33 offen offset:3072 sc1
    s_add_u32 s33, s33, 8192
    v_pk_mul_f32 v[16:17], v[192:193], v[192:193]
    v_pk_mul_f32 v[18:19], v[194:195], v[194:195]
    v_pk_mul_f32 v[20:21], v[208:209], v[208:209]
    v_pk_mul_f32 v[22:23], v[210:211], v[210:211]
    v_pk_mul_f32 v[24:25], v[196:197], v[196:197]
    v_pk_mul_f32 v[26:27], v[198:199], v[198:199]
    v_pk_mul_f32 v[28:29], v[212:213], v[212:213]
    v_pk_mul_f32 v[30:31], v[214:215], v[214:215]
    v_pk_fma_f32 v[16:17], v[16:17], v[6:7], v[4:5]
    v_pk_fma_f32 v[18:19], v[18:19], v[6:7], v[4:5]
    v_pk_fma_f32 v[20:21], v[20:21], v[6:7], v[4:5]
    v_pk_fma_f32 v[22:23], v[22:23], v[6:7], v[4:5]
    v_pk_fma_f32 v[24:25], v[24:25], v[6:7], v[4:5]
    v_pk_fma_f32 v[26:27], v[26:27], v[6:7], v[4:5]
    v_pk_fma_f32 v[28:29], v[28:29], v[6:7], v[4:5]
    v_pk_fma_f32 v[30:31], v[30:31], v[6:7], v[4:5]
    v_pk_mul_f32 v[16:17], v[16:17], v[192:193]
    v_pk_mul_f32 v[18:19], v[18:19], v[194:195]
    v_pk_mul_f32 v[20:21], v[20:21], v[208:209]
    v_pk_mul_f32 v[22:23], v[22:23], v[210:211]
    v_pk_mul_f32 v[24:25], v[24:25], v[196:197]
    v_pk_mul_f32 v[26:27], v[26:27], v[198:199]
    v_pk_mul_f32 v[28:29], v[28:29], v[212:213]
    v_pk_mul_f32 v[30:31], v[30:31], v[214:215]
    v_exp_f32 v16, v16
    v_exp_f32 v17, v17
    v_exp_f32 v18, v18
    v_exp_f32 v19, v19
    v_exp_f32 v20, v20
    v_exp_f32 v21, v21
    v_exp_f32 v22, v22
    v_exp_f32 v23, v23
    v_exp_f32 v24, v24
    v_exp_f32 v25, v25
    v_exp_f32 v26, v26
    v_exp_f32 v27, v27
    v_exp_f32 v28, v28
    v_exp_f32 v29, v29
    v_exp_f32 v30, v30
    v_exp_f32 v31, v31
    v_pk_add_f32 v[16:17], v[16:17], 1.0 op_sel_hi:[1,0]
    v_pk_add_f32 v[18:19], v[18:19], 1.0 op_sel_hi:[1,0]
    v_pk_add_f32 v[20:21], v[20:21], 1.0 op_sel_hi:[1,0]
    v_pk_add_f32 v[22:23], v[22:23], 1.0 op_sel_hi:[1,0]
    v_pk_add_f32 v[24:25], v[24:25], 1.0 op_sel_hi:[1,0]
    v_pk_add_f32 v[26:27], v[26:27], 1.0 op_sel_hi:[1,0]
    v_pk_add_f32 v[28:29], v[28:29], 1.0 op_sel_hi:[1,0]
    v_pk_add_f32 v[30:31], v[30:31], 1.0 op_sel_hi:[1,0]
    v_rcp_f32 v16, v16
    v_rcp_f32 v17, v17
    v_rcp_f32 v18, v18
    v_rcp_f32 v19, v19
    v_rcp_f32 v20, v20
    v_rcp_f32 v21, v21
    v_rcp_f32 v22, v22
    v_rcp_f32 v23, v23
    v_rcp_f32 v24, v24
    v_rcp_f32 v25, v25
    v_rcp_f32 v26, v26
    v_rcp_f32 v27, v27
    v_rcp_f32 v28, v28
    v_rcp_f32 v29, v29
    v_rcp_f32 v30, v30
    v_rcp_f32 v31, v31
    v_pk_mul_f32 v[16:17], v[16:17], v[192:193]
    v_pk_mul_f32 v[18:19], v[18:19], v[194:195]
    v_pk_mul_f32 v[20:21], v[20:21], v[208:209]
    v_pk_mul_f32 v[22:23], v[22:23], v[210:211]
    v_pk_mul_f32 v[24:25], v[24:25], v[196:197]
    v_pk_mul_f32 v[26:27], v[26:27], v[198:199]
    v_pk_mul_f32 v[28:29], v[28:29], v[212:213]
    v_pk_mul_f32 v[30:31], v[30:31], v[214:215]
    v_cvt_pk_bf16_f32 v48, v16, v17
    v_cvt_pk_bf16_f32 v49, v18, v19
    v_cvt_pk_bf16_f32 v50, v20, v21
    v_cvt_pk_bf16_f32 v51, v22, v23
    v_cvt_pk_bf16_f32 v52, v24, v25
    v_cvt_pk_bf16_f32 v53, v26, v27
    v_cvt_pk_bf16_f32 v54, v28, v29
    v_cvt_pk_bf16_f32 v55, v30, v31
    buffer_store_dwordx4 v[48:51], v8, s[12:15], s33 offen offset:0 sc1
    buffer_store_dwordx4 v[52:55], v8, s[12:15], s33 offen offset:1024 sc1
    v_pk_mul_f32 v[16:17], v[200:201], v[200:201]
    v_pk_mul_f32 v[18:19], v[202:203], v[202:203]
    v_pk_mul_f32 v[20:21], v[216:217], v[216:217]
    v_pk_mul_f32 v[22:23], v[218:219], v[218:219]
    v_pk_mul_f32 v[24:25], v[204:205], v[204:205]
    v_pk_mul_f32 v[26:27], v[206:207], v[206:207]
    v_pk_mul_f32 v[28:29], v[220:221], v[220:221]
    v_pk_mul_f32 v[30:31], v[222:223], v[222:223]
    v_pk_fma_f32 v[16:17], v[16:17], v[6:7], v[4:5]
    v_pk_fma_f32 v[18:19], v[18:19], v[6:7], v[4:5]
    v_pk_fma_f32 v[20:21], v[20:21], v[6:7], v[4:5]
    v_pk_fma_f32 v[22:23], v[22:23], v[6:7], v[4:5]
    v_pk_fma_f32 v[24:25], v[24:25], v[6:7], v[4:5]
    v_pk_fma_f32 v[26:27], v[26:27], v[6:7], v[4:5]
    v_pk_fma_f32 v[28:29], v[28:29], v[6:7], v[4:5]
    v_pk_fma_f32 v[30:31], v[30:31], v[6:7], v[4:5]
    v_pk_mul_f32 v[16:17], v[16:17], v[200:201]
    v_pk_mul_f32 v[18:19], v[18:19], v[202:203]
    v_pk_mul_f32 v[20:21], v[20:21], v[216:217]
    v_pk_mul_f32 v[22:23], v[22:23], v[218:219]
    v_pk_mul_f32 v[24:25], v[24:25], v[204:205]
    v_pk_mul_f32 v[26:27], v[26:27], v[206:207]
    v_pk_mul_f32 v[28:29], v[28:29], v[220:221]
    v_pk_mul_f32 v[30:31], v[30:31], v[222:223]
    v_exp_f32 v16, v16
    v_exp_f32 v17, v17
    v_exp_f32 v18, v18
    v_exp_f32 v19, v19
    v_exp_f32 v20, v20
    v_exp_f32 v21, v21
    v_exp_f32 v22, v22
    v_exp_f32 v23, v23
    v_exp_f32 v24, v24
    v_exp_f32 v25, v25
    v_exp_f32 v26, v26
    v_exp_f32 v27, v27
    v_exp_f32 v28, v28
    v_exp_f32 v29, v29
    v_exp_f32 v30, v30
    v_exp_f32 v31, v31
    v_pk_add_f32 v[16:17], v[16:17], 1.0 op_sel_hi:[1,0]
    v_pk_add_f32 v[18:19], v[18:19], 1.0 op_sel_hi:[1,0]
    v_pk_add_f32 v[20:21], v[20:21], 1.0 op_sel_hi:[1,0]
    v_pk_add_f32 v[22:23], v[22:23], 1.0 op_sel_hi:[1,0]
    v_pk_add_f32 v[24:25], v[24:25], 1.0 op_sel_hi:[1,0]
    v_pk_add_f32 v[26:27], v[26:27], 1.0 op_sel_hi:[1,0]
    v_pk_add_f32 v[28:29], v[28:29], 1.0 op_sel_hi:[1,0]
    v_pk_add_f32 v[30:31], v[30:31], 1.0 op_sel_hi:[1,0]
    v_rcp_f32 v16, v16
    v_rcp_f32 v17, v17
    v_rcp_f32 v18, v18
    v_rcp_f32 v19, v19
    v_rcp_f32 v20, v20
    v_rcp_f32 v21, v21
    v_rcp_f32 v22, v22
    v_rcp_f32 v23, v23
    v_rcp_f32 v24, v24
    v_rcp_f32 v25, v25
    v_rcp_f32 v26, v26
    v_rcp_f32 v27, v27
    v_rcp_f32 v28, v28
    v_rcp_f32 v29, v29
    v_rcp_f32 v30, v30
    v_rcp_f32 v31, v31
    v_pk_mul_f32 v[16:17], v[16:17], v[200:201]
    v_pk_mul_f32 v[18:19], v[18:19], v[202:203]
    v_pk_mul_f32 v[20:21], v[20:21], v[216:217]
    v_pk_mul_f32 v[22:23], v[22:23], v[218:219]
    v_pk_mul_f32 v[24:25], v[24:25], v[204:205]
    v_pk_mul_f32 v[26:27], v[26:27], v[206:207]
    v_pk_mul_f32 v[28:29], v[28:29], v[220:221]
    v_pk_mul_f32 v[30:31], v[30:31], v[222:223]
    v_cvt_pk_bf16_f32 v56, v16, v17
    v_cvt_pk_bf16_f32 v57, v18, v19
    v_cvt_pk_bf16_f32 v58, v20, v21
    v_cvt_pk_bf16_f32 v59, v22, v23
    v_cvt_pk_bf16_f32 v60, v24, v25
    v_cvt_pk_bf16_f32 v61, v26, v27
    v_cvt_pk_bf16_f32 v62, v28, v29
    v_cvt_pk_bf16_f32 v63, v30, v31
    buffer_store_dwordx4 v[56:59], v8, s[12:15], s33 offen offset:2048 sc1
    buffer_store_dwordx4 v[60:63], v8, s[12:15], s33 offen offset:3072 sc1
    s_add_u32 s33, s33, 8192
    v_pk_mul_f32 v[16:17], v[224:225], v[224:225]
    v_pk_mul_f32 v[18:19], v[226:227], v[226:227]
    v_pk_mul_f32 v[20:21], v[228:229], v[228:229]
    v_pk_mul_f32 v[22:23], v[230:231], v[230:231]
    v_pk_mul_f32 v[24:25], v[232:233], v[232:233]
    v_pk_mul_f32 v[26:27], v[234:235], v[234:235]
    v_pk_mul_f32 v[28:29], v[236:237], v[236:237]
    v_pk_mul_f32 v[30:31], v[238:239], v[238:239]
    v_pk_fma_f32 v[16:17], v[16:17], v[6:7], v[4:5]
    v_pk_fma_f32 v[18:19], v[18:19], v[6:7], v[4:5]
    v_pk_fma_f32 v[20:21], v[20:21], v[6:7], v[4:5]
    v_pk_fma_f32 v[22:23], v[22:23], v[6:7], v[4:5]
    v_pk_fma_f32 v[24:25], v[24:25], v[6:7], v[4:5]
    v_pk_fma_f32 v[26:27], v[26:27], v[6:7], v[4:5]
    v_pk_fma_f32 v[28:29], v[28:29], v[6:7], v[4:5]
    v_pk_fma_f32 v[30:31], v[30:31], v[6:7], v[4:5]
    v_pk_mul_f32 v[16:17], v[16:17], v[224:225]
    v_pk_mul_f32 v[18:19], v[18:19], v[226:227]
    v_pk_mul_f32 v[20:21], v[20:21], v[228:229]
    v_pk_mul_f32 v[22:23], v[22:23], v[230:231]
    v_pk_mul_f32 v[24:25], v[24:25], v[232:233]
    v_pk_mul_f32 v[26:27], v[26:27], v[234:235]
    v_pk_mul_f32 v[28:29], v[28:29], v[236:237]
    v_pk_mul_f32 v[30:31], v[30:31], v[238:239]
    v_exp_f32 v16, v16
    v_exp_f32 v17, v17
    v_exp_f32 v18, v18
    v_exp_f32 v19, v19
    v_exp_f32 v20, v20
    v_exp_f32 v21, v21
    v_exp_f32 v22, v22
    v_exp_f32 v23, v23
    v_exp_f32 v24, v24
    v_exp_f32 v25, v25
    v_exp_f32 v26, v26
    v_exp_f32 v27, v27
    v_exp_f32 v28, v28
    v_exp_f32 v29, v29
    v_exp_f32 v30, v30
    v_exp_f32 v31, v31
    v_pk_add_f32 v[16:17], v[16:17], 1.0 op_sel_hi:[1,0]
    v_pk_add_f32 v[18:19], v[18:19], 1.0 op_sel_hi:[1,0]
    v_pk_add_f32 v[20:21], v[20:21], 1.0 op_sel_hi:[1,0]
    v_pk_add_f32 v[22:23], v[22:23], 1.0 op_sel_hi:[1,0]
    v_pk_add_f32 v[24:25], v[24:25], 1.0 op_sel_hi:[1,0]
    v_pk_add_f32 v[26:27], v[26:27], 1.0 op_sel_hi:[1,0]
    v_pk_add_f32 v[28:29], v[28:29], 1.0 op_sel_hi:[1,0]
    v_pk_add_f32 v[30:31], v[30:31], 1.0 op_sel_hi:[1,0]
    v_rcp_f32 v16, v16
    v_rcp_f32 v17, v17
    v_rcp_f32 v18, v18
    v_rcp_f32 v19, v19
    v_rcp_f32 v20, v20
    v_rcp_f32 v21, v21
    v_rcp_f32 v22, v22
    v_rcp_f32 v23, v23
    v_rcp_f32 v24, v24
    v_rcp_f32 v25, v25
    v_rcp_f32 v26, v26
    v_rcp_f32 v27, v27
    v_rcp_f32 v28, v28
    v_rcp_f32 v29, v29
    v_rcp_f32 v30, v30
    v_rcp_f32 v31, v31
    v_pk_mul_f32 v[16:17], v[16:17], v[224:225]
    v_pk_mul_f32 v[18:19], v[18:19], v[226:227]
    v_pk_mul_f32 v[20:21], v[20:21], v[228:229]
    v_pk_mul_f32 v[22:23], v[22:23], v[230:231]
    v_pk_mul_f32 v[24:25], v[24:25], v[232:233]
    v_pk_mul_f32 v[26:27], v[26:27], v[234:235]
    v_pk_mul_f32 v[28:29], v[28:29], v[236:237]
    v_pk_mul_f32 v[30:31], v[30:31], v[238:239]
    v_cvt_pk_bf16_f32 v64, v16, v17
    v_cvt_pk_bf16_f32 v65, v18, v19
    v_cvt_pk_bf16_f32 v66, v20, v21
    v_cvt_pk_bf16_f32 v67, v22, v23
    v_cvt_pk_bf16_f32 v68, v24, v25
    v_cvt_pk_bf16_f32 v69, v26, v27
    v_cvt_pk_bf16_f32 v70, v28, v29
    v_cvt_pk_bf16_f32 v71, v30, v31
    buffer_store_dwordx2 v[64:65], v11, s[12:15], s34 offen offset:0 sc1
    buffer_store_dwordx2 v[66:67], v11, s[12:15], s34 offen offset:1024 sc1
    buffer_store_dwordx2 v[68:69], v11, s[12:15], s34 offen offset:2048 sc1
    buffer_store_dwordx2 v[70:71], v11, s[12:15], s34 offen offset:3072 sc1
    s_lshr_b32 s27, s20, 1
    s_and_b32 s28, s20, 1
    v_lshrrev_b32 v5, 2, v1
    v_lshlrev_b32 v6, 7, v5
    v_lshrrev_b32 v5, 1, v5
    v_and_b32 v5, 3, v5
    v_lshl_add_u32 v6, v5, 5, v6
    v_and_b32_e64 v7, 3, v1
    v_lshl_add_u32 v6, v7, 3, v6
    s_lshl_b32 s60, s28, 13
    v_xor_b32 v7, 0, v6
    v_add_u32 v10, s60, v7
    v_xor_b32 v7, 32, v6
    v_add_u32 v11, s60, v7
    v_xor_b32 v7, 64, v6
    v_add_u32_e64 v12, s60, v7
    v_xor_b32 v7, 96, v6
    v_add_u32 v13, s60, v7
    s_lshl_b32 s60, s27, 12
    s_add_u32 s60, s60, 16384
    v_lshl_add_u32 v14, v1, 4, s60
    s_mov_b32 s24, 0
    v_add_u32 v4, s24, v10
    v_add_u32 v5, s24, v11
    v_add_u32 v6, s24, v12
    v_add_u32 v7, s24, v13
    v_add_u32_e64 v8, s24, v14
    s_barrier
    ds_read_b128 v[16:19], v8 offset:0
    ds_read_b64_tr_b16 v[32:33], v4 offset:0
    ds_read_b64_tr_b16 v[34:35], v4 offset:2048
    ds_read_b128 v[20:23], v8 offset:1024
    ds_read_b64_tr_b16 v[36:37], v5 offset:0
    ds_read_b64_tr_b16 v[38:39], v5 offset:2048
    ds_read_b128 v[24:27], v8 offset:2048
    ds_read_b64_tr_b16 v[40:41], v6 offset:0
    ds_read_b64_tr_b16 v[42:43], v6 offset:2048
    ds_read_b128 v[28:31], v8 offset:3072
    ds_read_b64_tr_b16 v[44:45], v7 offset:0
    ds_read_b64_tr_b16 v[46:47], v7 offset:2048
    s_nop 0
    s_waitcnt lgkmcnt(0)
    v_mfma_f32_16x16x32_bf16 v[128:131], v[16:19], v[32:35], 0
    ds_read_b128 v[48:51], v8 offset:8192
    ds_read_b64_tr_b16 v[64:65], v4 offset:4096
    v_mfma_f32_16x16x32_bf16 v[132:135], v[16:19], v[36:39], 0
    ds_read_b64_tr_b16 v[66:67], v4 offset:6144
    v_mfma_f32_16x16x32_bf16 v[148:151], v[20:23], v[36:39], 0
    ds_read_b128 v[52:55], v8 offset:9216
    v_mfma_f32_16x16x32_bf16 v[144:147], v[20:23], v[32:35], 0
    ds_read_b64_tr_b16 v[68:69], v5 offset:4096
    v_mfma_f32_16x16x32_bf16 v[160:163], v[24:27], v[32:35], 0
    ds_read_b64_tr_b16 v[70:71], v5 offset:6144
    v_mfma_f32_16x16x32_bf16 v[164:167], v[24:27], v[36:39], 0
    ds_read_b128 v[56:59], v8 offset:10240
    ds_read_b64_tr_b16 v[72:73], v6 offset:4096
    v_mfma_f32_16x16x32_bf16 v[180:183], v[28:31], v[36:39], 0
    ds_read_b64_tr_b16 v[74:75], v6 offset:6144
    v_mfma_f32_16x16x32_bf16 v[176:179], v[28:31], v[32:35], 0
    ds_read_b128 v[60:63], v8 offset:11264
    v_mfma_f32_16x16x32_bf16 v[184:187], v[28:31], v[40:43], 0
    ds_read_b64_tr_b16 v[76:77], v7 offset:4096
    v_mfma_f32_16x16x32_bf16 v[188:191], v[28:31], v[44:47], 0
    ds_read_b64_tr_b16 v[78:79], v7 offset:6144
    v_mfma_f32_16x16x32_bf16 v[172:175], v[24:27], v[44:47], 0
    s_add_u32 s24, s24, 32768
    s_cmp_eq_u32 s24, 131072
    v_mfma_f32_16x16x32_bf16 v[168:171], v[24:27], v[40:43], 0
    s_cselect_b32 s24, 0, s24
    v_add_u32 v4, s24, v10
    v_mfma_f32_16x16x32_bf16 v[152:155], v[20:23], v[40:43], 0
    v_add_u32 v5, s24, v11
    v_add_u32 v6, s24, v12
    v_mfma_f32_16x16x32_bf16 v[156:159], v[20:23], v[44:47], 0
    v_add_u32 v7, s24, v13
    v_add_u32 v8, s24, v14
    v_mfma_f32_16x16x32_bf16 v[140:143], v[16:19], v[44:47], 0
    v_mfma_f32_16x16x32_bf16 v[136:139], v[16:19], v[40:43], 0
    s_waitcnt lgkmcnt(0)
    s_barrier
    v_mfma_f32_16x16x32_bf16 v[128:131], v[48:51], v[64:67], v[128:131]
    ds_read_b128 v[16:19], v8 offset:0
    ds_read_b64_tr_b16 v[32:33], v4 offset:0
    v_mfma_f32_16x16x32_bf16 v[132:135], v[48:51], v[68:71], v[132:135]
    ds_read_b64_tr_b16 v[34:35], v4 offset:2048
    v_mfma_f32_16x16x32_bf16 v[148:151], v[52:55], v[68:71], v[148:151]
    ds_read_b128 v[20:23], v8 offset:1024
    v_mfma_f32_16x16x32_bf16 v[144:147], v[52:55], v[64:67], v[144:147]
    ds_read_b64_tr_b16 v[36:37], v5 offset:0
    v_mfma_f32_16x16x32_bf16 v[160:163], v[56:59], v[64:67], v[160:163]
    ds_read_b64_tr_b16 v[38:39], v5 offset:2048
    v_mfma_f32_16x16x32_bf16 v[164:167], v[56:59], v[68:71], v[164:167]
    ds_read_b128 v[24:27], v8 offset:2048
    ds_read_b64_tr_b16 v[40:41], v6 offset:0
    v_mfma_f32_16x16x32_bf16 v[180:183], v[60:63], v[68:71], v[180:183]
    ds_read_b64_tr_b16 v[42:43], v6 offset:2048
    v_mfma_f32_16x16x32_bf16 v[176:179], v[60:63], v[64:67], v[176:179]
    ds_read_b128 v[28:31], v8 offset:3072
    v_mfma_f32_16x16x32_bf16 v[184:187], v[60:63], v[72:75], v[184:187]
    ds_read_b64_tr_b16 v[44:45], v7 offset:0
    v_mfma_f32_16x16x32_bf16 v[188:191], v[60:63], v[76:79], v[188:191]
    ds_read_b64_tr_b16 v[46:47], v7 offset:2048
    v_mfma_f32_16x16x32_bf16 v[172:175], v[56:59], v[76:79], v[172:175]
    v_mfma_f32_16x16x32_bf16 v[168:171], v[56:59], v[72:75], v[168:171]
    v_mfma_f32_16x16x32_bf16 v[152:155], v[52:55], v[72:75], v[152:155]
    v_mfma_f32_16x16x32_bf16 v[156:159], v[52:55], v[76:79], v[156:159]
    v_mfma_f32_16x16x32_bf16 v[140:143], v[48:51], v[76:79], v[140:143]
    v_mfma_f32_16x16x32_bf16 v[136:139], v[48:51], v[72:75], v[136:139]
    s_nop 0
    s_waitcnt lgkmcnt(0)
    v_mfma_f32_16x16x32_bf16 v[128:131], v[16:19], v[32:35], v[128:131]
    ds_read_b128 v[48:51], v8 offset:8192
    ds_read_b64_tr_b16 v[64:65], v4 offset:4096
    v_mfma_f32_16x16x32_bf16 v[132:135], v[16:19], v[36:39], v[132:135]
    ds_read_b64_tr_b16 v[66:67], v4 offset:6144
    v_mfma_f32_16x16x32_bf16 v[148:151], v[20:23], v[36:39], v[148:151]
    ds_read_b128 v[52:55], v8 offset:9216
    v_mfma_f32_16x16x32_bf16 v[144:147], v[20:23], v[32:35], v[144:147]
    ds_read_b64_tr_b16 v[68:69], v5 offset:4096
    v_mfma_f32_16x16x32_bf16 v[160:163], v[24:27], v[32:35], v[160:163]
    ds_read_b64_tr_b16 v[70:71], v5 offset:6144
    v_mfma_f32_16x16x32_bf16 v[164:167], v[24:27], v[36:39], v[164:167]
    ds_read_b128 v[56:59], v8 offset:10240
    ds_read_b64_tr_b16 v[72:73], v6 offset:4096
    v_mfma_f32_16x16x32_bf16 v[180:183], v[28:31], v[36:39], v[180:183]
    ds_read_b64_tr_b16 v[74:75], v6 offset:6144
    v_mfma_f32_16x16x32_bf16 v[176:179], v[28:31], v[32:35], v[176:179]
    ds_read_b128 v[60:63], v8 offset:11264
    v_mfma_f32_16x16x32_bf16 v[184:187], v[28:31], v[40:43], v[184:187]
    ds_read_b64_tr_b16 v[76:77], v7 offset:4096
    v_mfma_f32_16x16x32_bf16 v[188:191], v[28:31], v[44:47], v[188:191]
    ds_read_b64_tr_b16 v[78:79], v7 offset:6144
    v_mfma_f32_16x16x32_bf16 v[172:175], v[24:27], v[44:47], v[172:175]
    s_add_u32 s24, s24, 32768
    s_cmp_eq_u32 s24, 131072
    v_mfma_f32_16x16x32_bf16 v[168:171], v[24:27], v[40:43], v[168:171]
    s_cselect_b32 s24, 0, s24
    v_add_u32 v4, s24, v10
    v_mfma_f32_16x16x32_bf16 v[152:155], v[20:23], v[40:43], v[152:155]
    v_add_u32 v5, s24, v11
    v_add_u32 v6, s24, v12
    v_mfma_f32_16x16x32_bf16 v[156:159], v[20:23], v[44:47], v[156:159]
    v_add_u32 v7, s24, v13
    v_add_u32 v8, s24, v14
    v_mfma_f32_16x16x32_bf16 v[140:143], v[16:19], v[44:47], v[140:143]
    v_mfma_f32_16x16x32_bf16 v[136:139], v[16:19], v[40:43], v[136:139]
    s_waitcnt lgkmcnt(0)
    s_barrier
    v_mfma_f32_16x16x32_bf16 v[128:131], v[48:51], v[64:67], v[128:131]
    ds_read_b128 v[16:19], v8 offset:0
    ds_read_b64_tr_b16 v[32:33], v4 offset:0
    v_mfma_f32_16x16x32_bf16 v[132:135], v[48:51], v[68:71], v[132:135]
    ds_read_b64_tr_b16 v[34:35], v4 offset:2048
    v_mfma_f32_16x16x32_bf16 v[148:151], v[52:55], v[68:71], v[148:151]
    ds_read_b128 v[20:23], v8 offset:1024
    v_mfma_f32_16x16x32_bf16 v[144:147], v[52:55], v[64:67], v[144:147]
    ds_read_b64_tr_b16 v[36:37], v5 offset:0
    v_mfma_f32_16x16x32_bf16 v[160:163], v[56:59], v[64:67], v[160:163]
    ds_read_b64_tr_b16 v[38:39], v5 offset:2048
    v_mfma_f32_16x16x32_bf16 v[164:167], v[56:59], v[68:71], v[164:167]
    ds_read_b128 v[24:27], v8 offset:2048
    ds_read_b64_tr_b16 v[40:41], v6 offset:0
    v_mfma_f32_16x16x32_bf16 v[180:183], v[60:63], v[68:71], v[180:183]
    ds_read_b64_tr_b16 v[42:43], v6 offset:2048
    v_mfma_f32_16x16x32_bf16 v[176:179], v[60:63], v[64:67], v[176:179]
    ds_read_b128 v[28:31], v8 offset:3072
    v_mfma_f32_16x16x32_bf16 v[184:187], v[60:63], v[72:75], v[184:187]
    ds_read_b64_tr_b16 v[44:45], v7 offset:0
    v_mfma_f32_16x16x32_bf16 v[188:191], v[60:63], v[76:79], v[188:191]
    ds_read_b64_tr_b16 v[46:47], v7 offset:2048
    v_mfma_f32_16x16x32_bf16 v[172:175], v[56:59], v[76:79], v[172:175]
    v_mfma_f32_16x16x32_bf16 v[168:171], v[56:59], v[72:75], v[168:171]
    v_mfma_f32_16x16x32_bf16 v[152:155], v[52:55], v[72:75], v[152:155]
    v_mfma_f32_16x16x32_bf16 v[156:159], v[52:55], v[76:79], v[156:159]
    v_mfma_f32_16x16x32_bf16 v[140:143], v[48:51], v[76:79], v[140:143]
    v_mfma_f32_16x16x32_bf16 v[136:139], v[48:51], v[72:75], v[136:139]
    s_waitcnt lgkmcnt(0)
    s_waitcnt vmcnt(0)
    v_mov_b32 v15, s92
    v_lshlrev_b32_e64 v9, 2, v1
    s_mov_b32 exec_hi, 0
    buffer_store_dword v15, v9, s[12:15], s36 offen sc1
    s_mov_b32 exec_hi, -1
    s_lshl_b32 s37, s22, 3
    s_add_u32 s37, s37, s21
    s_lshl_b32 s37, s37, 2
    s_add_u32 s37, s37, s20
    s_lshl_b32 s38, s37, 7
    s_add_u32 s38, s38, 18153472
    s_lshl_b32 s37, s37, 13
    s_add_u32 s37, s37, 33554432
    s_add_u32 s39, s37, 4096
    v_sub_f32 v96, 1.0, v116
    v_sub_f32 v97, 1.0, v116
    v_lshlrev_b32 v104, 16, v120
    v_sub_f32 v98, 1.0, v117
    v_sub_f32 v99, 1.0, v117
    v_lshlrev_b32 v106, 16, v121
    v_sub_f32 v100, 1.0, v118
    v_sub_f32 v101, 1.0, v118
    v_lshlrev_b32 v108, 16, v122
    v_sub_f32 v102, 1.0, v119
    v_sub_f32 v103, 1.0, v119
    v_lshlrev_b32 v110, 16, v123
    v_mul_f32 v105, v104, v96
    v_mul_f32 v104, v104, v96
    v_mul_f32 v107, v106, v98
    v_mul_f32 v106, v106, v98
    v_mul_f32 v109, v108, v100
    v_mul_f32 v108, v108, v100
    v_mul_f32 v111, v110, v102
    v_mul_f32_e64 v110, v110, v102
    v_mfma_f32_16x16x32_bf16 v[128:131], v[16:19], v[32:35], v[128:131]
    ds_read_b128 v[48:51], v8 offset:8192
    ds_read_b64_tr_b16 v[64:65], v4 offset:4096
    v_mfma_f32_16x16x32_bf16 v[132:135], v[16:19], v[36:39], v[132:135]
    ds_read_b64_tr_b16 v[66:67], v4 offset:6144
    v_mfma_f32_16x16x32_bf16 v[148:151], v[20:23], v[36:39], v[148:151]
    ds_read_b128 v[52:55], v8 offset:9216
    v_mfma_f32_16x16x32_bf16 v[144:147], v[20:23], v[32:35], v[144:147]
    ds_read_b64_tr_b16 v[68:69], v5 offset:4096
    v_mfma_f32_16x16x32_bf16 v[160:163], v[24:27], v[32:35], v[160:163]
    ds_read_b64_tr_b16 v[70:71], v5 offset:6144
    v_mfma_f32_16x16x32_bf16 v[164:167], v[24:27], v[36:39], v[164:167]
    ds_read_b128 v[56:59], v8 offset:10240
    ds_read_b64_tr_b16 v[72:73], v6 offset:4096
    v_mfma_f32_16x16x32_bf16 v[180:183], v[28:31], v[36:39], v[180:183]
    ds_read_b64_tr_b16 v[74:75], v6 offset:6144
    v_mfma_f32_16x16x32_bf16 v[176:179], v[28:31], v[32:35], v[176:179]
    ds_read_b128 v[60:63], v8 offset:11264
    v_mfma_f32_16x16x32_bf16 v[184:187], v[28:31], v[40:43], v[184:187]
    ds_read_b64_tr_b16 v[76:77], v7 offset:4096
    v_mfma_f32_16x16x32_bf16 v[188:191], v[28:31], v[44:47], v[188:191]
    ds_read_b64_tr_b16 v[78:79], v7 offset:6144
    v_mfma_f32_16x16x32_bf16 v[172:175], v[24:27], v[44:47], v[172:175]
    s_add_u32 s24, s24, 32768
    s_cmp_eq_u32 s24, 131072
    v_mfma_f32_16x16x32_bf16 v[168:171], v[24:27], v[40:43], v[168:171]
    s_cselect_b32 s24, 0, s24
    v_add_u32 v4, s24, v10
    v_mfma_f32_16x16x32_bf16 v[152:155], v[20:23], v[40:43], v[152:155]
    v_add_u32 v5, s24, v11
    v_add_u32 v6, s24, v12
    v_mfma_f32_16x16x32_bf16 v[156:159], v[20:23], v[44:47], v[156:159]
    v_add_u32 v7, s24, v13
    v_add_u32 v8, s24, v14
    v_mfma_f32_16x16x32_bf16 v[140:143], v[16:19], v[44:47], v[140:143]
    v_mfma_f32_16x16x32_bf16 v[136:139], v[16:19], v[40:43], v[136:139]
    s_waitcnt lgkmcnt(0)
    s_barrier
    v_mfma_f32_16x16x32_bf16 v[128:131], v[48:51], v[64:67], v[128:131]
    ds_read_b128 v[16:19], v8 offset:0
    ds_read_b64_tr_b16 v[32:33], v4 offset:0
    v_mfma_f32_16x16x32_bf16 v[132:135], v[48:51], v[68:71], v[132:135]
    ds_read_b64_tr_b16 v[34:35], v4 offset:2048
    v_mfma_f32_16x16x32_bf16 v[148:151], v[52:55], v[68:71], v[148:151]
    ds_read_b128 v[20:23], v8 offset:1024
    v_mfma_f32_16x16x32_bf16 v[144:147], v[52:55], v[64:67], v[144:147]
    ds_read_b64_tr_b16 v[36:37], v5 offset:0
    v_mfma_f32_16x16x32_bf16 v[160:163], v[56:59], v[64:67], v[160:163]
    ds_read_b64_tr_b16 v[38:39], v5 offset:2048
    v_mfma_f32_16x16x32_bf16 v[164:167], v[56:59], v[68:71], v[164:167]
    ds_read_b128 v[24:27], v8 offset:2048
    ds_read_b64_tr_b16 v[40:41], v6 offset:0
    v_mfma_f32_16x16x32_bf16 v[180:183], v[60:63], v[68:71], v[180:183]
    ds_read_b64_tr_b16 v[42:43], v6 offset:2048
    v_mfma_f32_16x16x32_bf16 v[176:179], v[60:63], v[64:67], v[176:179]
    ds_read_b128 v[28:31], v8 offset:3072
    v_mfma_f32_16x16x32_bf16 v[184:187], v[60:63], v[72:75], v[184:187]
    ds_read_b64_tr_b16 v[44:45], v7 offset:0
    v_mfma_f32_16x16x32_bf16 v[188:191], v[60:63], v[76:79], v[188:191]
    ds_read_b64_tr_b16 v[46:47], v7 offset:2048
    v_mfma_f32_16x16x32_bf16 v[172:175], v[56:59], v[76:79], v[172:175]
    v_mfma_f32_16x16x32_bf16 v[168:171], v[56:59], v[72:75], v[168:171]
    v_mfma_f32_16x16x32_bf16 v[152:155], v[52:55], v[72:75], v[152:155]
    v_mfma_f32_16x16x32_bf16 v[156:159], v[52:55], v[76:79], v[156:159]
    v_mfma_f32_16x16x32_bf16 v[140:143], v[48:51], v[76:79], v[140:143]
    v_mfma_f32_16x16x32_bf16 v[136:139], v[48:51], v[72:75], v[136:139]
    s_waitcnt lgkmcnt(0)
    s_mov_b32 s23, 26
.p2align 6
C1_LOOP1:
    v_mfma_f32_16x16x32_bf16 v[128:131], v[16:19], v[32:35], v[128:131]
    ds_read_b128 v[48:51], v8 offset:8192
    ds_read_b64_tr_b16 v[64:65], v4 offset:4096
    v_mfma_f32_16x16x32_bf16 v[132:135], v[16:19], v[36:39], v[132:135]
    ds_read_b64_tr_b16 v[66:67], v4 offset:6144
    v_mfma_f32_16x16x32_bf16 v[148:151], v[20:23], v[36:39], v[148:151]
    ds_read_b128 v[52:55], v8 offset:9216
    v_mfma_f32_16x16x32_bf16 v[144:147], v[20:23], v[32:35], v[144:147]
    ds_read_b64_tr_b16 v[68:69], v5 offset:4096
    v_mfma_f32_16x16x32_bf16 v[160:163], v[24:27], v[32:35], v[160:163]
    ds_read_b64_tr_b16 v[70:71], v5 offset:6144
    v_mfma_f32_16x16x32_bf16 v[164:167], v[24:27], v[36:39], v[164:167]
    ds_read_b128 v[56:59], v8 offset:10240
    ds_read_b64_tr_b16 v[72:73], v6 offset:4096
    v_mfma_f32_16x16x32_bf16 v[180:183], v[28:31], v[36:39], v[180:183]
    ds_read_b64_tr_b16 v[74:75], v6 offset:6144
    v_mfma_f32_16x16x32_bf16 v[176:179], v[28:31], v[32:35], v[176:179]
    ds_read_b128 v[60:63], v8 offset:11264
    v_mfma_f32_16x16x32_bf16 v[184:187], v[28:31], v[40:43], v[184:187]
    ds_read_b64_tr_b16 v[76:77], v7 offset:4096
    v_mfma_f32_16x16x32_bf16 v[188:191], v[28:31], v[44:47], v[188:191]
    ds_read_b64_tr_b16 v[78:79], v7 offset:6144
    v_mfma_f32_16x16x32_bf16 v[172:175], v[24:27], v[44:47], v[172:175]
    s_add_u32 s24, s24, 32768
    s_cmp_eq_u32 s24, 131072
    v_mfma_f32_16x16x32_bf16 v[168:171], v[24:27], v[40:43], v[168:171]
    s_cselect_b32 s24, 0, s24
    v_add_u32 v4, s24, v10
    v_mfma_f32_16x16x32_bf16 v[152:155], v[20:23], v[40:43], v[152:155]
    v_add_u32 v5, s24, v11
    v_add_u32 v6, s24, v12
    v_mfma_f32_16x16x32_bf16 v[156:159], v[20:23], v[44:47], v[156:159]
    v_add_u32 v7, s24, v13
    v_add_u32 v8, s24, v14
    v_mfma_f32_16x16x32_bf16 v[140:143], v[16:19], v[44:47], v[140:143]
    v_mfma_f32_16x16x32_bf16 v[136:139], v[16:19], v[40:43], v[136:139]
    s_waitcnt lgkmcnt(0)
    s_barrier
    v_mfma_f32_16x16x32_bf16 v[128:131], v[48:51], v[64:67], v[128:131]
    ds_read_b128 v[16:19], v8 offset:0
    ds_read_b64_tr_b16 v[32:33], v4 offset:0
    v_mfma_f32_16x16x32_bf16 v[132:135], v[48:51], v[68:71], v[132:135]
    ds_read_b64_tr_b16 v[34:35], v4 offset:2048
    v_mfma_f32_16x16x32_bf16 v[148:151], v[52:55], v[68:71], v[148:151]
    ds_read_b128 v[20:23], v8 offset:1024
    v_mfma_f32_16x16x32_bf16 v[144:147], v[52:55], v[64:67], v[144:147]
    ds_read_b64_tr_b16 v[36:37], v5 offset:0
    v_mfma_f32_16x16x32_bf16 v[160:163], v[56:59], v[64:67], v[160:163]
    ds_read_b64_tr_b16 v[38:39], v5 offset:2048
    v_mfma_f32_16x16x32_bf16 v[164:167], v[56:59], v[68:71], v[164:167]
    ds_read_b128 v[24:27], v8 offset:2048
    ds_read_b64_tr_b16 v[40:41], v6 offset:0
    v_mfma_f32_16x16x32_bf16 v[180:183], v[60:63], v[68:71], v[180:183]
    ds_read_b64_tr_b16 v[42:43], v6 offset:2048
    v_mfma_f32_16x16x32_bf16 v[176:179], v[60:63], v[64:67], v[176:179]
    ds_read_b128 v[28:31], v8 offset:3072
    v_mfma_f32_16x16x32_bf16 v[184:187], v[60:63], v[72:75], v[184:187]
    ds_read_b64_tr_b16 v[44:45], v7 offset:0
    v_mfma_f32_16x16x32_bf16 v[188:191], v[60:63], v[76:79], v[188:191]
    ds_read_b64_tr_b16 v[46:47], v7 offset:2048
    v_mfma_f32_16x16x32_bf16 v[172:175], v[56:59], v[76:79], v[172:175]
    v_mfma_f32_16x16x32_bf16 v[168:171], v[56:59], v[72:75], v[168:171]
    v_mfma_f32_16x16x32_bf16 v[152:155], v[52:55], v[72:75], v[152:155]
    v_mfma_f32_16x16x32_bf16 v[156:159], v[52:55], v[76:79], v[156:159]
    v_mfma_f32_16x16x32_bf16 v[140:143], v[48:51], v[76:79], v[140:143]
    v_mfma_f32_16x16x32_bf16 v[136:139], v[48:51], v[72:75], v[136:139]
    s_nop 0
    s_waitcnt lgkmcnt(0)
    v_mfma_f32_16x16x32_bf16 v[128:131], v[16:19], v[32:35], v[128:131]
    ds_read_b128 v[48:51], v8 offset:8192
    ds_read_b64_tr_b16 v[64:65], v4 offset:4096
    v_mfma_f32_16x16x32_bf16 v[132:135], v[16:19], v[36:39], v[132:135]
    ds_read_b64_tr_b16 v[66:67], v4 offset:6144
    v_mfma_f32_16x16x32_bf16 v[148:151], v[20:23], v[36:39], v[148:151]
    ds_read_b128 v[52:55], v8 offset:9216
    v_mfma_f32_16x16x32_bf16 v[144:147], v[20:23], v[32:35], v[144:147]
    ds_read_b64_tr_b16 v[68:69], v5 offset:4096
    v_mfma_f32_16x16x32_bf16 v[160:163], v[24:27], v[32:35], v[160:163]
    ds_read_b64_tr_b16 v[70:71], v5 offset:6144
    v_mfma_f32_16x16x32_bf16 v[164:167], v[24:27], v[36:39], v[164:167]
    ds_read_b128 v[56:59], v8 offset:10240
    ds_read_b64_tr_b16 v[72:73], v6 offset:4096
    v_mfma_f32_16x16x32_bf16 v[180:183], v[28:31], v[36:39], v[180:183]
    ds_read_b64_tr_b16 v[74:75], v6 offset:6144
    v_mfma_f32_16x16x32_bf16 v[176:179], v[28:31], v[32:35], v[176:179]
    ds_read_b128 v[60:63], v8 offset:11264
    v_mfma_f32_16x16x32_bf16 v[184:187], v[28:31], v[40:43], v[184:187]
    ds_read_b64_tr_b16 v[76:77], v7 offset:4096
    v_mfma_f32_16x16x32_bf16 v[188:191], v[28:31], v[44:47], v[188:191]
    ds_read_b64_tr_b16 v[78:79], v7 offset:6144
    v_mfma_f32_16x16x32_bf16 v[172:175], v[24:27], v[44:47], v[172:175]
    s_add_u32 s24, s24, 32768
    s_cmp_eq_u32 s24, 131072
    v_mfma_f32_16x16x32_bf16 v[168:171], v[24:27], v[40:43], v[168:171]
    s_cselect_b32 s24, 0, s24
    v_add_u32 v4, s24, v10
    v_mfma_f32_16x16x32_bf16 v[152:155], v[20:23], v[40:43], v[152:155]
    v_add_u32 v5, s24, v11
    v_add_u32 v6, s24, v12
    v_mfma_f32_16x16x32_bf16 v[156:159], v[20:23], v[44:47], v[156:159]
    v_add_u32 v7, s24, v13
    v_add_u32 v8, s24, v14
    v_mfma_f32_16x16x32_bf16 v[140:143], v[16:19], v[44:47], v[140:143]
    v_mfma_f32_16x16x32_bf16 v[136:139], v[16:19], v[40:43], v[136:139]
    s_waitcnt lgkmcnt(0)
    s_barrier
    v_mfma_f32_16x16x32_bf16 v[128:131], v[48:51], v[64:67], v[128:131]
    ds_read_b128 v[16:19], v8 offset:0
    ds_read_b64_tr_b16 v[32:33], v4 offset:0
    v_mfma_f32_16x16x32_bf16 v[132:135], v[48:51], v[68:71], v[132:135]
    ds_read_b64_tr_b16 v[34:35], v4 offset:2048
    v_mfma_f32_16x16x32_bf16 v[148:151], v[52:55], v[68:71], v[148:151]
    ds_read_b128 v[20:23], v8 offset:1024
    v_mfma_f32_16x16x32_bf16 v[144:147], v[52:55], v[64:67], v[144:147]
    ds_read_b64_tr_b16 v[36:37], v5 offset:0
    v_mfma_f32_16x16x32_bf16 v[160:163], v[56:59], v[64:67], v[160:163]
    ds_read_b64_tr_b16 v[38:39], v5 offset:2048
    v_mfma_f32_16x16x32_bf16 v[164:167], v[56:59], v[68:71], v[164:167]
    ds_read_b128 v[24:27], v8 offset:2048
    ds_read_b64_tr_b16 v[40:41], v6 offset:0
    v_mfma_f32_16x16x32_bf16 v[180:183], v[60:63], v[68:71], v[180:183]
    ds_read_b64_tr_b16 v[42:43], v6 offset:2048
    v_mfma_f32_16x16x32_bf16 v[176:179], v[60:63], v[64:67], v[176:179]
    ds_read_b128 v[28:31], v8 offset:3072
    v_mfma_f32_16x16x32_bf16 v[184:187], v[60:63], v[72:75], v[184:187]
    ds_read_b64_tr_b16 v[44:45], v7 offset:0
    v_mfma_f32_16x16x32_bf16 v[188:191], v[60:63], v[76:79], v[188:191]
    ds_read_b64_tr_b16 v[46:47], v7 offset:2048
    v_mfma_f32_16x16x32_bf16 v[172:175], v[56:59], v[76:79], v[172:175]
    v_mfma_f32_16x16x32_bf16 v[168:171], v[56:59], v[72:75], v[168:171]
    v_mfma_f32_16x16x32_bf16 v[152:155], v[52:55], v[72:75], v[152:155]
    v_mfma_f32_16x16x32_bf16 v[156:159], v[52:55], v[76:79], v[156:159]
    v_mfma_f32_16x16x32_bf16 v[140:143], v[48:51], v[76:79], v[140:143]
    v_mfma_f32_16x16x32_bf16 v[136:139], v[48:51], v[72:75], v[136:139]
    s_waitcnt lgkmcnt(0)
    s_sub_u32 s23, s23, 1
    s_cmp_lg_u32 s23, 0
    s_cbranch_scc1 C1_LOOP1
    v_mfma_f32_16x16x32_bf16 v[128:131], v[16:19], v[32:35], v[128:131]
    ds_read_b128 v[48:51], v8 offset:8192
    ds_read_b64_tr_b16 v[64:65], v4 offset:4096
    v_mfma_f32_16x16x32_bf16 v[132:135], v[16:19], v[36:39], v[132:135]
    ds_read_b64_tr_b16 v[66:67], v4 offset:6144
    v_mfma_f32_16x16x32_bf16 v[148:151], v[20:23], v[36:39], v[148:151]
    ds_read_b128 v[52:55], v8 offset:9216
    v_mfma_f32_16x16x32_bf16 v[144:147], v[20:23], v[32:35], v[144:147]
    ds_read_b64_tr_b16 v[68:69], v5 offset:4096
    v_mfma_f32_16x16x32_bf16 v[160:163], v[24:27], v[32:35], v[160:163]
    ds_read_b64_tr_b16 v[70:71], v5 offset:6144
    v_mfma_f32_16x16x32_bf16 v[164:167], v[24:27], v[36:39], v[164:167]
    ds_read_b128 v[56:59], v8 offset:10240
    ds_read_b64_tr_b16 v[72:73], v6 offset:4096
    v_mfma_f32_16x16x32_bf16 v[180:183], v[28:31], v[36:39], v[180:183]
    ds_read_b64_tr_b16 v[74:75], v6 offset:6144
    v_mfma_f32_16x16x32_bf16 v[176:179], v[28:31], v[32:35], v[176:179]
    ds_read_b128 v[60:63], v8 offset:11264
    v_mfma_f32_16x16x32_bf16 v[184:187], v[28:31], v[40:43], v[184:187]
    ds_read_b64_tr_b16 v[76:77], v7 offset:4096
    v_mfma_f32_16x16x32_bf16 v[188:191], v[28:31], v[44:47], v[188:191]
    ds_read_b64_tr_b16 v[78:79], v7 offset:6144
    v_mfma_f32_16x16x32_bf16 v[172:175], v[24:27], v[44:47], v[172:175]
    v_mfma_f32_16x16x32_bf16 v[168:171], v[24:27], v[40:43], v[168:171]
    v_mfma_f32_16x16x32_bf16 v[152:155], v[20:23], v[40:43], v[152:155]
    v_mfma_f32_16x16x32_bf16 v[156:159], v[20:23], v[44:47], v[156:159]
    v_mfma_f32_16x16x32_bf16 v[140:143], v[16:19], v[44:47], v[140:143]
    v_mfma_f32_16x16x32_bf16 v[136:139], v[16:19], v[40:43], v[136:139]
    s_nop 0
    s_waitcnt lgkmcnt(0)
    v_mfma_f32_16x16x32_bf16 v[128:131], v[48:51], v[64:67], v[128:131]
    v_mfma_f32_16x16x32_bf16 v[132:135], v[48:51], v[68:71], v[132:135]
    v_mfma_f32_16x16x32_bf16 v[148:151], v[52:55], v[68:71], v[148:151]
    v_mfma_f32_16x16x32_bf16 v[144:147], v[52:55], v[64:67], v[144:147]
    v_mfma_f32_16x16x32_bf16 v[160:163], v[56:59], v[64:67], v[160:163]
    v_mfma_f32_16x16x32_bf16 v[164:167], v[56:59], v[68:71], v[164:167]
    v_mfma_f32_16x16x32_bf16 v[180:183], v[60:63], v[68:71], v[180:183]
    v_mfma_f32_16x16x32_bf16 v[176:179], v[60:63], v[64:67], v[176:179]
    v_mfma_f32_16x16x32_bf16 v[184:187], v[60:63], v[72:75], v[184:187]
    v_mfma_f32_16x16x32_bf16 v[188:191], v[60:63], v[76:79], v[188:191]
    v_mfma_f32_16x16x32_bf16 v[172:175], v[56:59], v[76:79], v[172:175]
    v_mfma_f32_16x16x32_bf16 v[168:171], v[56:59], v[72:75], v[168:171]
    v_mfma_f32_16x16x32_bf16 v[152:155], v[52:55], v[72:75], v[152:155]
    v_mfma_f32_16x16x32_bf16 v[156:159], v[52:55], v[76:79], v[156:159]
    v_mfma_f32_16x16x32_bf16 v[140:143], v[48:51], v[76:79], v[140:143]
    v_mfma_f32_16x16x32_bf16 v[136:139], v[48:51], v[72:75], v[136:139]
    v_lshlrev_b32 v8, 4, v1
    s_nop 2
    v_pk_fma_f32 v[128:129], v[128:129], v[96:97], v[104:105]
    v_pk_fma_f32 v[130:131], v[130:131], v[96:97], v[104:105]
    v_cvt_pk_bf16_f32 v16, v128, v129
    v_cvt_pk_bf16_f32 v17, v130, v131
    v_pk_fma_f32 v[144:145], v[144:145], v[96:97], v[104:105]
    v_pk_fma_f32 v[146:147], v[146:147], v[96:97], v[104:105]
    v_cvt_pk_bf16_f32 v18, v144, v145
    v_cvt_pk_bf16_f32 v19, v146, v147
    buffer_store_dwordx4 v[16:19], v8, s[12:15], s37 offen offset:0 sc1
    v_pk_fma_f32 v[160:161], v[160:161], v[96:97], v[104:105]
    v_pk_fma_f32 v[162:163], v[162:163], v[96:97], v[104:105]
    v_cvt_pk_bf16_f32 v20, v160, v161
    v_cvt_pk_bf16_f32 v21, v162, v163
    s_nop 0
    s_nop 0
    v_pk_fma_f32 v[176:177], v[176:177], v[96:97], v[104:105]
    v_pk_fma_f32 v[178:179], v[178:179], v[96:97], v[104:105]
    v_cvt_pk_bf16_f32 v22, v176, v177
    v_cvt_pk_bf16_f32 v23, v178, v179
    buffer_store_dwordx4 v[20:23], v8, s[12:15], s37 offen offset:1024 sc1
    v_pk_fma_f32 v[132:133], v[132:133], v[98:99], v[106:107]
    v_pk_fma_f32 v[134:135], v[134:135], v[98:99], v[106:107]
    v_cvt_pk_bf16_f32 v24, v132, v133
    v_cvt_pk_bf16_f32 v25, v134, v135
    v_pk_fma_f32 v[148:149], v[148:149], v[98:99], v[106:107]
    v_pk_fma_f32 v[150:151], v[150:151], v[98:99], v[106:107]
    v_cvt_pk_bf16_f32 v26, v148, v149
    v_cvt_pk_bf16_f32 v27, v150, v151
    buffer_store_dwordx4 v[24:27], v8, s[12:15], s37 offen offset:2048 sc1
    v_pk_fma_f32 v[164:165], v[164:165], v[98:99], v[106:107]
    v_pk_fma_f32 v[166:167], v[166:167], v[98:99], v[106:107]
    v_cvt_pk_bf16_f32 v28, v164, v165
    v_cvt_pk_bf16_f32 v29, v166, v167
    v_pk_fma_f32 v[180:181], v[180:181], v[98:99], v[106:107]
    v_pk_fma_f32 v[182:183], v[182:183], v[98:99], v[106:107]
    v_cvt_pk_bf16_f32 v30, v180, v181
    v_cvt_pk_bf16_f32 v31, v182, v183
    buffer_store_dwordx4 v[28:31], v8, s[12:15], s37 offen offset:3072 sc1
    v_pk_fma_f32 v[136:137], v[136:137], v[100:101], v[108:109]
    v_pk_fma_f32 v[138:139], v[138:139], v[100:101], v[108:109]
    v_cvt_pk_bf16_f32 v32, v136, v137
    v_cvt_pk_bf16_f32 v33, v138, v139
    v_pk_fma_f32 v[152:153], v[152:153], v[100:101], v[108:109]
    v_pk_fma_f32 v[154:155], v[154:155], v[100:101], v[108:109]
    v_cvt_pk_bf16_f32 v34, v152, v153
    v_cvt_pk_bf16_f32 v35, v154, v155
    buffer_store_dwordx4 v[32:35], v8, s[12:15], s39 offen offset:0 sc1
    v_pk_fma_f32 v[168:169], v[168:169], v[100:101], v[108:109]
    v_pk_fma_f32 v[170:171], v[170:171], v[100:101], v[108:109]
    v_cvt_pk_bf16_f32 v36, v168, v169
    v_cvt_pk_bf16_f32 v37, v170, v171
    v_pk_fma_f32 v[184:185], v[184:185], v[100:101], v[108:109]
    v_pk_fma_f32 v[186:187], v[186:187], v[100:101], v[108:109]
    v_cvt_pk_bf16_f32 v38, v184, v185
    v_cvt_pk_bf16_f32 v39, v186, v187
    buffer_store_dwordx4 v[36:39], v8, s[12:15], s39 offen offset:1024 sc1
    v_pk_fma_f32 v[140:141], v[140:141], v[102:103], v[110:111]
    v_pk_fma_f32 v[142:143], v[142:143], v[102:103], v[110:111]
    v_cvt_pk_bf16_f32 v40, v140, v141
    v_cvt_pk_bf16_f32 v41, v142, v143
    v_pk_fma_f32 v[156:157], v[156:157], v[102:103], v[110:111]
    v_pk_fma_f32 v[158:159], v[158:159], v[102:103], v[110:111]
    v_cvt_pk_bf16_f32 v42, v156, v157
    v_cvt_pk_bf16_f32 v43, v158, v159
    buffer_store_dwordx4 v[40:43], v8, s[12:15], s39 offen offset:2048 sc1
    v_pk_fma_f32 v[172:173], v[172:173], v[102:103], v[110:111]
    v_pk_fma_f32 v[174:175], v[174:175], v[102:103], v[110:111]
    v_cvt_pk_bf16_f32 v44, v172, v173
    v_cvt_pk_bf16_f32 v45, v174, v175
    v_pk_fma_f32 v[188:189], v[188:189], v[102:103], v[110:111]
    v_pk_fma_f32 v[190:191], v[190:191], v[102:103], v[110:111]
    v_cvt_pk_bf16_f32 v46, v188, v189
    v_cvt_pk_bf16_f32 v47, v190, v191
    buffer_store_dwordx4 v[44:47], v8, s[12:15], s39 offen offset:3072 sc1
    v_mov_b32 v9, 0
    s_waitcnt vmcnt(0)
    v_mov_b32 v10, s92
    v_lshlrev_b32_e64 v9, 2, v1
    s_mov_b32 exec_hi, 0
    buffer_store_dword v10, v9, s[12:15], s38 offen sc1
    s_mov_b32 exec_hi, -1
    s_endpgm
G_LOADER:
    s_mov_b32 s24, 0
    s_mov_b32 s25, 0
    s_mov_b32 s26, 0
    s_mov_b32 m0, s54
    s_add_u32 s56, s54, 4096
    buffer_load_dwordx4 v200, s[48:51], s25 offen offset:0 lds
    buffer_load_dwordx4 v201, s[48:51], s25 offen offset:1024 lds
    buffer_load_dwordx4 v202, s[48:51], s25 offen offset:2048 lds
    buffer_load_dwordx4 v203, s[48:51], s25 offen offset:3072 lds
    s_add_u32 m0, s24, s56
    s_nop 0
    buffer_load_dwordx4 v204, s[48:51], s25 offen offset:0 lds
    buffer_load_dwordx4 v205, s[48:51], s25 offen offset:1024 lds
    buffer_load_dwordx4 v206, s[48:51], s25 offen offset:2048 lds
    buffer_load_dwordx4 v207, s[48:51], s25 offen offset:3072 lds
    s_add_u32 m0, s24, s55
    s_add_u32 s25, s25, 458752
    s_barrier
    buffer_load_dwordx4 v208, s[12:15], s26 offen offset:0 sc1 lds
    s_add_u32 s24, s24, 49152
    buffer_load_dwordx4 v208, s[12:15], s26 offen offset:1024 sc1 lds
    s_cmp_eq_u32 s24, 147456
    buffer_load_dwordx4 v208, s[12:15], s26 offen offset:2048 sc1 lds
    s_cselect_b32 s24, 0, s24
    buffer_load_dwordx4 v208, s[12:15], s26 offen offset:3072 sc1 lds
    s_add_u32 s26, s26, 16384
    s_nop 0
    s_add_u32 m0, s24, s54
    s_nop 0
    buffer_load_dwordx4 v200, s[48:51], s25 offen offset:0 lds
    buffer_load_dwordx4 v201, s[48:51], s25 offen offset:1024 lds
    buffer_load_dwordx4 v202, s[48:51], s25 offen offset:2048 lds
    buffer_load_dwordx4 v203, s[48:51], s25 offen offset:3072 lds
    s_add_u32 m0, s24, s56
    s_nop 0
    buffer_load_dwordx4 v204, s[48:51], s25 offen offset:0 lds
    buffer_load_dwordx4 v205, s[48:51], s25 offen offset:1024 lds
    buffer_load_dwordx4 v206, s[48:51], s25 offen offset:2048 lds
    buffer_load_dwordx4 v207, s[48:51], s25 offen offset:3072 lds
    s_nop 0
    s_add_u32 m0, s24, s55
    s_add_u32 s25, s25, 458752
    buffer_load_dwordx4 v208, s[12:15], s26 offen offset:0 sc1 lds
    s_add_u32 s24, s24, 49152
    buffer_load_dwordx4 v208, s[12:15], s26 offen offset:1024 sc1 lds
    s_cmp_eq_u32 s24, 147456
    buffer_load_dwordx4 v208, s[12:15], s26 offen offset:2048 sc1 lds
    s_cselect_b32 s24, 0, s24
    buffer_load_dwordx4 v208, s[12:15], s26 offen offset:3072 sc1 lds
    s_add_u32 s26, s26, 16384
    s_add_u32 m0, s24, s54
    s_waitcnt vmcnt(12)
    s_barrier
    s_cmp_eq_u32 s20, 4
    s_cbranch_scc0 M1_NGF
    s_add_u32 s28, s33, 18022400
    v_mov_b32 v17, s92
    v_lshlrev_b32_e64 v16, 2, v1
    s_mov_b32 exec_hi, 0
    buffer_store_dword v17, v16, s[12:15], s28 offen sc1
    s_mov_b32 exec_hi, -1
M1_NGF:
    s_nop 0
    buffer_load_dwordx4 v200, s[48:51], s25 offen offset:0 lds
    buffer_load_dwordx4 v201, s[48:51], s25 offen offset:1024 lds
    buffer_load_dwordx4 v202, s[48:51], s25 offen offset:2048 lds
    buffer_load_dwordx4 v203, s[48:51], s25 offen offset:3072 lds
    s_add_u32 m0, s24, s56
    s_nop 0
    buffer_load_dwordx4 v204, s[48:51], s25 offen offset:0 lds
    buffer_load_dwordx4 v205, s[48:51], s25 offen offset:1024 lds
    buffer_load_dwordx4 v206, s[48:51], s25 offen offset:2048 lds
    buffer_load_dwordx4 v207, s[48:51], s25 offen offset:3072 lds
    s_nop 0
    s_add_u32 m0, s24, s55
    s_add_u32 s25, s25, 458752
    buffer_load_dwordx4 v208, s[12:15], s26 offen offset:0 sc1 lds
    s_add_u32 s24, s24, 49152
    buffer_load_dwordx4 v208, s[12:15], s26 offen offset:1024 sc1 lds
    s_cmp_eq_u32 s24, 147456
    buffer_load_dwordx4 v208, s[12:15], s26 offen offset:2048 sc1 lds
    s_cselect_b32 s24, 0, s24
    buffer_load_dwordx4 v208, s[12:15], s26 offen offset:3072 sc1 lds
    s_add_u32 s26, s26, 16384
    s_add_u32 m0, s24, s54
    s_waitcnt vmcnt(12)
    s_barrier
    buffer_load_dwordx4 v200, s[48:51], s25 offen offset:0 lds
    buffer_load_dwordx4 v201, s[48:51], s25 offen offset:1024 lds
    buffer_load_dwordx4 v202, s[48:51], s25 offen offset:2048 lds
    buffer_load_dwordx4 v203, s[48:51], s25 offen offset:3072 lds
    s_add_u32 m0, s24, s56
    s_nop 0
    buffer_load_dwordx4 v204, s[48:51], s25 offen offset:0 lds
    buffer_load_dwordx4 v205, s[48:51], s25 offen offset:1024 lds
    buffer_load_dwordx4 v206, s[48:51], s25 offen offset:2048 lds
    buffer_load_dwordx4 v207, s[48:51], s25 offen offset:3072 lds
    s_nop 0
    s_add_u32 m0, s24, s55
    s_add_u32 s25, s25, 458752
    buffer_load_dwordx4 v208, s[12:15], s26 offen offset:0 sc1 lds
    s_add_u32 s24, s24, 49152
    buffer_load_dwordx4 v208, s[12:15], s26 offen offset:1024 sc1 lds
    s_cmp_eq_u32 s24, 147456
    buffer_load_dwordx4 v208, s[12:15], s26 offen offset:2048 sc1 lds
    s_cselect_b32 s24, 0, s24
    buffer_load_dwordx4 v208, s[12:15], s26 offen offset:3072 sc1 lds
    s_add_u32 s26, s26, 16384
    s_add_u32 m0, s24, s54
    s_mov_b32 s23, 7
.p2align 6
M1_LDL:
    s_waitcnt vmcnt(12)
    s_barrier
    buffer_load_dwordx4 v200, s[48:51], s25 offen offset:0 lds
    buffer_load_dwordx4 v201, s[48:51], s25 offen offset:1024 lds
    buffer_load_dwordx4 v202, s[48:51], s25 offen offset:2048 lds
    buffer_load_dwordx4 v203, s[48:51], s25 offen offset:3072 lds
    s_add_u32 m0, s24, s56
    s_nop 0
    buffer_load_dwordx4 v204, s[48:51], s25 offen offset:0 lds
    buffer_load_dwordx4 v205, s[48:51], s25 offen offset:1024 lds
    buffer_load_dwordx4 v206, s[48:51], s25 offen offset:2048 lds
    buffer_load_dwordx4 v207, s[48:51], s25 offen offset:3072 lds
    s_nop 0
    s_add_u32 m0, s24, s55
    s_add_u32 s25, s25, 458752
    buffer_load_dwordx4 v208, s[12:15], s26 offen offset:0 sc1 lds
    s_add_u32 s24, s24, 49152
    buffer_load_dwordx4 v208, s[12:15], s26 offen offset:1024 sc1 lds
    s_cmp_eq_u32 s24, 147456
    buffer_load_dwordx4 v208, s[12:15], s26 offen offset:2048 sc1 lds
    s_cselect_b32 s24, 0, s24
    buffer_load_dwordx4 v208, s[12:15], s26 offen offset:3072 sc1 lds
    s_add_u32 s26, s26, 16384
    s_add_u32 m0, s24, s54
    s_waitcnt vmcnt(12)
    s_barrier
    buffer_load_dwordx4 v200, s[48:51], s25 offen offset:0 lds
    buffer_load_dwordx4 v201, s[48:51], s25 offen offset:1024 lds
    buffer_load_dwordx4 v202, s[48:51], s25 offen offset:2048 lds
    buffer_load_dwordx4 v203, s[48:51], s25 offen offset:3072 lds
    s_add_u32 m0, s24, s56
    s_nop 0
    buffer_load_dwordx4 v204, s[48:51], s25 offen offset:0 lds
    buffer_load_dwordx4 v205, s[48:51], s25 offen offset:1024 lds
    buffer_load_dwordx4 v206, s[48:51], s25 offen offset:2048 lds
    buffer_load_dwordx4 v207, s[48:51], s25 offen offset:3072 lds
    s_nop 0
    s_add_u32 m0, s24, s55
    s_add_u32 s25, s25, 458752
    buffer_load_dwordx4 v208, s[12:15], s26 offen offset:0 sc1 lds
    s_add_u32 s24, s24, 49152
    buffer_load_dwordx4 v208, s[12:15], s26 offen offset:1024 sc1 lds
    s_cmp_eq_u32 s24, 147456
    buffer_load_dwordx4 v208, s[12:15], s26 offen offset:2048 sc1 lds
    s_cselect_b32 s24, 0, s24
    buffer_load_dwordx4 v208, s[12:15], s26 offen offset:3072 sc1 lds
    s_add_u32 s26, s26, 16384
    s_add_u32 m0, s24, s54
    s_waitcnt vmcnt(12)
    s_barrier
    buffer_load_dwordx4 v200, s[48:51], s25 offen offset:0 lds
    buffer_load_dwordx4 v201, s[48:51], s25 offen offset:1024 lds
    buffer_load_dwordx4 v202, s[48:51], s25 offen offset:2048 lds
    buffer_load_dwordx4 v203, s[48:51], s25 offen offset:3072 lds
    s_add_u32 m0, s24, s56
    s_nop 0
    buffer_load_dwordx4 v204, s[48:51], s25 offen offset:0 lds
    buffer_load_dwordx4 v205, s[48:51], s25 offen offset:1024 lds
    buffer_load_dwordx4 v206, s[48:51], s25 offen offset:2048 lds
    buffer_load_dwordx4 v207, s[48:51], s25 offen offset:3072 lds
    s_nop 0
    s_add_u32 m0, s24, s55
    s_add_u32 s25, s25, 458752
    buffer_load_dwordx4 v208, s[12:15], s26 offen offset:0 sc1 lds
    s_add_u32 s24, s24, 49152
    buffer_load_dwordx4 v208, s[12:15], s26 offen offset:1024 sc1 lds
    s_cmp_eq_u32 s24, 147456
    buffer_load_dwordx4 v208, s[12:15], s26 offen offset:2048 sc1 lds
    s_cselect_b32 s24, 0, s24
    buffer_load_dwordx4 v208, s[12:15], s26 offen offset:3072 sc1 lds
    s_add_u32 s26, s26, 16384
    s_add_u32 m0, s24, s54
    s_waitcnt vmcnt(12)
    s_barrier
    buffer_load_dwordx4 v200, s[48:51], s25 offen offset:0 lds
    buffer_load_dwordx4 v201, s[48:51], s25 offen offset:1024 lds
    buffer_load_dwordx4 v202, s[48:51], s25 offen offset:2048 lds
    buffer_load_dwordx4 v203, s[48:51], s25 offen offset:3072 lds
    s_add_u32 m0, s24, s56
    s_nop 0
    buffer_load_dwordx4 v204, s[48:51], s25 offen offset:0 lds
    buffer_load_dwordx4 v205, s[48:51], s25 offen offset:1024 lds
    buffer_load_dwordx4 v206, s[48:51], s25 offen offset:2048 lds
    buffer_load_dwordx4 v207, s[48:51], s25 offen offset:3072 lds
    s_nop 0
    s_add_u32 m0, s24, s55
    s_add_u32 s25, s25, 458752
    buffer_load_dwordx4 v208, s[12:15], s26 offen offset:0 sc1 lds
    s_add_u32 s24, s24, 49152
    buffer_load_dwordx4 v208, s[12:15], s26 offen offset:1024 sc1 lds
    s_cmp_eq_u32 s24, 147456
    buffer_load_dwordx4 v208, s[12:15], s26 offen offset:2048 sc1 lds
    s_cselect_b32 s24, 0, s24
    buffer_load_dwordx4 v208, s[12:15], s26 offen offset:3072 sc1 lds
    s_add_u32 s26, s26, 16384
    s_add_u32 m0, s24, s54
    s_sub_u32 s23, s23, 1
    s_cmp_lg_u32 s23, 0
    s_cbranch_scc1 M1_LDL
    s_waitcnt vmcnt(12)
    s_barrier
    s_waitcnt vmcnt(0)
    s_barrier
    s_cmp_eq_u32 s20, 4
    s_cbranch_scc0 M1_NGP
    s_lshl_b32 s28, s22, 10
    s_add_u32 s28, s28, 18022400
    v_and_b32 v16, 7, v1
    v_lshlrev_b32 v16, 7, v16
    s_mov_b32 s99, 0x40000
M1G_2_P:
    buffer_load_dword v17, v16, s[12:15], s28 offen offset:0 sc1
    s_waitcnt vmcnt(0)
    v_xor_b32 v17, s92, v17
    v_cmp_ne_u32 vcc, 0, v17
    s_sub_u32 s99, s99, 1
    s_cbranch_vccz M1G_2_D
    s_sleep 4
    s_cmp_lg_u32 s99, 0
    s_cbranch_scc1 M1G_2_P
M1G_2_D:
M1_NGP:
    s_barrier
    s_mov_b32 s8, s80
    s_and_b32 s9, s81, 0xffff
    s_mov_b32 s10, 0xe00000
    s_mov_b32 s11, 0x20000
    s_and_b32 s27, s20, 3
    s_lshr_b32 s28, s27, 1
    s_and_b32 s29, s27, 1
    v_lshrrev_b32 v4, 3, v1
    v_and_b32 v5, 7, v1
    v_and_b32 v6, 6, v4
    v_xor_b32 v5, v5, v6
    s_lshl_b32 s60, s29, 7
    s_lshl_b32 s61, s22, 8
    s_add_u32 s60, s60, s61
    v_lshlrev_b32 v4, 12, v4
    v_add_u32 v4, s60, v4
    v_lshl_add_u32 v6, v5, 4, v4
    v_add_u32_e64 v8, 0, v6
    v_add_u32 v9, 31744, v6
    v_add_u32 v10, 63488, v6
    v_add_u32 v11, 95232, v6
    v_lshrrev_b32 v4, 5, v1
    v_lshlrev_b32 v4, 14, v4
    v_add_u32 v20, v4, v8
    v_add_u32 v21, v4, v9
    v_add_u32 v21, 32768, v21
    v_add_u32_e64 v22, v4, v10
    v_add_u32 v22, 4294918144, v22
    v_add_u32_e64 v23, v4, v11
    v_add_u32 v23, 4294950912, v23
    s_lshl_b32 s32, s29, 12
    s_mul_i32 s31, s21, 917504
    s_add_u32 s31, s31, s32
    s_add_u32 s31, s31, 4194304
    v_lshl_add_u32 v7, v1, 4, s31
    s_lshl_b32 s30, s29, 13
    s_lshl_b32 s31, s28, 12
    s_add_u32 s30, s30, s31
    s_lshl_b32 s31, s27, 12
    s_add_u32 s31, s31, 16384
    s_mov_b32 s24, 0
    s_mov_b32 s33, 0
    s_lshl_b32 s34, s21, 13
    s_add_u32 s34, s34, 18350080
    v_and_b32 v4, 2, v3
    v_xor_b32_e64 v4, s27, v4
    v_lshl_add_u32 v4, v2, 2, v4
    v_lshlrev_b32 v16, 7, v4
    v_min_u32 v4, 1, v3
    v_lshl_add_u32 v16, v4, 16, v16
    s_mov_b32 s44, 0xffff
    s_mov_b32 s45, 0
    s_mov_b64 s[40:41], 0
    s_mov_b64 s[52:53], 0
    s_lshl_b32 s35, s28, 2
    s_and_b32 s36, s22, 12
    s_add_u32 s36, s36, 4
    s_sleep 40
    s_lshl_b32 s47, s33, 1
    s_add_u32 s47, s47, s28
    s_lshr_b32 s48, s33, 4
    s_add_u32 s48, s48, s35
    s_cmp_ge_u32 s33, 16
    s_cselect_b32 s38, 0x10000, 1
    s_cmp_ge_u32 s33, 48
    s_cselect_b32 s47, s47, s33
    s_cselect_b32 s48, 3, s48
    s_cselect_b32 s39, 1, 0
    s_add_u32 s47, s47, s36
    s_and_b32 s47, s47, 15
    s_lshl_b64 s[38:39], s[38:39], s47
    s_mul_i32 s47, s47, 7
    s_add_u32 s48, s48, s47
    s_mov_b32 s50, s31
    s_lshl_b32 s25, s48, 17
    s_cmp_eq_u32 s33, 48
    s_cbranch_scc1 L1W1_P
L1W1_D:
    s_andn2_b64 s[42:43], s[38:39], s[40:41]
    s_cbranch_scc1 L1G2_P
L1G2_D:
    s_add_u32 m0, s24, s30
    s_lshl_b32 s26, s48, 13
    buffer_load_dwordx4 v8, s[8:11], s25 offen offset:0 lds
    s_add_u32 s33, s33, 1
    s_lshl_b32 s47, s33, 1
    s_add_u32 s47, s47, s28
    s_lshr_b32 s48, s33, 4
    buffer_load_dwordx4 v9, s[8:11], s25 offen offset:1024 lds
    s_add_u32 s48, s48, s35
    s_cmp_ge_u32 s33, 16
    s_cselect_b32 s38, 0x10000, 1
    s_cmp_ge_u32 s33, 48
    buffer_load_dwordx4 v10, s[8:11], s25 offen offset:2048 lds
    s_cselect_b32 s47, s47, s33
    s_cselect_b32 s48, 3, s48
    s_cselect_b32 s39, 1, 0
    s_add_u32 s47, s47, s36
    buffer_load_dwordx4 v11, s[8:11], s25 offen offset:3072 lds
    s_mov_b32 m0, s50
    s_and_b32 s47, s47, 15
    s_lshl_b64 s[38:39], s[38:39], s47
    s_mul_i32 s47, s47, 7
    s_add_u32 s48, s48, s47
    buffer_load_dwordx4 v7, s[12:15], s26 offen offset:0 sc1 lds
    s_add_u32 s24, s24, 32768
    s_cmp_eq_u32 s24, 131072
    s_cselect_b32 s24, 0, s24
    s_add_u32 s50, s24, s31
    buffer_load_dwordx4 v7, s[12:15], s26 offen offset:1024 sc1 lds
    s_lshl_b32 s25, s48, 17
    s_cmp_eq_u32 s33, 48
    s_cbranch_scc1 L1W3_P
L1W3_D:
    s_andn2_b64 s[42:43], s[38:39], s[40:41]
    s_cbranch_scc1 L1G4_P
L1G4_D:
    buffer_load_dwordx4 v7, s[12:15], s26 offen offset:2048 sc1 lds
    buffer_load_dwordx4 v7, s[12:15], s26 offen offset:3072 sc1 lds
    s_add_u32 m0, s24, s30
    s_lshl_b32 s26, s48, 13
    buffer_load_dwordx4 v8, s[8:11], s25 offen offset:0 lds
    s_add_u32 s33, s33, 1
    s_lshl_b32 s47, s33, 1
    s_add_u32 s47, s47, s28
    s_lshr_b32 s48, s33, 4
    buffer_load_dwordx4 v9, s[8:11], s25 offen offset:1024 lds
    s_add_u32 s48, s48, s35
    s_cmp_ge_u32 s33, 16
    s_cselect_b32 s38, 0x10000, 1
    s_cmp_ge_u32 s33, 48
    buffer_load_dwordx4 v10, s[8:11], s25 offen offset:2048 lds
    s_cselect_b32 s47, s47, s33
    s_cselect_b32 s48, 3, s48
    s_cselect_b32 s39, 1, 0
    s_add_u32 s47, s47, s36
    buffer_load_dwordx4 v11, s[8:11], s25 offen offset:3072 lds
    s_mov_b32 m0, s50
    s_and_b32 s47, s47, 15
    s_lshl_b64 s[38:39], s[38:39], s47
    s_mul_i32 s47, s47, 7
    s_add_u32 s48, s48, s47
    buffer_load_dwordx4 v7, s[12:15], s26 offen offset:0 sc1 lds
    s_add_u32 s24, s24, 32768
    s_cmp_eq_u32 s24, 131072
    s_cselect_b32 s24, 0, s24
    s_add_u32 s50, s24, s31
    buffer_load_dwordx4 v7, s[12:15], s26 offen offset:1024 sc1 lds
    s_lshl_b32 s25, s48, 17
    s_cmp_eq_u32 s33, 48
    s_cbranch_scc1 L1W5_P
L1W5_D:
    s_andn2_b64 s[42:43], s[38:39], s[40:41]
    s_cbranch_scc1 L1G6_P
L1G6_D:
    buffer_load_dwordx4 v7, s[12:15], s26 offen offset:2048 sc1 lds
    buffer_load_dwordx4 v7, s[12:15], s26 offen offset:3072 sc1 lds
    s_add_u32 m0, s24, s30
    s_lshl_b32 s26, s48, 13
    s_waitcnt vmcnt(8)
    s_barrier
    buffer_load_dwordx4 v8, s[8:11], s25 offen offset:0 lds
    s_add_u32 s33, s33, 1
    s_lshl_b32 s47, s33, 1
    s_add_u32 s47, s47, s28
    s_lshr_b32 s48, s33, 4
    buffer_load_dwordx4 v9, s[8:11], s25 offen offset:1024 lds
    s_add_u32 s48, s48, s35
    s_cmp_ge_u32 s33, 16
    s_cselect_b32 s38, 0x10000, 1
    s_cmp_ge_u32 s33, 48
    buffer_load_dwordx4 v10, s[8:11], s25 offen offset:2048 lds
    s_cselect_b32 s47, s47, s33
    s_cselect_b32 s48, 3, s48
    s_cselect_b32 s39, 1, 0
    s_add_u32 s47, s47, s36
    buffer_load_dwordx4 v11, s[8:11], s25 offen offset:3072 lds
    s_mov_b32 m0, s50
    s_and_b32 s47, s47, 15
    s_lshl_b64 s[38:39], s[38:39], s47
    s_mul_i32 s47, s47, 7
    s_add_u32 s48, s48, s47
    buffer_load_dwordx4 v7, s[12:15], s26 offen offset:0 sc1 lds
    s_add_u32 s24, s24, 32768
    s_cmp_eq_u32 s24, 131072
    s_cselect_b32 s24, 0, s24
    s_add_u32 s50, s24, s31
    buffer_load_dwordx4 v7, s[12:15], s26 offen offset:1024 sc1 lds
    s_lshl_b32 s25, s48, 17
    s_cmp_eq_u32 s33, 48
    s_cbranch_scc1 L1W7_P
L1W7_D:
    s_andn2_b64 s[42:43], s[38:39], s[40:41]
    s_cbranch_scc1 L1G8_P
L1G8_D:
    buffer_load_dwordx4 v7, s[12:15], s26 offen offset:2048 sc1 lds
    buffer_load_dwordx4 v7, s[12:15], s26 offen offset:3072 sc1 lds
    s_add_u32 m0, s24, s30
    s_lshl_b32 s26, s48, 13
    s_waitcnt vmcnt(8)
    s_barrier
    buffer_load_dwordx4 v8, s[8:11], s25 offen offset:0 lds
    s_add_u32 s33, s33, 1
    s_lshl_b32 s47, s33, 1
    s_add_u32 s47, s47, s28
    s_lshr_b32 s48, s33, 4
    buffer_load_dwordx4 v9, s[8:11], s25 offen offset:1024 lds
    s_add_u32 s48, s48, s35
    s_cmp_ge_u32 s33, 16
    s_cselect_b32 s38, 0x10000, 1
    s_cmp_ge_u32 s33, 48
    buffer_load_dwordx4 v10, s[8:11], s25 offen offset:2048 lds
    s_cselect_b32 s47, s47, s33
    s_cselect_b32 s48, 3, s48
    s_cselect_b32 s39, 1, 0
    s_add_u32 s47, s47, s36
    buffer_load_dwordx4 v11, s[8:11], s25 offen offset:3072 lds
    s_mov_b32 m0, s50
    s_and_b32 s47, s47, 15
    s_lshl_b64 s[38:39], s[38:39], s47
    s_mul_i32 s47, s47, 7
    s_add_u32 s48, s48, s47
    buffer_load_dwordx4 v7, s[12:15], s26 offen offset:0 sc1 lds
    s_add_u32 s24, s24, 32768
    s_cmp_eq_u32 s24, 131072
    s_cselect_b32 s24, 0, s24
    s_add_u32 s50, s24, s31
    buffer_load_dwordx4 v7, s[12:15], s26 offen offset:1024 sc1 lds
    s_lshl_b32 s25, s48, 17
    s_cmp_eq_u32 s33, 48
    s_cbranch_scc1 L1W9_P
L1W9_D:
    s_andn2_b64 s[42:43], s[38:39], s[40:41]
    s_cbranch_scc1 L1G10_P
L1G10_D:
    buffer_load_dwordx4 v7, s[12:15], s26 offen offset:2048 sc1 lds
    buffer_load_dwordx4 v7, s[12:15], s26 offen offset:3072 sc1 lds
    s_add_u32 m0, s24, s30
    s_lshl_b32 s26, s48, 13
    s_waitcnt vmcnt(8)
    s_barrier
    buffer_load_dwordx4 v8, s[8:11], s25 offen offset:0 lds
    s_add_u32 s33, s33, 1
    s_lshl_b32 s47, s33, 1
    s_add_u32 s47, s47, s28
    s_lshr_b32 s48, s33, 4
    buffer_load_dwordx4 v9, s[8:11], s25 offen offset:1024 lds
    s_add_u32 s48, s48, s35
    s_cmp_ge_u32 s33, 16
    s_cselect_b32 s38, 0x10000, 1
    s_cmp_ge_u32 s33, 48
    buffer_load_dwordx4 v10, s[8:11], s25 offen offset:2048 lds
    s_cselect_b32 s47, s47, s33
    s_cselect_b32 s48, 3, s48
    s_cselect_b32 s39, 1, 0
    s_add_u32 s47, s47, s36
    buffer_load_dwordx4 v11, s[8:11], s25 offen offset:3072 lds
    s_mov_b32 m0, s50
    s_and_b32 s47, s47, 15
    s_lshl_b64 s[38:39], s[38:39], s47
    s_mul_i32 s47, s47, 7
    s_add_u32 s48, s48, s47
    buffer_load_dwordx4 v7, s[12:15], s26 offen offset:0 sc1 lds
    s_add_u32 s24, s24, 32768
    s_cmp_eq_u32 s24, 131072
    s_cselect_b32 s24, 0, s24
    s_add_u32 s50, s24, s31
    buffer_load_dwordx4 v7, s[12:15], s26 offen offset:1024 sc1 lds
    s_lshl_b32 s25, s48, 17
    s_cmp_eq_u32 s33, 48
    s_cbranch_scc1 L1W11_P
L1W11_D:
    s_andn2_b64 s[42:43], s[38:39], s[40:41]
    s_cbranch_scc1 L1G12_P
L1G12_D:
    buffer_load_dwordx4 v7, s[12:15], s26 offen offset:2048 sc1 lds
    buffer_load_dwordx4 v7, s[12:15], s26 offen offset:3072 sc1 lds
    s_add_u32 m0, s24, s30
    s_lshl_b32 s26, s48, 13
    s_waitcnt vmcnt(8)
    s_barrier
    buffer_load_dwordx4 v8, s[8:11], s25 offen offset:0 lds
    s_add_u32 s33, s33, 1
    s_lshl_b32 s47, s33, 1
    s_add_u32 s47, s47, s28
    s_lshr_b32 s48, s33, 4
    buffer_load_dwordx4 v9, s[8:11], s25 offen offset:1024 lds
    s_add_u32 s48, s48, s35
    s_cmp_ge_u32 s33, 16
    s_cselect_b32 s38, 0x10000, 1
    s_cmp_ge_u32 s33, 48
    buffer_load_dwordx4 v10, s[8:11], s25 offen offset:2048 lds
    s_cselect_b32 s47, s47, s33
    s_cselect_b32 s48, 3, s48
    s_cselect_b32 s39, 1, 0
    s_add_u32 s47, s47, s36
    buffer_load_dwordx4 v11, s[8:11], s25 offen offset:3072 lds
    s_mov_b32 m0, s50
    s_and_b32 s47, s47, 15
    s_lshl_b64 s[38:39], s[38:39], s47
    s_mul_i32 s47, s47, 7
    s_add_u32 s48, s48, s47
    buffer_load_dwordx4 v7, s[12:15], s26 offen offset:0 sc1 lds
    s_add_u32 s24, s24, 32768
    s_cmp_eq_u32 s24, 131072
    s_cselect_b32 s24, 0, s24
    s_add_u32 s50, s24, s31
    buffer_load_dwordx4 v7, s[12:15], s26 offen offset:1024 sc1 lds
    s_lshl_b32 s25, s48, 17
    s_cmp_eq_u32 s33, 48
    s_cbranch_scc1 L1W13_P
L1W13_D:
    s_andn2_b64 s[42:43], s[38:39], s[40:41]
    s_cbranch_scc1 L1G14_P
L1G14_D:
    buffer_load_dwordx4 v7, s[12:15], s26 offen offset:2048 sc1 lds
    buffer_load_dwordx4 v7, s[12:15], s26 offen offset:3072 sc1 lds
    s_add_u32 m0, s24, s30
    s_lshl_b32 s26, s48, 13
    s_waitcnt vmcnt(8)
    s_barrier
    buffer_load_dwordx4 v8, s[8:11], s25 offen offset:0 lds
    s_add_u32 s33, s33, 1
    s_lshl_b32 s47, s33, 1
    s_add_u32 s47, s47, s28
    s_lshr_b32 s48, s33, 4
    buffer_load_dwordx4 v9, s[8:11], s25 offen offset:1024 lds
    s_add_u32 s48, s48, s35
    s_cmp_ge_u32 s33, 16
    s_cselect_b32 s38, 0x10000, 1
    s_cmp_ge_u32 s33, 48
    buffer_load_dwordx4 v10, s[8:11], s25 offen offset:2048 lds
    s_cselect_b32 s47, s47, s33
    s_cselect_b32 s48, 3, s48
    s_cselect_b32 s39, 1, 0
    s_add_u32 s47, s47, s36
    buffer_load_dwordx4 v11, s[8:11], s25 offen offset:3072 lds
    s_mov_b32 m0, s50
    s_and_b32 s47, s47, 15
    s_lshl_b64 s[38:39], s[38:39], s47
    s_mul_i32 s47, s47, 7
    s_add_u32 s48, s48, s47
    buffer_load_dwordx4 v7, s[12:15], s26 offen offset:0 sc1 lds
    s_add_u32 s24, s24, 32768
    s_cmp_eq_u32 s24, 131072
    s_cselect_b32 s24, 0, s24
    s_add_u32 s50, s24, s31
    buffer_load_dwordx4 v7, s[12:15], s26 offen offset:1024 sc1 lds
    s_lshl_b32 s25, s48, 17
    s_cmp_eq_u32 s33, 48
    s_cbranch_scc1 L1W15_P
L1W15_D:
    s_andn2_b64 s[42:43], s[38:39], s[40:41]
    s_cbranch_scc1 L1G16_P
L1G16_D:
    buffer_load_dwordx4 v7, s[12:15], s26 offen offset:2048 sc1 lds
    buffer_load_dwordx4 v7, s[12:15], s26 offen offset:3072 sc1 lds
    s_add_u32 m0, s24, s30
    s_lshl_b32 s26, s48, 13
    s_mov_b32 s44, -1
    s_mov_b32 s45, 0xffff
    s_mov_b32 s23, 12
.p2align 6
L1_LOOP:
    s_waitcnt vmcnt(8)
    s_andn2_b64 s[52:53], s[44:45], s[40:41]
    s_cbranch_scc1 L1R17_P
L1R17_D:
    s_barrier
    buffer_load_dwordx4 v8, s[8:11], s25 offen offset:0 lds
    s_add_u32 s33, s33, 1
    s_lshl_b32 s47, s33, 1
    s_add_u32 s47, s47, s28
    s_lshr_b32 s48, s33, 4
    buffer_load_dwordx4 v9, s[8:11], s25 offen offset:1024 lds
    s_add_u32 s48, s48, s35
    s_cmp_ge_u32 s33, 16
    s_cselect_b32 s38, 0x10000, 1
    s_cmp_ge_u32 s33, 48
    buffer_load_dwordx4 v10, s[8:11], s25 offen offset:2048 lds
    s_cselect_b32 s47, s47, s33
    s_cselect_b32 s48, 3, s48
    s_cselect_b32 s39, 1, 0
    s_add_u32 s47, s47, s36
    buffer_load_dwordx4 v11, s[8:11], s25 offen offset:3072 lds
    s_mov_b32 m0, s50
    s_and_b32 s47, s47, 15
    s_lshl_b64 s[38:39], s[38:39], s47
    s_mul_i32 s47, s47, 7
    s_add_u32 s48, s48, s47
    buffer_load_dwordx4 v7, s[12:15], s26 offen offset:0 sc1 lds
    s_add_u32 s24, s24, 32768
    s_cmp_eq_u32 s24, 131072
    s_cselect_b32 s24, 0, s24
    s_add_u32 s50, s24, s31
    buffer_load_dwordx4 v7, s[12:15], s26 offen offset:1024 sc1 lds
    s_lshl_b32 s25, s48, 17
    s_cmp_eq_u32 s33, 48
    s_cbranch_scc1 L1W18_P
L1W18_D:
    s_andn2_b64 s[42:43], s[38:39], s[40:41]
    s_cbranch_scc1 L1G19_P
L1G19_D:
    buffer_load_dwordx4 v7, s[12:15], s26 offen offset:2048 sc1 lds
    buffer_load_dwordx4 v7, s[12:15], s26 offen offset:3072 sc1 lds
    s_add_u32 m0, s24, s30
    s_lshl_b32 s26, s48, 13
    s_waitcnt vmcnt(8)
    s_barrier
    buffer_load_dwordx4 v8, s[8:11], s25 offen offset:0 lds
    s_add_u32 s33, s33, 1
    s_lshl_b32 s47, s33, 1
    s_add_u32 s47, s47, s28
    s_lshr_b32 s48, s33, 4
    buffer_load_dwordx4 v9, s[8:11], s25 offen offset:1024 lds
    s_add_u32 s48, s48, s35
    s_cmp_ge_u32 s33, 16
    s_cselect_b32 s38, 0x10000, 1
    s_cmp_ge_u32 s33, 48
    buffer_load_dwordx4 v10, s[8:11], s25 offen offset:2048 lds
    s_cselect_b32 s47, s47, s33
    s_cselect_b32 s48, 3, s48
    s_cselect_b32 s39, 1, 0
    s_add_u32 s47, s47, s36
    buffer_load_dwordx4 v11, s[8:11], s25 offen offset:3072 lds
    s_mov_b32 m0, s50
    s_and_b32 s47, s47, 15
    s_lshl_b64 s[38:39], s[38:39], s47
    s_mul_i32 s47, s47, 7
    s_add_u32 s48, s48, s47
    buffer_load_dwordx4 v7, s[12:15], s26 offen offset:0 sc1 lds
    s_add_u32 s24, s24, 32768
    s_cmp_eq_u32 s24, 131072
    s_cselect_b32 s24, 0, s24
    s_add_u32 s50, s24, s31
    buffer_load_dwordx4 v7, s[12:15], s26 offen offset:1024 sc1 lds
    s_lshl_b32 s25, s48, 17
    s_cmp_eq_u32 s33, 48
    s_cbranch_scc1 L1W20_P
L1W20_D:
    s_andn2_b64 s[42:43], s[38:39], s[40:41]
    s_cbranch_scc1 L1G21_P
L1G21_D:
    buffer_load_dwordx4 v7, s[12:15], s26 offen offset:2048 sc1 lds
    buffer_load_dwordx4 v7, s[12:15], s26 offen offset:3072 sc1 lds
    s_add_u32 m0, s24, s30
    s_lshl_b32 s26, s48, 13
    s_waitcnt vmcnt(8)
    s_barrier
    buffer_load_dwordx4 v8, s[8:11], s25 offen offset:0 lds
    s_add_u32 s33, s33, 1
    s_lshl_b32 s47, s33, 1
    s_add_u32 s47, s47, s28
    s_lshr_b32 s48, s33, 4
    buffer_load_dwordx4 v9, s[8:11], s25 offen offset:1024 lds
    s_add_u32 s48, s48, s35
    s_cmp_ge_u32 s33, 16
    s_cselect_b32 s38, 0x10000, 1
    s_cmp_ge_u32 s33, 48
    buffer_load_dwordx4 v10, s[8:11], s25 offen offset:2048 lds
    s_cselect_b32 s47, s47, s33
    s_cselect_b32 s48, 3, s48
    s_cselect_b32 s39, 1, 0
    s_add_u32 s47, s47, s36
    buffer_load_dwordx4 v11, s[8:11], s25 offen offset:3072 lds
    s_mov_b32 m0, s50
    s_and_b32 s47, s47, 15
    s_lshl_b64 s[38:39], s[38:39], s47
    s_mul_i32 s47, s47, 7
    s_add_u32 s48, s48, s47
    buffer_load_dwordx4 v7, s[12:15], s26 offen offset:0 sc1 lds
    s_add_u32 s24, s24, 32768
    s_cmp_eq_u32 s24, 131072
    s_cselect_b32 s24, 0, s24
    s_add_u32 s50, s24, s31
    buffer_load_dwordx4 v7, s[12:15], s26 offen offset:1024 sc1 lds
    s_lshl_b32 s25, s48, 17
    s_cmp_eq_u32 s33, 48
    s_cbranch_scc1 L1W22_P
L1W22_D:
    s_andn2_b64 s[42:43], s[38:39], s[40:41]
    s_cbranch_scc1 L1G23_P
L1G23_D:
    buffer_load_dwordx4 v7, s[12:15], s26 offen offset:2048 sc1 lds
    buffer_load_dwordx4 v7, s[12:15], s26 offen offset:3072 sc1 lds
    s_add_u32 m0, s24, s30
    s_lshl_b32 s26, s48, 13
    s_waitcnt vmcnt(8)
    s_cmp_lg_u64 s[52:53], 0
    s_cbranch_scc1 L1R24_P
L1R24_D:
    s_barrier
    buffer_load_dwordx4 v8, s[8:11], s25 offen offset:0 lds
    s_add_u32 s33, s33, 1
    s_lshl_b32 s47, s33, 1
    s_add_u32 s47, s47, s28
    s_lshr_b32 s48, s33, 4
    buffer_load_dwordx4 v9, s[8:11], s25 offen offset:1024 lds
    s_add_u32 s48, s48, s35
    s_cmp_ge_u32 s33, 16
    s_cselect_b32 s38, 0x10000, 1
    s_cmp_ge_u32 s33, 48
    buffer_load_dwordx4 v10, s[8:11], s25 offen offset:2048 lds
    s_cselect_b32 s47, s47, s33
    s_cselect_b32 s48, 3, s48
    s_cselect_b32 s39, 1, 0
    s_add_u32 s47, s47, s36
    buffer_load_dwordx4 v11, s[8:11], s25 offen offset:3072 lds
    s_mov_b32 m0, s50
    s_and_b32 s47, s47, 15
    s_lshl_b64 s[38:39], s[38:39], s47
    s_mul_i32 s47, s47, 7
    s_add_u32 s48, s48, s47
    buffer_load_dwordx4 v7, s[12:15], s26 offen offset:0 sc1 lds
    s_add_u32 s24, s24, 32768
    s_cmp_eq_u32 s24, 131072
    s_cselect_b32 s24, 0, s24
    s_add_u32 s50, s24, s31
    buffer_load_dwordx4 v7, s[12:15], s26 offen offset:1024 sc1 lds
    s_lshl_b32 s25, s48, 17
    s_cmp_eq_u32 s33, 48
    s_cbranch_scc1 L1W25_P
L1W25_D:
    s_andn2_b64 s[42:43], s[38:39], s[40:41]
    s_cbranch_scc1 L1G26_P
L1G26_D:
    buffer_load_dwordx4 v7, s[12:15], s26 offen offset:2048 sc1 lds
    buffer_load_dwordx4 v7, s[12:15], s26 offen offset:3072 sc1 lds
    s_add_u32 m0, s24, s30
    s_lshl_b32 s26, s48, 13
    s_sub_u32 s23, s23, 1
    s_cmp_lg_u32 s23, 0
    s_cbranch_scc1 L1_LOOP
    s_nop 0
    s_waitcnt vmcnt(8)
    s_barrier
    buffer_load_dwordx4 v8, s[8:11], s25 offen offset:0 lds
    buffer_load_dwordx4 v9, s[8:11], s25 offen offset:1024 lds
    buffer_load_dwordx4 v10, s[8:11], s25 offen offset:2048 lds
    buffer_load_dwordx4 v11, s[8:11], s25 offen offset:3072 lds
    s_mov_b32 m0, s50
    s_nop 0
    buffer_load_dwordx4 v7, s[12:15], s26 offen offset:0 sc1 lds
    buffer_load_dwordx4 v7, s[12:15], s26 offen offset:1024 sc1 lds
    buffer_load_dwordx4 v7, s[12:15], s26 offen offset:2048 sc1 lds
    buffer_load_dwordx4 v7, s[12:15], s26 offen offset:3072 sc1 lds
    s_waitcnt vmcnt(8)
    s_barrier
    s_waitcnt vmcnt(0)
    s_barrier
    s_branch L1_GEND
L1W1_P:
    v_mov_b32 v8, v20
    v_mov_b32 v9, v21
    v_mov_b32 v10, v22
    v_mov_b32 v11, v23
    s_branch L1W1_D
L1G2_P:
    s_mov_b32 s99, 0x40000
L1G2_C:
    s_andn2_b64 exec, s[44:45], s[40:41]
    buffer_load_dword v17, v16, s[12:15], s34 offen sc1
    s_waitcnt vmcnt(0)
    v_cmp_eq_u32 vcc, s92, v17
    s_mov_b64 exec, -1
    s_or_b64 s[40:41], s[40:41], vcc
    s_andn2_b64 s[42:43], s[38:39], s[40:41]
    s_cbranch_scc0 L1G2_D
    s_sleep 3
    s_sub_u32 s99, s99, 1
    s_cmp_lg_u32 s99, 0
    s_cbranch_scc1 L1G2_C
    s_branch L1G2_D
L1W3_P:
    v_mov_b32 v8, v20
    v_mov_b32 v9, v21
    v_mov_b32 v10, v22
    v_mov_b32_e64 v11, v23
    s_branch L1W3_D
L1G4_P:
    s_mov_b32 s99, 0x40000
L1G4_C:
    s_andn2_b64 exec, s[44:45], s[40:41]
    buffer_load_dword v17, v16, s[12:15], s34 offen sc1
    s_waitcnt vmcnt(0)
    v_cmp_eq_u32 vcc, s92, v17
    s_mov_b64 exec, -1
    s_or_b64 s[40:41], s[40:41], vcc
    s_andn2_b64 s[42:43], s[38:39], s[40:41]
    s_cbranch_scc0 L1G4_D
    s_sleep 3
    s_sub_u32 s99, s99, 1
    s_cmp_lg_u32 s99, 0
    s_cbranch_scc1 L1G4_C
    s_branch L1G4_D
L1W5_P:
    v_mov_b32 v8, v20
    v_mov_b32 v9, v21
    v_mov_b32 v10, v22
    v_mov_b32_e64 v11, v23
    s_branch L1W5_D
L1G6_P:
    s_mov_b32 s99, 0x40000
L1G6_C:
    s_andn2_b64 exec, s[44:45], s[40:41]
    buffer_load_dword v17, v16, s[12:15], s34 offen sc1
    s_waitcnt vmcnt(0)
    v_cmp_eq_u32 vcc, s92, v17
    s_mov_b64 exec, -1
    s_or_b64 s[40:41], s[40:41], vcc
    s_andn2_b64 s[42:43], s[38:39], s[40:41]
    s_cbranch_scc0 L1G6_D
    s_sleep 3
    s_sub_u32 s99, s99, 1
    s_cmp_lg_u32 s99, 0
    s_cbranch_scc1 L1G6_C
    s_branch L1G6_D
L1W7_P:
    v_mov_b32 v8, v20
    v_mov_b32 v9, v21
    v_mov_b32 v10, v22
    v_mov_b32_e64 v11, v23
    s_branch L1W7_D
L1G8_P:
    s_mov_b32 s99, 0x40000
L1G8_C:
    s_andn2_b64 exec, s[44:45], s[40:41]
    buffer_load_dword v17, v16, s[12:15], s34 offen sc1
    s_waitcnt vmcnt(0)
    v_cmp_eq_u32 vcc, s92, v17
    s_mov_b64 exec, -1
    s_or_b64 s[40:41], s[40:41], vcc
    s_andn2_b64 s[42:43], s[38:39], s[40:41]
    s_cbranch_scc0 L1G8_D
    s_sleep 3
    s_sub_u32 s99, s99, 1
    s_cmp_lg_u32 s99, 0
    s_cbranch_scc1 L1G8_C
    s_branch L1G8_D
L1W9_P:
    v_mov_b32 v8, v20
    v_mov_b32 v9, v21
    v_mov_b32 v10, v22
    v_mov_b32_e64 v11, v23
    s_branch L1W9_D
L1G10_P:
    s_mov_b32 s99, 0x40000
L1G10_C:
    s_andn2_b64 exec, s[44:45], s[40:41]
    buffer_load_dword v17, v16, s[12:15], s34 offen sc1
    s_waitcnt vmcnt(0)
    v_cmp_eq_u32 vcc, s92, v17
    s_mov_b64 exec, -1
    s_or_b64 s[40:41], s[40:41], vcc
    s_andn2_b64 s[42:43], s[38:39], s[40:41]
    s_cbranch_scc0 L1G10_D
    s_sleep 3
    s_sub_u32 s99, s99, 1
    s_cmp_lg_u32 s99, 0
    s_cbranch_scc1 L1G10_C
    s_branch L1G10_D
L1W11_P:
    v_mov_b32 v8, v20
    v_mov_b32 v9, v21
    v_mov_b32 v10, v22
    v_mov_b32_e64 v11, v23
    s_branch L1W11_D
L1G12_P:
    s_mov_b32 s99, 0x40000
L1G12_C:
    s_andn2_b64 exec, s[44:45], s[40:41]
    buffer_load_dword v17, v16, s[12:15], s34 offen sc1
    s_waitcnt vmcnt(0)
    v_cmp_eq_u32 vcc, s92, v17
    s_mov_b64 exec, -1
    s_or_b64 s[40:41], s[40:41], vcc
    s_andn2_b64 s[42:43], s[38:39], s[40:41]
    s_cbranch_scc0 L1G12_D
    s_sleep 3
    s_sub_u32 s99, s99, 1
    s_cmp_lg_u32 s99, 0
    s_cbranch_scc1 L1G12_C
    s_branch L1G12_D
L1W13_P:
    v_mov_b32 v8, v20
    v_mov_b32 v9, v21
    v_mov_b32 v10, v22
    v_mov_b32_e64 v11, v23
    s_branch L1W13_D
L1G14_P:
    s_mov_b32 s99, 0x40000
L1G14_C:
    s_andn2_b64 exec, s[44:45], s[40:41]
    buffer_load_dword v17, v16, s[12:15], s34 offen sc1
    s_waitcnt vmcnt(0)
    v_cmp_eq_u32 vcc, s92, v17
    s_mov_b64 exec, -1
    s_or_b64 s[40:41], s[40:41], vcc
    s_andn2_b64 s[42:43], s[38:39], s[40:41]
    s_cbranch_scc0 L1G14_D
    s_sleep 3
    s_sub_u32 s99, s99, 1
    s_cmp_lg_u32 s99, 0
    s_cbranch_scc1 L1G14_C
    s_branch L1G14_D
L1W15_P:
    v_mov_b32 v8, v20
    v_mov_b32 v9, v21
    v_mov_b32 v10, v22
    v_mov_b32_e64 v11, v23
    s_branch L1W15_D
L1G16_P:
    s_mov_b32 s99, 0x40000
L1G16_C:
    s_andn2_b64 exec, s[44:45], s[40:41]
    buffer_load_dword v17, v16, s[12:15], s34 offen sc1
    s_waitcnt vmcnt(0)
    v_cmp_eq_u32_e64 vcc, s92, v17
    s_mov_b64 exec, -1
    s_or_b64 s[40:41], s[40:41], vcc
    s_andn2_b64 s[42:43], s[38:39], s[40:41]
    s_cbranch_scc0 L1G16_D
    s_sleep 3
    s_sub_u32 s99, s99, 1
    s_cmp_lg_u32 s99, 0
    s_cbranch_scc1 L1G16_C
    s_branch L1G16_D
L1R17_P:
    s_mov_b64 exec, s[52:53]
    buffer_load_dword v18, v16, s[12:15], s34 offen sc1
    s_mov_b64 exec, -1
    s_branch L1R17_D
L1W18_P:
    v_mov_b32 v8, v20
    v_mov_b32 v9, v21
    v_mov_b32 v10, v22
    v_mov_b32_e64 v11, v23
    s_branch L1W18_D
L1G19_P:
    s_mov_b32 s99, 0x40000
L1G19_C:
    s_andn2_b64 exec, s[44:45], s[40:41]
    buffer_load_dword v17, v16, s[12:15], s34 offen sc1
    s_waitcnt vmcnt(0)
    v_cmp_eq_u32 vcc, s92, v17
    s_mov_b64 exec, -1
    s_or_b64 s[40:41], s[40:41], vcc
    s_andn2_b64 s[42:43], s[38:39], s[40:41]
    s_cbranch_scc0 L1G19_D
    s_sleep 3
    s_sub_u32 s99, s99, 1
    s_cmp_lg_u32 s99, 0
    s_cbranch_scc1 L1G19_C
    s_branch L1G19_D
L1W20_P:
    v_mov_b32 v8, v20
    v_mov_b32 v9, v21
    v_mov_b32 v10, v22
    v_mov_b32_e64 v11, v23
    s_branch L1W20_D
L1G21_P:
    s_mov_b32 s99, 0x40000
L1G21_C:
    s_andn2_b64 exec, s[44:45], s[40:41]
    buffer_load_dword v17, v16, s[12:15], s34 offen sc1
    s_waitcnt vmcnt(0)
    v_cmp_eq_u32 vcc, s92, v17
    s_mov_b64 exec, -1
    s_or_b64 s[40:41], s[40:41], vcc
    s_andn2_b64 s[42:43], s[38:39], s[40:41]
    s_cbranch_scc0 L1G21_D
    s_sleep 3
    s_sub_u32 s99, s99, 1
    s_cmp_lg_u32 s99, 0
    s_cbranch_scc1 L1G21_C
    s_branch L1G21_D
L1W22_P:
    v_mov_b32 v8, v20
    v_mov_b32 v9, v21
    v_mov_b32 v10, v22
    v_mov_b32_e64 v11, v23
    s_branch L1W22_D
L1G23_P:
    s_mov_b32 s99, 0x40000
L1G23_C:
    s_andn2_b64 exec, s[44:45], s[40:41]
    buffer_load_dword v17, v16, s[12:15], s34 offen sc1
    s_waitcnt vmcnt(0)
    v_cmp_eq_u32 vcc, s92, v17
    s_mov_b64 exec, -1
    s_or_b64 s[40:41], s[40:41], vcc
    s_andn2_b64 s[42:43], s[38:39], s[40:41]
    s_cbranch_scc0 L1G23_D
    s_sleep 3
    s_sub_u32 s99, s99, 1
    s_cmp_lg_u32 s99, 0
    s_cbranch_scc1 L1G23_C
    s_branch L1G23_D
L1R24_P:
    s_mov_b64 exec, s[52:53]
    v_cmp_eq_u32 vcc, s92, v18
    s_mov_b64 exec, -1
    s_or_b64 s[40:41], s[40:41], vcc
    s_branch L1R24_D
L1W25_P:
    v_mov_b32 v8, v20
    v_mov_b32 v9, v21
    v_mov_b32 v10, v22
    v_mov_b32 v11, v23
    s_branch L1W25_D
L1G26_P:
    s_mov_b32 s99, 0x40000
L1G26_C:
    s_andn2_b64 exec, s[44:45], s[40:41]
    buffer_load_dword v17, v16, s[12:15], s34 offen sc1
    s_waitcnt vmcnt(0)
    v_cmp_eq_u32_e64 vcc, s92, v17
    s_mov_b64 exec, -1
    s_or_b64 s[40:41], s[40:41], vcc
    s_andn2_b64 s[42:43], s[38:39], s[40:41]
    s_cbranch_scc0 L1G26_D
    s_sleep 3
    s_sub_u32 s99, s99, 1
    s_cmp_lg_u32 s99, 0
    s_cbranch_scc1 L1G26_C
    s_branch L1G26_D
L1_GEND:
    s_endpgm
A_ROLE:
    s_sub_u32 s98, s98, 16
    s_and_b32 s21, s98, 7
    s_lshl_b32 s22, s93, 1
    s_lshr_b32 s29, s98, 3
    s_add_u32 s22, s22, s29
    s_and_b32 s56, s20, 3
    s_lshr_b32 s57, s20, 2
    s_mov_b32 s8, s66
    s_and_b32 s9, s67, 0xffff
    s_mov_b32 s10, 0x200000
    s_mov_b32 s11, 0x20000
    s_nop 0
    s_mov_b32 s16, s64
    s_and_b32 s17, s65, 0xffff
    s_mov_b32 s18, 0x400000
    s_mov_b32 s19, 0x20000
    s_sub_u32 s34, s2, 128
    s_lshl_b32 s34, s34, 3
    s_add_u32 s34, s34, s20
    s_lshl_b32 s34, s34, 7
    v_lshlrev_b32 v14, 17, v2
    s_mov_b64 exec, 0xffff
    buffer_load_dword v254, v14, s[8:11], s34 offen
    s_mov_b64 exec, -1
    v_lshlrev_b32 v77, 4, v1
    v_mov_b32 v112, 0
    v_mov_b32 v113, 0
    v_mov_b32 v114, 0
    v_mov_b32 v115, 0
    v_mov_b32 v116, 0
    v_mov_b32 v117, 0
    v_mov_b32 v118, 0
    v_mov_b32 v119, 0
    v_mov_b32 v120, 0
    v_mov_b32 v121, 0
    v_mov_b32 v122, 0
    v_mov_b32 v123, 0
    v_mov_b32 v124, 0
    v_mov_b32 v125, 0
    v_mov_b32 v126, 0
    v_mov_b32 v127, 0
    v_mov_b32 v128, 0
    v_mov_b32 v129, 0
    v_mov_b32 v130, 0
    v_mov_b32 v131, 0
    v_mov_b32 v132, 0
    v_mov_b32 v133, 0
    v_mov_b32 v134, 0
    v_mov_b32 v135, 0
    v_mov_b32 v136, 0
    v_mov_b32 v137, 0
    v_mov_b32 v138, 0
    v_mov_b32 v139, 0
    v_mov_b32 v140, 0
    v_mov_b32 v141, 0
    v_mov_b32 v142, 0
    v_mov_b32 v143, 0
    v_mov_b32 v68, 0
    v_mov_b32 v72, 0
    v_mov_b32 v60, 0
    v_mov_b32 v44, 0
    v_mov_b32 v69, 0
    v_mov_b32 v73, 0
    v_mov_b32 v61, 0
    v_mov_b32 v45, 0
    v_mov_b32 v70, 0
    v_mov_b32 v74, 0
    v_mov_b32 v62, 0
    v_mov_b32 v46, 0
    v_mov_b32 v71, 0
    v_mov_b32 v75, 0
    v_mov_b32 v63, 0
    v_mov_b32 v47, 0
    v_lshrrev_b32 v7, 2, v2
    v_xor_b32 v7, v7, v3
    v_and_b32 v7, 1, v7
    v_and_b32 v12, 3, v2
    v_or_b32 v7, v7, v12
    v_cmp_eq_u32 vcc, 0, v7
    v_mov_b32 v12, 0x3f803f80
    s_nop 0
    v_cndmask_b32 v64, 0, v12, vcc
    v_mov_b32 v65, v64
    v_mov_b32 v66, v64
    v_mov_b32 v67, v64
    s_lshl_b32 s34, s98, 3
    s_add_u32 s34, s34, s20
    s_lshl_b32 s35, s98, 2
    s_add_u32 s35, s35, s56
    s_lshl_b32 s35, s35, 2
    v_add_u32 v6, s35, v3
    s_movk_i32 s35, 7168
    v_mul_lo_u32 v6, v6, s35
    v_min_u32_e64 v7, 13, v2
    v_lshl_add_u32 v6, v7, 7, v6
    s_lshr_b32 s35, s93, 1
    s_mul_i32 s37, s35, 1792
    v_add_u32 v240, s37, v6
    s_mul_i32 s37, s98, 7
    s_lshl_b32 s38, s57, 2
    s_add_u32 s37, s37, s38
    s_lshl_b32 s37, s37, 2
    s_add_u32 s37, s37, s56
    s_lshl_b32 s37, s37, 3
    v_lshrrev_b32 v6, 3, v1
    v_add_u32 v6, s37, v6
    v_lshlrev_b32 v6, 12, v6
    v_and_b32 v7, 7, v1
    v_lshl_add_u32 v6, v7, 7, v6
    s_lshl_b32 s35, s35, 10
    v_add_u32_e64 v241, s35, v6
    s_lshr_b32 s34, s98, 2
    s_lshl_b32 s34, s34, 18
    s_and_b32 s35, s98, 3
    s_lshl_b32 s35, s35, 2
    s_add_u32 s35, s35, s56
    s_lshl_b32 s35, s35, 13
    s_add_u32 s34, s34, s35
    v_lshl_add_u32 v242, v1, 7, s34
    s_and_b32 s34, s93, 1
    s_lshl_b32 s34, s34, 2
    s_add_u32 s34, s34, s56
    s_mul_i32 s34, s34, 112
    s_mul_i32 s35, s98, 7
    s_add_u32 s34, s34, s35
    s_lshl_b32 s35, s57, 2
    s_add_u32 s34, s34, s35
    s_lshl_b32 s34, s34, 13
    s_add_u32 s34, s34, 4194304
    v_lshl_add_u32 v243, v1, 7, s34
    s_and_b32 s27, s20, 3
    s_lshr_b32 s28, s27, 1
    s_and_b32 s29, s27, 1
    v_lshrrev_b32 v4, 3, v1
    v_and_b32 v5, 7, v1
    v_and_b32 v6, 6, v4
    v_xor_b32 v5, v5, v6
    s_lshl_b32 s60, s29, 7
    s_lshl_b32 s61, s21, 8
    s_add_u32 s60, s60, s61
    v_lshlrev_b32 v4, 11, v4
    v_add_u32 v4, s60, v4
    v_lshl_add_u32 v6, v5, 4, v4
    v_add_u32_e64 v244, 0, v6
    v_add_u32 v245, 15360, v6
    v_add_u32 v246, 30720, v6
    v_add_u32 v247, 46080, v6
    s_lshl_b32 s34, s98, 2
    s_add_u32 s34, s34, s56
    s_lshr_b32 s58, s34, 3
    s_and_b32 s34, s34, 7
    s_lshr_b32 s35, s93, 1
    s_lshl_b32 s59, s35, 2
    s_add_u32 s59, s59, 4
    s_lshl_b32 s35, s35, 10
    s_lshl_b32 s37, s34, 14
    s_add_u32 s35, s35, s37
    v_lshrrev_b32 v6, 3, v1
    v_lshlrev_b32 v6, 12, v6
    v_and_b32_e64 v7, 7, v1
    v_lshl_add_u32 v6, v7, 7, v6
    v_add_u32_e64 v6, s35, v6
    s_and_b32 s35, s93, 1
    s_lshl_b32 s35, s35, 2
    s_lshr_b32 s37, s34, 1
    s_add_u32 s35, s35, s37
    s_mul_i32 s35, s35, 917504
    s_and_b32 s37, s34, 1
    s_lshl_b32 s37, s37, 12
    s_add_u32 s35, s35, s37
    s_add_u32 s35, s35, 4190208
    v_lshl_add_u32 v7, v1, 7, s35
    v_cmp_gt_u32 vcc, 32, v1
    v_mov_b32 v12, s90
    v_mov_b32 v13, s91
    v_mov_b32 v14, s80
    v_mov_b32 v15, s81
    v_cndmask_b32 v6, v7, v6, vcc
    v_cndmask_b32 v12, v12, v14, vcc
    v_cndmask_b32_e64 v13, v13, v15, vcc
    v_mov_b32 v14, 8192
    v_mov_b32 v15, 0x20000
    v_cndmask_b32 v249, v14, v15, vcc
    v_add_co_u32 v250, vcc, v12, v6
    s_nop 1
    v_addc_co_u32 v251, vcc, 0, v13, vcc
    s_lshl_b32 s34, s98, 2
    s_add_u32 s34, s34, s56
    s_mul_i32 s34, s34, 6
    v_add_u32 v248, s34, v1
    v_lshlrev_b32_e64 v248, 7, v248
    v_min_u32 v248, MK_END-MK_PC, v248
    s_cmp_ge_u32 s20, 4
    s_cbranch_scc1 AQ_LOADER
    s_lshr_b32 s27, s20, 1
    s_and_b32 s28, s20, 1
    v_lshrrev_b32_e64 v5, 2, v2
    v_lshl_add_u32 v6, v3, 3, v5
    v_lshlrev_b32 v6, 7, v6
    v_lshrrev_b32 v5, 1, v5
    v_and_b32_e64 v7, 1, v3
    v_lshl_add_u32 v5, v7, 1, v5
    v_lshl_add_u32 v6, v5, 5, v6
    v_and_b32_e64 v7, 3, v1
    v_lshl_add_u32 v6, v7, 3, v6
    s_lshl_b32 s60, s27, 13
    v_xor_b32 v7, 0, v6
    v_add_u32 v10, s60, v7
    v_xor_b32 v7, 32, v6
    v_add_u32 v11, s60, v7
    v_xor_b32 v7, 64, v6
    v_add_u32_e64 v12, s60, v7
    v_xor_b32 v7, 96, v6
    v_add_u32 v13, s60, v7
    v_and_b32 v5, 7, v2
    v_xor_b32 v5, v5, v3
    v_lshlrev_b32 v6, 7, v2
    v_lshl_add_u32 v6, v5, 4, v6
    s_lshl_b32 s60, s28, 13
    s_add_u32 s60, s60, 16384
    v_add_u32 v14, s60, v6
    v_xor_b32 v15, 64, v14
    s_mov_b32 s24, 0
    v_add_u32 v4, s24, v10
    v_add_u32 v5, s24, v11
    v_add_u32 v6, s24, v12
    v_add_u32 v7, s24, v13
    v_add_u32 v8, s24, v14
    v_add_u32_e64 v9, s24, v15
    s_waitcnt lgkmcnt(0)
    s_mul_i32 s92, s92, 1664525
    s_add_u32 s92, s92, 1013904223
    s_nop 0
    s_barrier
    ds_read_b128 v[176:179], v8 offset:0
    ds_read_b64_tr_b16 v[192:193], v4 offset:0
    ds_read_b64_tr_b16 v[194:195], v4 offset:512
    ds_read_b128 v[180:183], v8 offset:2048
    ds_read_b64_tr_b16 v[196:197], v5 offset:0
    ds_read_b64_tr_b16 v[198:199], v5 offset:512
    ds_read_b128 v[184:187], v8 offset:4096
    ds_read_b64_tr_b16 v[200:201], v6 offset:0
    ds_read_b64_tr_b16 v[202:203], v6 offset:512
    ds_read_b128 v[188:191], v8 offset:6144
    ds_read_b64_tr_b16 v[204:205], v7 offset:0
    ds_read_b64_tr_b16 v[206:207], v7 offset:512
    s_nop 0
    s_waitcnt lgkmcnt(0)
    v_mfma_f32_16x16x32_bf16 v[80:83], v[192:195], v[176:179], 0
    ds_read_b128 v[208:211], v9 offset:0
    ds_read_b64_tr_b16 v[224:225], v4 offset:4096
    v_mfma_f32_16x16x32_bf16 v[84:87], v[192:195], v[180:183], 0
    ds_read_b64_tr_b16 v[226:227], v4 offset:4608
    v_mfma_f32_16x16x32_bf16 v[100:103], v[196:199], v[180:183], 0
    ds_read_b128 v[212:215], v9 offset:2048
    v_mfma_f32_16x16x32_bf16 v[96:99], v[196:199], v[176:179], 0
    ds_read_b64_tr_b16 v[228:229], v5 offset:4096
    v_mfma_f32_16x16x32_bf16 v[144:147], v[200:203], v[176:179], 0
    ds_read_b64_tr_b16 v[230:231], v5 offset:4608
    v_mfma_f32_16x16x32_bf16 v[148:151], v[200:203], v[180:183], 0
    ds_read_b128 v[216:219], v9 offset:4096
    ds_read_b64_tr_b16 v[232:233], v6 offset:4096
    v_mfma_f32_16x16x32_bf16 v[164:167], v[204:207], v[180:183], 0
    ds_read_b64_tr_b16 v[234:235], v6 offset:4608
    v_mfma_f32_16x16x32_bf16 v[160:163], v[204:207], v[176:179], 0
    ds_read_b128 v[220:223], v9 offset:6144
    v_mfma_f32_16x16x32_bf16 v[168:171], v[204:207], v[184:187], 0
    ds_read_b64_tr_b16 v[236:237], v7 offset:4096
    v_mfma_f32_16x16x32_bf16 v[172:175], v[204:207], v[188:191], 0
    ds_read_b64_tr_b16 v[238:239], v7 offset:4608
    v_mfma_f32_16x16x32_bf16 v[156:159], v[200:203], v[188:191], 0
    s_add_u32 s24, s24, 32768
    s_cmp_eq_u32 s24, 131072
    v_mfma_f32_16x16x32_bf16 v[152:155], v[200:203], v[184:187], 0
    s_cselect_b32 s24, 0, s24
    v_add_u32 v4, s24, v10
    v_mfma_f32_16x16x32_bf16 v[104:107], v[196:199], v[184:187], 0
    v_add_u32 v5, s24, v11
    v_add_u32 v6, s24, v12
    v_mfma_f32_16x16x32_bf16 v[108:111], v[196:199], v[188:191], 0
    v_add_u32 v7, s24, v13
    v_add_u32 v8, s24, v14
    v_mfma_f32_16x16x32_bf16 v[92:95], v[192:195], v[188:191], 0
    v_add_u32_e64 v9, s24, v15
    v_mfma_f32_16x16x32_bf16 v[88:91], v[192:195], v[184:187], 0
    s_waitcnt lgkmcnt(0)
    s_barrier
    v_mfma_f32_16x16x32_bf16 v[80:83], v[224:227], v[208:211], v[80:83]
    ds_read_b128 v[176:179], v8 offset:0
    ds_read_b64_tr_b16 v[192:193], v4 offset:0
    v_mfma_f32_16x16x32_bf16 v[84:87], v[224:227], v[212:215], v[84:87]
    ds_read_b64_tr_b16 v[194:195], v4 offset:512
    v_mfma_f32_16x16x32_bf16 v[100:103], v[228:231], v[212:215], v[100:103]
    ds_read_b128 v[180:183], v8 offset:2048
    v_mfma_f32_16x16x32_bf16 v[96:99], v[228:231], v[208:211], v[96:99]
    ds_read_b64_tr_b16 v[196:197], v5 offset:0
    v_mfma_f32_16x16x32_bf16 v[144:147], v[232:235], v[208:211], v[144:147]
    ds_read_b64_tr_b16 v[198:199], v5 offset:512
    v_mfma_f32_16x16x32_bf16 v[148:151], v[232:235], v[212:215], v[148:151]
    ds_read_b128 v[184:187], v8 offset:4096
    ds_read_b64_tr_b16 v[200:201], v6 offset:0
    v_mfma_f32_16x16x32_bf16 v[164:167], v[236:239], v[212:215], v[164:167]
    ds_read_b64_tr_b16 v[202:203], v6 offset:512
    v_mfma_f32_16x16x32_bf16 v[160:163], v[236:239], v[208:211], v[160:163]
    ds_read_b128 v[188:191], v8 offset:6144
    v_mfma_f32_16x16x32_bf16 v[168:171], v[236:239], v[216:219], v[168:171]
    ds_read_b64_tr_b16 v[204:205], v7 offset:0
    v_mfma_f32_16x16x32_bf16 v[172:175], v[236:239], v[220:223], v[172:175]
    ds_read_b64_tr_b16 v[206:207], v7 offset:512
    v_mfma_f32_16x16x32_bf16 v[156:159], v[232:235], v[220:223], v[156:159]
    v_mfma_f32_16x16x32_bf16 v[152:155], v[232:235], v[216:219], v[152:155]
    v_mfma_f32_16x16x32_bf16 v[104:107], v[228:231], v[216:219], v[104:107]
    v_mfma_f32_16x16x32_bf16 v[108:111], v[228:231], v[220:223], v[108:111]
    v_mfma_f32_16x16x32_bf16 v[92:95], v[224:227], v[220:223], v[92:95]
    v_mfma_f32_16x16x32_bf16 v[88:91], v[224:227], v[216:219], v[88:91]
    s_waitcnt lgkmcnt(0)
    s_mov_b32 s23, 7
.p2align 6
C0_LOOP1:
    v_mfma_f32_16x16x32_bf16 v[80:83], v[192:195], v[176:179], v[80:83]
    ds_read_b128 v[208:211], v9 offset:0
    ds_read_b64_tr_b16 v[224:225], v4 offset:4096
    v_mfma_f32_16x16x32_bf16 v[84:87], v[192:195], v[180:183], v[84:87]
    ds_read_b64_tr_b16 v[226:227], v4 offset:4608
    v_mfma_f32_16x16x32_bf16 v[100:103], v[196:199], v[180:183], v[100:103]
    ds_read_b128 v[212:215], v9 offset:2048
    v_mfma_f32_16x16x32_bf16 v[96:99], v[196:199], v[176:179], v[96:99]
    ds_read_b64_tr_b16 v[228:229], v5 offset:4096
    v_mfma_f32_16x16x32_bf16 v[144:147], v[200:203], v[176:179], v[144:147]
    ds_read_b64_tr_b16 v[230:231], v5 offset:4608
    v_mfma_f32_16x16x32_bf16 v[148:151], v[200:203], v[180:183], v[148:151]
    ds_read_b128 v[216:219], v9 offset:4096
    ds_read_b64_tr_b16 v[232:233], v6 offset:4096
    v_mfma_f32_16x16x32_bf16 v[164:167], v[204:207], v[180:183], v[164:167]
    ds_read_b64_tr_b16 v[234:235], v6 offset:4608
    v_mfma_f32_16x16x32_bf16 v[160:163], v[204:207], v[176:179], v[160:163]
    ds_read_b128 v[220:223], v9 offset:6144
    v_mfma_f32_16x16x32_bf16 v[168:171], v[204:207], v[184:187], v[168:171]
    ds_read_b64_tr_b16 v[236:237], v7 offset:4096
    v_mfma_f32_16x16x32_bf16 v[172:175], v[204:207], v[188:191], v[172:175]
    ds_read_b64_tr_b16 v[238:239], v7 offset:4608
    v_mfma_f32_16x16x32_bf16 v[156:159], v[200:203], v[188:191], v[156:159]
    s_add_u32 s24, s24, 32768
    s_cmp_eq_u32 s24, 131072
    v_mfma_f32_16x16x32_bf16 v[152:155], v[200:203], v[184:187], v[152:155]
    s_cselect_b32 s24, 0, s24
    v_add_u32 v4, s24, v10
    v_mfma_f32_16x16x32_bf16 v[104:107], v[196:199], v[184:187], v[104:107]
    v_add_u32 v5, s24, v11
    v_add_u32 v6, s24, v12
    v_mfma_f32_16x16x32_bf16 v[108:111], v[196:199], v[188:191], v[108:111]
    v_add_u32 v7, s24, v13
    v_add_u32 v8, s24, v14
    v_mfma_f32_16x16x32_bf16 v[92:95], v[192:195], v[188:191], v[92:95]
    v_add_u32_e64 v9, s24, v15
    v_mfma_f32_16x16x32_bf16 v[88:91], v[192:195], v[184:187], v[88:91]
    s_waitcnt lgkmcnt(0)
    s_barrier
    v_mfma_f32_16x16x32_bf16 v[80:83], v[224:227], v[208:211], v[80:83]
    ds_read_b128 v[176:179], v8 offset:0
    ds_read_b64_tr_b16 v[192:193], v4 offset:0
    v_mfma_f32_16x16x32_bf16 v[84:87], v[224:227], v[212:215], v[84:87]
    ds_read_b64_tr_b16 v[194:195], v4 offset:512
    v_mfma_f32_16x16x32_bf16 v[100:103], v[228:231], v[212:215], v[100:103]
    ds_read_b128 v[180:183], v8 offset:2048
    v_mfma_f32_16x16x32_bf16 v[96:99], v[228:231], v[208:211], v[96:99]
    ds_read_b64_tr_b16 v[196:197], v5 offset:0
    v_mfma_f32_16x16x32_bf16 v[144:147], v[232:235], v[208:211], v[144:147]
    ds_read_b64_tr_b16 v[198:199], v5 offset:512
    v_mfma_f32_16x16x32_bf16 v[148:151], v[232:235], v[212:215], v[148:151]
    ds_read_b128 v[184:187], v8 offset:4096
    ds_read_b64_tr_b16 v[200:201], v6 offset:0
    v_mfma_f32_16x16x32_bf16 v[164:167], v[236:239], v[212:215], v[164:167]
    ds_read_b64_tr_b16 v[202:203], v6 offset:512
    v_mfma_f32_16x16x32_bf16 v[160:163], v[236:239], v[208:211], v[160:163]
    ds_read_b128 v[188:191], v8 offset:6144
    v_mfma_f32_16x16x32_bf16 v[168:171], v[236:239], v[216:219], v[168:171]
    ds_read_b64_tr_b16 v[204:205], v7 offset:0
    v_mfma_f32_16x16x32_bf16 v[172:175], v[236:239], v[220:223], v[172:175]
    ds_read_b64_tr_b16 v[206:207], v7 offset:512
    v_mfma_f32_16x16x32_bf16 v[156:159], v[232:235], v[220:223], v[156:159]
    v_mfma_f32_16x16x32_bf16 v[152:155], v[232:235], v[216:219], v[152:155]
    v_mfma_f32_16x16x32_bf16 v[104:107], v[228:231], v[216:219], v[104:107]
    v_mfma_f32_16x16x32_bf16 v[108:111], v[228:231], v[220:223], v[108:111]
    v_mfma_f32_16x16x32_bf16 v[92:95], v[224:227], v[220:223], v[92:95]
    v_mfma_f32_16x16x32_bf16 v[88:91], v[224:227], v[216:219], v[88:91]
    s_nop 0
    s_waitcnt lgkmcnt(0)
    v_mfma_f32_16x16x32_bf16 v[80:83], v[192:195], v[176:179], v[80:83]
    ds_read_b128 v[208:211], v9 offset:0
    ds_read_b64_tr_b16 v[224:225], v4 offset:4096
    v_mfma_f32_16x16x32_bf16 v[84:87], v[192:195], v[180:183], v[84:87]
    ds_read_b64_tr_b16 v[226:227], v4 offset:4608
    v_mfma_f32_16x16x32_bf16 v[100:103], v[196:199], v[180:183], v[100:103]
    ds_read_b128 v[212:215], v9 offset:2048
    v_mfma_f32_16x16x32_bf16 v[96:99], v[196:199], v[176:179], v[96:99]
    ds_read_b64_tr_b16 v[228:229], v5 offset:4096
    v_mfma_f32_16x16x32_bf16 v[144:147], v[200:203], v[176:179], v[144:147]
    ds_read_b64_tr_b16 v[230:231], v5 offset:4608
    v_mfma_f32_16x16x32_bf16 v[148:151], v[200:203], v[180:183], v[148:151]
    ds_read_b128 v[216:219], v9 offset:4096
    ds_read_b64_tr_b16 v[232:233], v6 offset:4096
    v_mfma_f32_16x16x32_bf16 v[164:167], v[204:207], v[180:183], v[164:167]
    ds_read_b64_tr_b16 v[234:235], v6 offset:4608
    v_mfma_f32_16x16x32_bf16 v[160:163], v[204:207], v[176:179], v[160:163]
    ds_read_b128 v[220:223], v9 offset:6144
    v_mfma_f32_16x16x32_bf16 v[168:171], v[204:207], v[184:187], v[168:171]
    ds_read_b64_tr_b16 v[236:237], v7 offset:4096
    v_mfma_f32_16x16x32_bf16 v[172:175], v[204:207], v[188:191], v[172:175]
    ds_read_b64_tr_b16 v[238:239], v7 offset:4608
    v_mfma_f32_16x16x32_bf16 v[156:159], v[200:203], v[188:191], v[156:159]
    s_add_u32 s24, s24, 32768
    s_cmp_eq_u32 s24, 131072
    v_mfma_f32_16x16x32_bf16 v[152:155], v[200:203], v[184:187], v[152:155]
    s_cselect_b32 s24, 0, s24
    v_add_u32 v4, s24, v10
    v_mfma_f32_16x16x32_bf16 v[104:107], v[196:199], v[184:187], v[104:107]
    v_add_u32 v5, s24, v11
    v_add_u32 v6, s24, v12
    v_mfma_f32_16x16x32_bf16 v[108:111], v[196:199], v[188:191], v[108:111]
    v_add_u32 v7, s24, v13
    v_add_u32 v8, s24, v14
    v_mfma_f32_16x16x32_bf16 v[92:95], v[192:195], v[188:191], v[92:95]
    v_add_u32_e64 v9, s24, v15
    v_mfma_f32_16x16x32_bf16 v[88:91], v[192:195], v[184:187], v[88:91]
    s_waitcnt lgkmcnt(0)
    s_barrier
    v_mfma_f32_16x16x32_bf16 v[80:83], v[224:227], v[208:211], v[80:83]
    ds_read_b128 v[176:179], v8 offset:0
    ds_read_b64_tr_b16 v[192:193], v4 offset:0
    v_mfma_f32_16x16x32_bf16 v[84:87], v[224:227], v[212:215], v[84:87]
    ds_read_b64_tr_b16 v[194:195], v4 offset:512
    v_mfma_f32_16x16x32_bf16 v[100:103], v[228:231], v[212:215], v[100:103]
    ds_read_b128 v[180:183], v8 offset:2048
    v_mfma_f32_16x16x32_bf16 v[96:99], v[228:231], v[208:211], v[96:99]
    ds_read_b64_tr_b16 v[196:197], v5 offset:0
    v_mfma_f32_16x16x32_bf16 v[144:147], v[232:235], v[208:211], v[144:147]
    ds_read_b64_tr_b16 v[198:199], v5 offset:512
    v_mfma_f32_16x16x32_bf16 v[148:151], v[232:235], v[212:215], v[148:151]
    ds_read_b128 v[184:187], v8 offset:4096
    ds_read_b64_tr_b16 v[200:201], v6 offset:0
    v_mfma_f32_16x16x32_bf16 v[164:167], v[236:239], v[212:215], v[164:167]
    ds_read_b64_tr_b16 v[202:203], v6 offset:512
    v_mfma_f32_16x16x32_bf16 v[160:163], v[236:239], v[208:211], v[160:163]
    ds_read_b128 v[188:191], v8 offset:6144
    v_mfma_f32_16x16x32_bf16 v[168:171], v[236:239], v[216:219], v[168:171]
    ds_read_b64_tr_b16 v[204:205], v7 offset:0
    v_mfma_f32_16x16x32_bf16 v[172:175], v[236:239], v[220:223], v[172:175]
    ds_read_b64_tr_b16 v[206:207], v7 offset:512
    v_mfma_f32_16x16x32_bf16 v[156:159], v[232:235], v[220:223], v[156:159]
    v_mfma_f32_16x16x32_bf16 v[152:155], v[232:235], v[216:219], v[152:155]
    v_mfma_f32_16x16x32_bf16 v[104:107], v[228:231], v[216:219], v[104:107]
    v_mfma_f32_16x16x32_bf16 v[108:111], v[228:231], v[220:223], v[108:111]
    v_mfma_f32_16x16x32_bf16 v[92:95], v[224:227], v[220:223], v[92:95]
    v_mfma_f32_16x16x32_bf16 v[88:91], v[224:227], v[216:219], v[88:91]
    s_waitcnt lgkmcnt(0)
    s_sub_u32 s23, s23, 1
    s_cmp_lg_u32 s23, 0
    s_cbranch_scc1 C0_LOOP1
    v_mfma_f32_16x16x32_bf16 v[80:83], v[192:195], v[176:179], v[80:83]
    ds_read_b128 v[208:211], v9 offset:0
    ds_read_b64_tr_b16 v[224:225], v4 offset:4096
    v_mfma_f32_16x16x32_bf16 v[84:87], v[192:195], v[180:183], v[84:87]
    ds_read_b64_tr_b16 v[226:227], v4 offset:4608
    v_mfma_f32_16x16x32_bf16 v[100:103], v[196:199], v[180:183], v[100:103]
    ds_read_b128 v[212:215], v9 offset:2048
    v_mfma_f32_16x16x32_bf16 v[96:99], v[196:199], v[176:179], v[96:99]
    ds_read_b64_tr_b16 v[228:229], v5 offset:4096
    v_mfma_f32_16x16x32_bf16 v[144:147], v[200:203], v[176:179], v[144:147]
    ds_read_b64_tr_b16 v[230:231], v5 offset:4608
    v_mfma_f32_16x16x32_bf16 v[148:151], v[200:203], v[180:183], v[148:151]
    ds_read_b128 v[216:219], v9 offset:4096
    ds_read_b64_tr_b16 v[232:233], v6 offset:4096
    v_mfma_f32_16x16x32_bf16 v[164:167], v[204:207], v[180:183], v[164:167]
    ds_read_b64_tr_b16 v[234:235], v6 offset:4608
    v_mfma_f32_16x16x32_bf16 v[160:163], v[204:207], v[176:179], v[160:163]
    ds_read_b128 v[220:223], v9 offset:6144
    v_mfma_f32_16x16x32_bf16 v[168:171], v[204:207], v[184:187], v[168:171]
    ds_read_b64_tr_b16 v[236:237], v7 offset:4096
    v_mfma_f32_16x16x32_bf16 v[172:175], v[204:207], v[188:191], v[172:175]
    ds_read_b64_tr_b16 v[238:239], v7 offset:4608
    v_mfma_f32_16x16x32_bf16 v[156:159], v[200:203], v[188:191], v[156:159]
    v_mfma_f32_16x16x32_bf16 v[152:155], v[200:203], v[184:187], v[152:155]
    v_mfma_f32_16x16x32_bf16 v[104:107], v[196:199], v[184:187], v[104:107]
    v_mfma_f32_16x16x32_bf16 v[108:111], v[196:199], v[188:191], v[108:111]
    v_mfma_f32_16x16x32_bf16 v[92:95], v[192:195], v[188:191], v[92:95]
    v_mfma_f32_16x16x32_bf16 v[88:91], v[192:195], v[184:187], v[88:91]
    s_nop 0
    s_waitcnt lgkmcnt(0)
    v_mfma_f32_16x16x32_bf16 v[80:83], v[224:227], v[208:211], v[80:83]
    v_mfma_f32_16x16x32_bf16 v[84:87], v[224:227], v[212:215], v[84:87]
    v_mfma_f32_16x16x32_bf16 v[100:103], v[228:231], v[212:215], v[100:103]
    v_mfma_f32_16x16x32_bf16 v[96:99], v[228:231], v[208:211], v[96:99]
    v_mfma_f32_16x16x32_bf16 v[144:147], v[232:235], v[208:211], v[144:147]
    v_mfma_f32_16x16x32_bf16 v[148:151], v[232:235], v[212:215], v[148:151]
    v_mfma_f32_16x16x32_bf16 v[164:167], v[236:239], v[212:215], v[164:167]
    v_mfma_f32_16x16x32_bf16 v[160:163], v[236:239], v[208:211], v[160:163]
    v_mfma_f32_16x16x32_bf16 v[168:171], v[236:239], v[216:219], v[168:171]
    v_mfma_f32_16x16x32_bf16 v[172:175], v[236:239], v[220:223], v[172:175]
    v_mfma_f32_16x16x32_bf16 v[156:159], v[232:235], v[220:223], v[156:159]
    v_mfma_f32_16x16x32_bf16 v[152:155], v[232:235], v[216:219], v[152:155]
    v_mfma_f32_16x16x32_bf16 v[104:107], v[228:231], v[216:219], v[104:107]
    v_mfma_f32_16x16x32_bf16 v[108:111], v[228:231], v[220:223], v[108:111]
    v_mfma_f32_16x16x32_bf16 v[92:95], v[224:227], v[220:223], v[92:95]
    v_mfma_f32_16x16x32_bf16 v[88:91], v[224:227], v[216:219], v[88:91]
    v_mov_b32 v14, 0x3e8293ee
    v_mov_b32 v15, 0x3e8293ee
    v_and_b32 v4, 1, v3
    v_lshlrev_b32 v4, 9, v4
    v_lshl_add_u32 v4, v2, 4, v4
    v_lshrrev_b32_e64 v5, 1, v3
    v_lshl_add_u32 v4, v5, 3, v4
    s_lshl_b32 s34, s27, 14
    s_lshl_b32 s35, s28, 12
    s_add_u32 s34, s34, s35
    s_add_u32 s34, s34, 65536
    v_add_u32 v4, s34, v4
    v_pk_mul_f32 v[80:81], v[80:81], v[14:15]
    v_pk_mul_f32 v[82:83], v[82:83], v[14:15]
    v_cvt_pk_bf16_f32 v176, v80, v81
    v_cvt_pk_bf16_f32 v177, v82, v83
    ds_write_b64 v4, v[176:177] offset:0
    v_pk_mul_f32 v[84:85], v[84:85], v[14:15]
    v_pk_mul_f32 v[86:87], v[86:87], v[14:15]
    v_cvt_pk_bf16_f32 v178, v84, v85
    v_cvt_pk_bf16_f32 v179, v86, v87
    ds_write_b64 v4, v[178:179] offset:256
    v_pk_mul_f32 v[88:89], v[88:89], v[14:15]
    v_pk_mul_f32 v[90:91], v[90:91], v[14:15]
    v_cvt_pk_bf16_f32 v180, v88, v89
    v_cvt_pk_bf16_f32 v181, v90, v91
    ds_write_b64 v4, v[180:181] offset:2048
    v_pk_mul_f32 v[92:93], v[92:93], v[14:15]
    v_pk_mul_f32 v[94:95], v[94:95], v[14:15]
    v_cvt_pk_bf16_f32 v182, v92, v93
    v_cvt_pk_bf16_f32 v183, v94, v95
    ds_write_b64 v4, v[182:183] offset:2304
    v_pk_mul_f32 v[96:97], v[96:97], v[14:15]
    v_pk_mul_f32 v[98:99], v[98:99], v[14:15]
    v_cvt_pk_bf16_f32 v184, v96, v97
    v_cvt_pk_bf16_f32 v185, v98, v99
    ds_write_b64 v4, v[184:185] offset:1024
    v_pk_mul_f32 v[100:101], v[100:101], v[14:15]
    v_pk_mul_f32 v[102:103], v[102:103], v[14:15]
    v_cvt_pk_bf16_f32 v186, v100, v101
    v_cvt_pk_bf16_f32 v187, v102, v103
    ds_write_b64 v4, v[186:187] offset:1280
    v_pk_mul_f32 v[104:105], v[104:105], v[14:15]
    v_pk_mul_f32 v[106:107], v[106:107], v[14:15]
    v_cvt_pk_bf16_f32 v188, v104, v105
    v_cvt_pk_bf16_f32 v189, v106, v107
    ds_write_b64 v4, v[188:189] offset:3072
    v_pk_mul_f32 v[108:109], v[108:109], v[14:15]
    v_pk_mul_f32 v[110:111], v[110:111], v[14:15]
    v_cvt_pk_bf16_f32 v190, v108, v109
    v_cvt_pk_bf16_f32 v191, v110, v111
    ds_write_b64 v4, v[190:191] offset:3328
    v_pk_mul_f32 v[144:145], v[144:145], v[14:15]
    v_pk_mul_f32 v[146:147], v[146:147], v[14:15]
    v_cvt_pk_bf16_f32 v192, v144, v145
    v_cvt_pk_bf16_f32 v193, v146, v147
    ds_write_b64 v4, v[192:193] offset:8192
    v_pk_mul_f32 v[148:149], v[148:149], v[14:15]
    v_pk_mul_f32 v[150:151], v[150:151], v[14:15]
    v_cvt_pk_bf16_f32 v194, v148, v149
    v_cvt_pk_bf16_f32 v195, v150, v151
    ds_write_b64 v4, v[194:195] offset:8448
    v_pk_mul_f32 v[152:153], v[152:153], v[14:15]
    v_pk_mul_f32 v[154:155], v[154:155], v[14:15]
    v_cvt_pk_bf16_f32 v196, v152, v153
    v_cvt_pk_bf16_f32 v197, v154, v155
    ds_write_b64 v4, v[196:197] offset:10240
    v_pk_mul_f32 v[156:157], v[156:157], v[14:15]
    v_pk_mul_f32 v[158:159], v[158:159], v[14:15]
    v_cvt_pk_bf16_f32 v198, v156, v157
    v_cvt_pk_bf16_f32 v199, v158, v159
    ds_write_b64 v4, v[198:199] offset:10496
    v_pk_mul_f32 v[160:161], v[160:161], v[14:15]
    v_pk_mul_f32 v[162:163], v[162:163], v[14:15]
    v_cvt_pk_bf16_f32 v200, v160, v161
    v_cvt_pk_bf16_f32 v201, v162, v163
    ds_write_b64 v4, v[200:201] offset:9216
    v_pk_mul_f32 v[164:165], v[164:165], v[14:15]
    v_pk_mul_f32 v[166:167], v[166:167], v[14:15]
    v_cvt_pk_bf16_f32 v202, v164, v165
    v_cvt_pk_bf16_f32 v203, v166, v167
    ds_write_b64 v4, v[202:203] offset:9472
    v_pk_mul_f32 v[168:169], v[168:169], v[14:15]
    v_pk_mul_f32 v[170:171], v[170:171], v[14:15]
    v_cvt_pk_bf16_f32 v204, v168, v169
    v_cvt_pk_bf16_f32 v205, v170, v171
    ds_write_b64 v4, v[204:205] offset:11264
    v_pk_mul_f32 v[172:173], v[172:173], v[14:15]
    v_pk_mul_f32 v[174:175], v[174:175], v[14:15]
    v_cvt_pk_bf16_f32 v206, v172, v173
    v_cvt_pk_bf16_f32 v207, v174, v175
    ds_write_b64 v4, v[206:207] offset:11520
    s_waitcnt lgkmcnt(0)
    s_branch AQ_JOIN
AQ_LOADER:
    v_lshrrev_b32 v4, 3, v1
    v_and_b32 v5, 7, v1
    v_and_b32 v6, 2, v4
    v_xor_b32 v5, v5, v6
    s_lshl_b32 s60, s29, 7
    s_lshl_b32 s61, s21, 8
    s_add_u32 s60, s60, s61
    v_lshlrev_b32 v4, 11, v4
    v_add_u32_e64 v4, s60, v4
    v_lshl_add_u32 v6, v5, 4, v4
    v_xor_b32_e64 v5, 4, v5
    v_lshl_add_u32 v5, v5, 4, v4
    v_add_u32_e64 v8, 0, v6
    v_add_u32 v9, 15360, v5
    v_add_u32 v10, 30720, v6
    v_add_u32 v11, 46080, v5
    v_lshrrev_b32 v4, 3, v1
    v_and_b32 v5, 7, v1
    v_xor_b32 v5, v5, v4
    s_lshl_b32 s34, s22, 7
    s_lshl_b32 s35, s27, 5
    s_add_u32 s34, s34, s35
    v_add_u32 v4, s34, v4
    v_lshlrev_b32 v4, 11, v4
    v_lshl_add_u32 v4, v5, 4, v4
    v_add_u32_e64 v12, 0, v4
    v_add_u32 v13, 15360, v4
    v_add_u32 v14, 30720, v4
    v_add_u32 v15, 46080, v4
    s_lshl_b32 s30, s29, 13
    s_lshl_b32 s31, s28, 12
    s_add_u32 s30, s30, s31
    s_lshl_b32 s31, s27, 12
    s_add_u32 s31, s31, 16384
    s_mov_b32 s24, 0
    s_and_b32 s26, s22, 1
    s_lshl_b32 s26, s26, 10
    s_and_b32 s26, s26, 2047
    s_nop 0
    s_lshl_b32 s25, s26, 10
    s_lshl_b32 s34, s28, 16
    s_add_u32 s25, s25, s34
    s_mov_b32 s50, s31
    s_mov_b32 m0, s30
    s_waitcnt vmcnt(0) lgkmcnt(0)
    s_mul_i32 s92, s92, 1664525
    s_add_u32 s92, s92, 1013904223
    buffer_load_dwordx4 v8, s[8:11], s25 offen offset:0 lds
    buffer_load_dwordx4 v9, s[8:11], s25 offen offset:1024 lds
    buffer_load_dwordx4 v10, s[8:11], s25 offen offset:2048 lds
    buffer_load_dwordx4 v11, s[8:11], s25 offen offset:3072 lds
    s_mov_b32 m0, s50
    s_nop 0
    buffer_load_dwordx4 v12, s[16:19], s26 offen offset:0 lds
    s_add_u32 s24, s24, 32768
    s_cmp_eq_u32 s24, 131072
    s_cselect_b32 s24, 0, s24
    s_add_u32 s50, s24, s31
    buffer_load_dwordx4 v13, s[16:19], s26 offen offset:1024 lds
    s_add_u32 s25, s25, 131072
    s_and_b32 s25, s25, 0x1fffff
    s_add_u32 s48, s26, 128
    buffer_load_dwordx4 v14, s[16:19], s26 offen offset:2048 lds
    buffer_load_dwordx4 v15, s[16:19], s26 offen offset:3072 lds
    s_nop 0
    s_add_u32 m0, s24, s30
    s_and_b32 s26, s48, 2047
    buffer_load_dwordx4 v8, s[8:11], s25 offen offset:0 lds
    buffer_load_dwordx4 v9, s[8:11], s25 offen offset:1024 lds
    buffer_load_dwordx4 v10, s[8:11], s25 offen offset:2048 lds
    buffer_load_dwordx4 v11, s[8:11], s25 offen offset:3072 lds
    s_mov_b32 m0, s50
    s_nop 0
    buffer_load_dwordx4 v12, s[16:19], s26 offen offset:0 lds
    s_add_u32 s24, s24, 32768
    s_cmp_eq_u32 s24, 131072
    s_cselect_b32 s24, 0, s24
    s_add_u32 s50, s24, s31
    buffer_load_dwordx4 v13, s[16:19], s26 offen offset:1024 lds
    s_add_u32 s25, s25, 131072
    s_and_b32 s25, s25, 0x1fffff
    s_add_u32 s48, s26, 128
    buffer_load_dwordx4 v14, s[16:19], s26 offen offset:2048 lds
    buffer_load_dwordx4 v15, s[16:19], s26 offen offset:3072 lds
    s_add_u32 m0, s24, s30
    s_and_b32 s26, s48, 2047
    s_nop 0
    s_waitcnt vmcnt(8)
    s_barrier
    buffer_load_dwordx4 v8, s[8:11], s25 offen offset:0 lds
    buffer_load_dwordx4 v9, s[8:11], s25 offen offset:1024 lds
    buffer_load_dwordx4 v10, s[8:11], s25 offen offset:2048 lds
    buffer_load_dwordx4 v11, s[8:11], s25 offen offset:3072 lds
    s_mov_b32 m0, s50
    s_nop 0
    buffer_load_dwordx4 v12, s[16:19], s26 offen offset:0 lds
    s_add_u32 s24, s24, 32768
    s_cmp_eq_u32 s24, 131072
    s_cselect_b32 s24, 0, s24
    s_add_u32 s50, s24, s31
    buffer_load_dwordx4 v13, s[16:19], s26 offen offset:1024 lds
    s_add_u32 s25, s25, 131072
    s_and_b32 s25, s25, 0x1fffff
    s_add_u32 s48, s26, 128
    buffer_load_dwordx4 v14, s[16:19], s26 offen offset:2048 lds
    buffer_load_dwordx4 v15, s[16:19], s26 offen offset:3072 lds
    s_add_u32 m0, s24, s30
    s_and_b32 s26, s48, 2047
    s_mov_b32 s23, 6
.p2align 6
AQ_LOOP:
    s_waitcnt vmcnt(8)
    s_barrier
    buffer_load_dwordx4 v8, s[8:11], s25 offen offset:0 lds
    buffer_load_dwordx4 v9, s[8:11], s25 offen offset:1024 lds
    buffer_load_dwordx4 v10, s[8:11], s25 offen offset:2048 lds
    buffer_load_dwordx4 v11, s[8:11], s25 offen offset:3072 lds
    s_mov_b32 m0, s50
    s_nop 0
    buffer_load_dwordx4 v12, s[16:19], s26 offen offset:0 lds
    s_add_u32 s24, s24, 32768
    s_cmp_eq_u32 s24, 131072
    s_cselect_b32 s24, 0, s24
    s_add_u32 s50, s24, s31
    buffer_load_dwordx4 v13, s[16:19], s26 offen offset:1024 lds
    s_add_u32 s25, s25, 131072
    s_and_b32 s25, s25, 0x1fffff
    s_add_u32 s48, s26, 128
    buffer_load_dwordx4 v14, s[16:19], s26 offen offset:2048 lds
    buffer_load_dwordx4 v15, s[16:19], s26 offen offset:3072 lds
    s_add_u32 m0, s24, s30
    s_and_b32 s26, s48, 2047
    s_nop 0
    s_waitcnt vmcnt(8)
    s_barrier
    buffer_load_dwordx4 v8, s[8:11], s25 offen offset:0 lds
    buffer_load_dwordx4 v9, s[8:11], s25 offen offset:1024 lds
    buffer_load_dwordx4 v10, s[8:11], s25 offen offset:2048 lds
    buffer_load_dwordx4 v11, s[8:11], s25 offen offset:3072 lds
    s_mov_b32 m0, s50
    s_nop 0
    buffer_load_dwordx4 v12, s[16:19], s26 offen offset:0 lds
    s_add_u32 s24, s24, 32768
    s_cmp_eq_u32 s24, 131072
    s_cselect_b32 s24, 0, s24
    s_add_u32 s50, s24, s31
    buffer_load_dwordx4 v13, s[16:19], s26 offen offset:1024 lds
    s_add_u32 s25, s25, 131072
    s_and_b32 s25, s25, 0x1fffff
    s_add_u32 s48, s26, 128
    buffer_load_dwordx4 v14, s[16:19], s26 offen offset:2048 lds
    buffer_load_dwordx4 v15, s[16:19], s26 offen offset:3072 lds
    s_add_u32 m0, s24, s30
    s_and_b32 s26, s48, 2047
    s_sub_u32 s23, s23, 1
    s_cmp_lg_u32 s23, 0
    s_cbranch_scc1 AQ_LOOP
    s_waitcnt vmcnt(8)
    s_barrier
    buffer_load_dwordx4 v8, s[8:11], s25 offen offset:0 lds
    buffer_load_dwordx4 v9, s[8:11], s25 offen offset:1024 lds
    buffer_load_dwordx4 v10, s[8:11], s25 offen offset:2048 lds
    buffer_load_dwordx4 v11, s[8:11], s25 offen offset:3072 lds
    s_mov_b32 m0, s50
    s_nop 0
    buffer_load_dwordx4 v12, s[16:19], s26 offen offset:0 lds
    buffer_load_dwordx4 v13, s[16:19], s26 offen offset:1024 lds
    buffer_load_dwordx4 v14, s[16:19], s26 offen offset:2048 lds
    buffer_load_dwordx4 v15, s[16:19], s26 offen offset:3072 lds
    s_waitcnt vmcnt(8)
    s_barrier
    s_cmp_eq_u32 s20, 4
    s_cbranch_scc0 AQ_NP
    s_mov_b32 s34, 17956864
    s_mov_b32 s35, 17965056
    v_lshlrev_b32_e64 v4, 7, v1
    s_mov_b32 s99, 0x40000
ATP_3_P:
    buffer_load_dword v12, v4, s[12:15], s34 offen offset:0 sc1
    buffer_load_dword v13, v4, s[12:15], s35 offen offset:0 sc1
    s_waitcnt vmcnt(0)
    v_xor_b32 v12, s92, v12
    v_xor_b32 v13, s92, v13
    v_or_b32 v12, v12, v13
    v_cmp_ne_u32 vcc, 0, v12
    s_sub_u32 s99, s99, 1
    s_cbranch_vccz ATP_3_D
    s_sleep 8
    s_cmp_lg_u32 s99, 0
    s_cbranch_scc1 ATP_3_P
ATP_3_D:
AQ_NP:
    s_waitcnt vmcnt(0)
    s_barrier
    s_mov_b32 s34, 17047552
    v_lshlrev_b32_e64 v12, 7, v1
    buffer_load_dword v13, v12, s[12:15], s34 offen sc1
    s_lshl_b32 s35, s27, 13
    s_add_u32 s34, s35, 16777216
    s_add_u32 m0, s35, 131072
    s_nop 0
    buffer_load_dwordx4 v77, s[12:15], s34 offen offset:0 sc1 lds
    buffer_load_dwordx4 v77, s[12:15], s34 offen offset:1024 sc1 lds
    buffer_load_dwordx4 v77, s[12:15], s34 offen offset:2048 sc1 lds
    buffer_load_dwordx4 v77, s[12:15], s34 offen offset:3072 sc1 lds
    s_add_u32 s34, s34, 4096
    s_add_u32 m0, s35, 135168
    s_nop 0
    s_nop 0
    buffer_load_dwordx4 v77, s[12:15], s34 offen offset:0 sc1 lds
    buffer_load_dwordx4 v77, s[12:15], s34 offen offset:1024 sc1 lds
    buffer_load_dwordx4 v77, s[12:15], s34 offen offset:2048 sc1 lds
    buffer_load_dwordx4 v77, s[12:15], s34 offen offset:3072 sc1 lds
    s_add_u32 s34, s34, 4096
    s_waitcnt vmcnt(8)
    s_nop 1
    v_max_f32_dpp v13, v13, v13 row_shr:1 row_mask:0xf bank_mask:0xf
    s_nop 1
    v_max_f32_dpp v13, v13, v13 row_shr:2 row_mask:0xf bank_mask:0xf
    s_nop 1
    v_max_f32_dpp v13, v13, v13 row_shr:4 row_mask:0xf bank_mask:0xf
    s_nop 1
    v_max_f32_dpp v13, v13, v13 row_shr:8 row_mask:0xf bank_mask:0xf
    s_nop 1
    v_max_f32_dpp v13, v13, v13 row_bcast:15 row_mask:0xa bank_mask:0xf
    s_nop 1
    v_max_f32_dpp v13, v13, v13 row_bcast:31 row_mask:0xc bank_mask:0xf
    s_nop 1
    v_mov_b32 v12, 0
    s_mov_b32 exec_lo, 0
    s_mov_b32 exec_hi, 0x80000000
    ds_write_b32 v12, v13 offset:57344
    s_mov_b64 exec, -1
    s_waitcnt vmcnt(0) lgkmcnt(0)
AQ_JOIN:
    s_barrier
    v_mov_b32_e64 v4, v77
    s_lshl_b32 s34, s57, 14
    s_lshl_b32 s35, s56, 11
    s_add_u32 s34, s34, s35
    s_add_u32 s34, s34, 65536
    v_add_u32 v12, s34, v4
    v_mov_b32 v13, 0
    ds_read_b128 v[16:19], v12
    ds_read_b128 v[20:23], v12 offset:1024
    ds_read_b128 v[24:27], v12 offset:8192
    ds_read_b128 v[28:31], v12 offset:9216
    ds_read_b32 v78, v13 offset:57344
    v_add_u32 v5, 131072, v4
    v_add_u32 v6, 147456, v4
    ds_read_b128 v[32:35], v5
    ds_read_b128 v[36:39], v5 offset:1024
    ds_read_b128 v[40:43], v5 offset:2048
    s_lshl_b32 s27, s20, 11
    s_add_u32 s28, s27, 16809984
    s_mov_b32 s24, s27
    s_waitcnt lgkmcnt(3)
    s_barrier
    v_mov_b32 v12, 0
    s_mov_b32 m0, s24
    v_dot2_f32_bf16 v12, v16, v16, v12
    v_dot2_f32_bf16 v13, v24, v24, v13
    s_add_u32 s24, s24, 16384
    v_dot2_f32_bf16 v12, v17, v17, v12
    v_dot2_f32_bf16 v13, v25, v25, v13
    buffer_load_dwordx4 v4, s[12:15], s28 offen sc1 lds
    v_dot2_f32_bf16 v12, v18, v18, v12
    v_dot2_f32_bf16 v13, v26, v26, v13
    buffer_load_dwordx4 v4, s[12:15], s28 offen offset:1024 sc1 lds
    v_dot2_f32_bf16 v12, v19, v19, v12
    v_dot2_f32_bf16 v13, v27, v27, v13
    s_add_u32 s28, s28, 16384
    v_dot2_f32_bf16 v12, v20, v20, v12
    v_dot2_f32_bf16 v13, v28, v28, v13
    s_nop 0
    s_mov_b32 m0, s24
    v_dot2_f32_bf16 v12, v21, v21, v12
    v_dot2_f32_bf16 v13, v29, v29, v13
    s_add_u32 s24, s24, 16384
    v_dot2_f32_bf16 v12, v22, v22, v12
    v_dot2_f32_bf16 v13, v30, v30, v13
    buffer_load_dwordx4 v4, s[12:15], s28 offen sc1 lds
    v_dot2_f32_bf16 v12, v23, v23, v12
    v_dot2_f32_bf16 v13, v31, v31, v13
    s_nop 2
    buffer_load_dwordx4 v4, s[12:15], s28 offen offset:1024 sc1 lds
    v_mov_b32 v14, v12
    v_mov_b32_e64 v15, v13
    s_add_u32 s28, s28, 16384
    s_nop 1
    v_permlane32_swap_b32 v12, v14
    s_mov_b32 m0, s24
    v_permlane32_swap_b32 v13, v15
    v_mul_f32 v78, 0x3f83d70a, v78
    s_add_u32 s24, s24, 16384
    v_add_f32 v12, v12, v14
    v_add_f32 v13, v13, v15
    buffer_load_dwordx4 v4, s[12:15], s28 offen sc1 lds
    v_mul_f32 v12, v12, v78
    v_mul_f32 v13, v13, v78
    buffer_load_dwordx4 v4, s[12:15], s28 offen offset:1024 sc1 lds
    v_sqrt_f32 v12, v12
    v_sqrt_f32 v13, v13
    s_add_u32 s28, s28, 16384
    v_mov_b32 v14, 0x42200000
    v_max_f32 v15, v12, v13
    v_cmp_nle_f32 vcc, v15, v14
    s_nop 1
    s_cbranch_vccnz AT_EXACT
AT_FAST:
    v_sub_f32 v144, 0, v12
    v_sub_f32 v160, 0, v13
    v_sub_f32 v145, 0, v12
    v_sub_f32 v161, 0, v13
    v_sub_f32 v146, 0, v12
    v_sub_f32 v162, 0, v13
    v_sub_f32 v147, 0, v12
    v_sub_f32 v163, 0, v13
    v_sub_f32 v148, 0, v12
    v_sub_f32 v164, 0, v13
    v_sub_f32 v149, 0, v12
    v_sub_f32 v165, 0, v13
    v_sub_f32 v150, 0, v12
    v_sub_f32 v166, 0, v13
    v_sub_f32 v151, 0, v12
    v_sub_f32 v167, 0, v13
    v_sub_f32 v152, 0, v12
    v_sub_f32 v168, 0, v13
    v_sub_f32 v153, 0, v12
    v_sub_f32 v169, 0, v13
    v_sub_f32 v154, 0, v12
    v_sub_f32 v170, 0, v13
    v_sub_f32 v155, 0, v12
    v_sub_f32 v171, 0, v13
    v_sub_f32 v156, 0, v12
    v_sub_f32 v172, 0, v13
    v_sub_f32 v157, 0, v12
    v_sub_f32 v173, 0, v13
    v_sub_f32 v158, 0, v12
    v_sub_f32 v174, 0, v13
    v_sub_f32 v159, 0, v12
    v_sub_f32_e64 v175, 0, v13
    s_cmp_eq_u32 s57, 0
    s_mov_b32 s40, 0xfcd5
    s_cselect_b32 s40, s40, 0x7ef5
    s_movk_i32 s41, 0x2222
    s_mov_b32 s23, 0
    s_mov_b32 s26, 147456
    s_waitcnt lgkmcnt(0)
    v_mfma_f32_32x32x16_bf16 v[80:95], v[32:35], v[16:19], v[144:159]
    v_mfma_f32_32x32x16_bf16 v[80:95], v[36:39], v[20:23], v[80:95]
    s_nop 8
    s_cmp_eq_u32 s57, 1
    s_cbranch_scc1 AT_MP1
AT_MP0:
    s_setprio 2
.p2align 6
AT_ML0:
    s_bitcmp1_b32 s40, s23
    s_cbranch_scc1 AT_EVT_0
AT_EBT_0:
    v_mfma_f32_32x32x16_bf16 v[96:111], v[32:35], v[24:27], v[160:175]
    v_exp_f32 v80, v80
    v_exp_f32 v81, v81
    v_exp_f32 v82, v82
    v_exp_f32 v83, v83
    v_mfma_f32_32x32x16_bf16 v[96:111], v[36:39], v[28:31], v[96:111]
    ds_read_b128 v[32:35], v5 offset:4096
    ds_read_b128 v[36:39], v5 offset:5120
    v_cvt_pk_bf16_f32 v48, v80, v81
    v_cvt_pk_bf16_f32 v49, v82, v83
    v_exp_f32 v84, v84
    v_exp_f32 v85, v85
    v_exp_f32_e64 v86, v86
    v_mfma_f32_32x32x16_bf16 v[128:143], v[44:47], v[60:63], v[128:143]
    ds_read_b128 v[44:47], v5 offset:3072
    v_exp_f32_e64 v87, v87
    v_cvt_pk_bf16_f32 v50, v84, v85
    v_cvt_pk_bf16_f32 v51, v86, v87
    v_exp_f32 v88, v88
    v_exp_f32 v89, v89
    v_mfma_f32_16x16x32_bf16 v[72:75], v[64:67], v[60:63], v[72:75]
    v_exp_f32_e64 v90, v90
    v_exp_f32_e64 v91, v91
    s_waitcnt lgkmcnt(3)
    v_mfma_f32_32x32x16_bf16 v[112:127], v[40:43], v[48:51], v[112:127]
    v_cvt_pk_bf16_f32 v52, v88, v89
    v_cvt_pk_bf16_f32 v53, v90, v91
    v_exp_f32 v92, v92
    v_exp_f32_e64 v93, v93
    v_exp_f32_e64 v94, v94
    v_mfma_f32_16x16x32_bf16 v[68:71], v[64:67], v[48:51], v[68:71]
    v_exp_f32_e64 v95, v95
    v_cvt_pk_bf16_f32 v54, v92, v93
    v_cvt_pk_bf16_f32 v55, v94, v95
    s_waitcnt lgkmcnt(1)
    v_mfma_f32_32x32x16_bf16 v[80:95], v[32:35], v[16:19], v[144:159]
    v_exp_f32 v96, v96
    v_exp_f32 v97, v97
    v_exp_f32 v98, v98
    v_exp_f32_e64 v99, v99
    v_mfma_f32_32x32x16_bf16 v[80:95], v[36:39], v[20:23], v[80:95]
    v_cvt_pk_bf16_f32 v56, v96, v97
    v_cvt_pk_bf16_f32 v57, v98, v99
    v_exp_f32 v100, v100
    v_exp_f32 v101, v101
    v_exp_f32 v102, v102
    s_waitcnt lgkmcnt(0)
    v_mfma_f32_32x32x16_bf16 v[112:127], v[44:47], v[52:55], v[112:127]
    v_exp_f32_e64 v103, v103
    v_cvt_pk_bf16_f32 v58, v100, v101
    v_cvt_pk_bf16_f32 v59, v102, v103
    v_exp_f32 v104, v104
    v_exp_f32 v105, v105
    v_mfma_f32_16x16x32_bf16 v[68:71], v[64:67], v[52:55], v[68:71]
    v_exp_f32 v106, v106
    v_exp_f32 v107, v107
    v_mfma_f32_32x32x16_bf16 v[128:143], v[40:43], v[56:59], v[128:143]
    ds_read_b128 v[40:43], v5 offset:6144
    v_cvt_pk_bf16_f32 v60, v104, v105
    v_cvt_pk_bf16_f32 v61, v106, v107
    v_exp_f32 v108, v108
    v_exp_f32 v109, v109
    v_exp_f32_e64 v110, v110
    v_mfma_f32_16x16x32_bf16 v[72:75], v[64:67], v[56:59], v[72:75]
    v_exp_f32_e64 v111, v111
    v_cvt_pk_bf16_f32 v62, v108, v109
    v_cvt_pk_bf16_f32 v63, v110, v111
    v_mfma_f32_32x32x16_bf16 v[96:111], v[32:35], v[24:27], v[160:175]
    v_exp_f32 v80, v80
    v_exp_f32 v81, v81
    v_exp_f32 v82, v82
    v_exp_f32 v83, v83
    v_mfma_f32_32x32x16_bf16 v[96:111], v[36:39], v[28:31], v[96:111]
    ds_read_b128 v[32:35], v5 offset:8192
    ds_read_b128 v[36:39], v5 offset:9216
    v_cvt_pk_bf16_f32 v48, v80, v81
    v_cvt_pk_bf16_f32 v49, v82, v83
    v_exp_f32 v84, v84
    v_exp_f32 v85, v85
    v_exp_f32_e64 v86, v86
    v_mfma_f32_32x32x16_bf16 v[128:143], v[44:47], v[60:63], v[128:143]
    ds_read_b128 v[44:47], v5 offset:7168
    v_exp_f32_e64 v87, v87
    v_cvt_pk_bf16_f32 v50, v84, v85
    v_cvt_pk_bf16_f32 v51, v86, v87
    v_exp_f32 v88, v88
    v_exp_f32 v89, v89
    v_mfma_f32_16x16x32_bf16 v[72:75], v[64:67], v[60:63], v[72:75]
    v_exp_f32_e64 v90, v90
    v_exp_f32_e64 v91, v91
    s_waitcnt lgkmcnt(3)
    v_mfma_f32_32x32x16_bf16 v[112:127], v[40:43], v[48:51], v[112:127]
    v_cvt_pk_bf16_f32 v52, v88, v89
    v_cvt_pk_bf16_f32 v53, v90, v91
    v_exp_f32 v92, v92
    v_exp_f32_e64 v93, v93
    v_exp_f32_e64 v94, v94
    v_mfma_f32_16x16x32_bf16 v[68:71], v[64:67], v[48:51], v[68:71]
    v_exp_f32_e64 v95, v95
    v_cvt_pk_bf16_f32 v54, v92, v93
    v_cvt_pk_bf16_f32 v55, v94, v95
    s_setprio 0
    s_waitcnt lgkmcnt(1)
    v_mfma_f32_32x32x16_bf16 v[80:95], v[32:35], v[16:19], v[144:159]
    v_exp_f32 v96, v96
    v_exp_f32 v97, v97
    v_exp_f32 v98, v98
    v_exp_f32 v99, v99
    v_mfma_f32_32x32x16_bf16 v[80:95], v[36:39], v[20:23], v[80:95]
    v_cvt_pk_bf16_f32 v56, v96, v97
    v_cvt_pk_bf16_f32 v57, v98, v99
    v_exp_f32 v100, v100
    v_exp_f32 v101, v101
    v_exp_f32 v102, v102
    s_waitcnt lgkmcnt(0)
    v_mfma_f32_32x32x16_bf16 v[112:127], v[44:47], v[52:55], v[112:127]
    v_exp_f32_e64 v103, v103
    v_cvt_pk_bf16_f32 v58, v100, v101
    v_cvt_pk_bf16_f32 v59, v102, v103
    v_exp_f32 v104, v104
    v_exp_f32 v105, v105
    v_mfma_f32_16x16x32_bf16 v[68:71], v[64:67], v[52:55], v[68:71]
    v_exp_f32 v106, v106
    v_exp_f32 v107, v107
    v_mfma_f32_32x32x16_bf16 v[128:143], v[40:43], v[56:59], v[128:143]
    ds_read_b128 v[40:43], v5 offset:10240
    v_cvt_pk_bf16_f32 v60, v104, v105
    v_cvt_pk_bf16_f32 v61, v106, v107
    v_exp_f32 v108, v108
    v_exp_f32 v109, v109
    v_exp_f32_e64 v110, v110
    v_mfma_f32_16x16x32_bf16 v[72:75], v[64:67], v[56:59], v[72:75]
    v_exp_f32 v111, v111
    s_setprio 2
    v_cvt_pk_bf16_f32 v62, v108, v109
    v_cvt_pk_bf16_f32 v63, v110, v111
    v_mfma_f32_32x32x16_bf16 v[96:111], v[32:35], v[24:27], v[160:175]
    v_exp_f32 v80, v80
    v_exp_f32 v81, v81
    v_exp_f32 v82, v82
    v_exp_f32 v83, v83
    v_mfma_f32_32x32x16_bf16 v[96:111], v[36:39], v[28:31], v[96:111]
    ds_read_b128 v[32:35], v5 offset:12288
    ds_read_b128 v[36:39], v5 offset:13312
    v_cvt_pk_bf16_f32 v48, v80, v81
    v_cvt_pk_bf16_f32 v49, v82, v83
    v_exp_f32 v84, v84
    v_exp_f32 v85, v85
    v_exp_f32_e64 v86, v86
    v_mfma_f32_32x32x16_bf16 v[128:143], v[44:47], v[60:63], v[128:143]
    ds_read_b128 v[44:47], v5 offset:11264
    v_exp_f32_e64 v87, v87
    v_cvt_pk_bf16_f32 v50, v84, v85
    v_cvt_pk_bf16_f32 v51, v86, v87
    v_exp_f32 v88, v88
    v_exp_f32 v89, v89
    v_mfma_f32_16x16x32_bf16 v[72:75], v[64:67], v[60:63], v[72:75]
    v_exp_f32_e64 v90, v90
    v_exp_f32_e64 v91, v91
    s_waitcnt lgkmcnt(3)
    v_mfma_f32_32x32x16_bf16 v[112:127], v[40:43], v[48:51], v[112:127]
    v_cvt_pk_bf16_f32 v52, v88, v89
    v_cvt_pk_bf16_f32 v53, v90, v91
    v_exp_f32 v92, v92
    v_exp_f32_e64 v93, v93
    v_exp_f32_e64 v94, v94
    v_mfma_f32_16x16x32_bf16 v[68:71], v[64:67], v[48:51], v[68:71]
    v_exp_f32_e64 v95, v95
    v_cvt_pk_bf16_f32 v54, v92, v93
    v_cvt_pk_bf16_f32 v55, v94, v95
    s_waitcnt lgkmcnt(1)
    v_mfma_f32_32x32x16_bf16 v[80:95], v[32:35], v[16:19], v[144:159]
    v_exp_f32 v96, v96
    v_exp_f32 v97, v97
    v_exp_f32 v98, v98
    v_exp_f32_e64 v99, v99
    v_mfma_f32_32x32x16_bf16 v[80:95], v[36:39], v[20:23], v[80:95]
    v_cvt_pk_bf16_f32 v56, v96, v97
    v_cvt_pk_bf16_f32 v57, v98, v99
    v_exp_f32 v100, v100
    v_exp_f32 v101, v101
    v_exp_f32 v102, v102
    s_waitcnt lgkmcnt(0)
    v_mfma_f32_32x32x16_bf16 v[112:127], v[44:47], v[52:55], v[112:127]
    v_exp_f32_e64 v103, v103
    v_cvt_pk_bf16_f32 v58, v100, v101
    v_cvt_pk_bf16_f32 v59, v102, v103
    v_exp_f32 v104, v104
    v_exp_f32 v105, v105
    v_mfma_f32_16x16x32_bf16 v[68:71], v[64:67], v[52:55], v[68:71]
    v_exp_f32 v106, v106
    v_exp_f32 v107, v107
    v_mfma_f32_32x32x16_bf16 v[128:143], v[40:43], v[56:59], v[128:143]
    ds_read_b128 v[40:43], v5 offset:14336
    v_cvt_pk_bf16_f32 v60, v104, v105
    v_cvt_pk_bf16_f32 v61, v106, v107
    v_exp_f32 v108, v108
    v_exp_f32 v109, v109
    v_exp_f32_e64 v110, v110
    v_mfma_f32_16x16x32_bf16 v[72:75], v[64:67], v[56:59], v[72:75]
    v_exp_f32_e64 v111, v111
    v_cvt_pk_bf16_f32 v62, v108, v109
    v_cvt_pk_bf16_f32 v63, v110, v111
    s_bitcmp1_b32 s41, s23
    s_cbranch_scc1 AT_EVB_0
AT_EBB_0:
    s_cmp_gt_u32 s23, 10
    s_cbranch_scc1 AT_NK_0
    s_nop 0
    s_mov_b32 m0, s24
    s_add_u32 s24, s24, 16384
    buffer_load_dwordx4 v4, s[12:15], s28 offen sc1 lds
    buffer_load_dwordx4 v4, s[12:15], s28 offen offset:1024 sc1 lds
    s_add_u32 s28, s28, 16384
    s_cmp_ge_u32 s24, 163840
    s_cselect_b32 s24, s27, s24
AT_NK_0:
    v_mfma_f32_32x32x16_bf16 v[96:111], v[32:35], v[24:27], v[160:175]
    v_exp_f32 v80, v80
    v_exp_f32 v81, v81
    v_exp_f32 v82, v82
    v_exp_f32_e64 v83, v83
    v_mfma_f32_32x32x16_bf16 v[96:111], v[36:39], v[28:31], v[96:111]
    ds_read_b128 v[32:35], v6 offset:0
    ds_read_b128 v[36:39], v6 offset:1024
    v_cvt_pk_bf16_f32 v48, v80, v81
    v_cvt_pk_bf16_f32 v49, v82, v83
    v_exp_f32 v84, v84
    v_exp_f32 v85, v85
    v_exp_f32_e64 v86, v86
    v_mfma_f32_32x32x16_bf16 v[128:143], v[44:47], v[60:63], v[128:143]
    ds_read_b128 v[44:47], v5 offset:15360
    v_exp_f32_e64 v87, v87
    v_cvt_pk_bf16_f32 v50, v84, v85
    v_cvt_pk_bf16_f32 v51, v86, v87
    v_exp_f32 v88, v88
    v_exp_f32 v89, v89
    v_mfma_f32_16x16x32_bf16 v[72:75], v[64:67], v[60:63], v[72:75]
    v_exp_f32_e64 v90, v90
    v_exp_f32_e64 v91, v91
    s_waitcnt lgkmcnt(3)
    v_mfma_f32_32x32x16_bf16 v[112:127], v[40:43], v[48:51], v[112:127]
    v_cvt_pk_bf16_f32 v52, v88, v89
    v_cvt_pk_bf16_f32 v53, v90, v91
    v_exp_f32 v92, v92
    v_exp_f32_e64 v93, v93
    v_exp_f32_e64 v94, v94
    v_mfma_f32_16x16x32_bf16 v[68:71], v[64:67], v[48:51], v[68:71]
    v_exp_f32_e64 v95, v95
    v_cvt_pk_bf16_f32 v54, v92, v93
    v_cvt_pk_bf16_f32 v55, v94, v95
    s_setprio 0
    s_waitcnt lgkmcnt(1)
    v_mfma_f32_32x32x16_bf16 v[80:95], v[32:35], v[16:19], v[144:159]
    v_exp_f32 v96, v96
    v_exp_f32 v97, v97
    v_exp_f32 v98, v98
    v_exp_f32 v99, v99
    v_mfma_f32_32x32x16_bf16 v[80:95], v[36:39], v[20:23], v[80:95]
    v_cvt_pk_bf16_f32 v56, v96, v97
    v_cvt_pk_bf16_f32 v57, v98, v99
    v_exp_f32 v100, v100
    v_exp_f32 v101, v101
    v_exp_f32 v102, v102
    s_waitcnt lgkmcnt(0)
    v_mfma_f32_32x32x16_bf16 v[112:127], v[44:47], v[52:55], v[112:127]
    v_exp_f32_e64 v103, v103
    v_cvt_pk_bf16_f32 v58, v100, v101
    v_cvt_pk_bf16_f32 v59, v102, v103
    v_exp_f32 v104, v104
    v_exp_f32 v105, v105
    v_mfma_f32_16x16x32_bf16 v[68:71], v[64:67], v[52:55], v[68:71]
    v_exp_f32 v106, v106
    v_exp_f32 v107, v107
    v_mfma_f32_32x32x16_bf16 v[128:143], v[40:43], v[56:59], v[128:143]
    ds_read_b128 v[40:43], v6 offset:2048
    s_add_u32 s26, s26, 16384
    s_cmp_ge_u32 s26, 163840
    s_cselect_b32 s26, 0, s26
    s_add_u32 s23, s23, 1
    v_cvt_pk_bf16_f32 v60, v104, v105
    v_cvt_pk_bf16_f32 v61, v106, v107
    v_exp_f32 v108, v108
    v_exp_f32 v109, v109
    v_exp_f32_e64 v110, v110
    v_mfma_f32_16x16x32_bf16 v[72:75], v[64:67], v[56:59], v[72:75]
    v_exp_f32 v111, v111
    s_setprio 2
    v_cvt_pk_bf16_f32 v62, v108, v109
    v_cvt_pk_bf16_f32 v63, v110, v111
    v_mov_b32 v5, v6
    v_add_u32 v6, s26, v4
    s_cmp_lt_u32 s23, 16
    s_cbranch_scc1 AT_ML0
    s_branch AT_MEND
AT_MP1:
    s_setprio 1
.p2align 6
AT_ML1:
    v_mfma_f32_32x32x16_bf16 v[96:111], v[32:35], v[24:27], v[160:175]
    v_exp_f32 v80, v80
    v_exp_f32 v81, v81
    v_exp_f32 v82, v82
    v_exp_f32 v83, v83
    v_mfma_f32_32x32x16_bf16 v[96:111], v[36:39], v[28:31], v[96:111]
    ds_read_b128 v[32:35], v5 offset:4096
    ds_read_b128 v[36:39], v5 offset:5120
    v_cvt_pk_bf16_f32 v48, v80, v81
    v_cvt_pk_bf16_f32 v49, v82, v83
    v_exp_f32 v84, v84
    v_exp_f32 v85, v85
    v_exp_f32_e64 v86, v86
    v_mfma_f32_32x32x16_bf16 v[128:143], v[44:47], v[60:63], v[128:143]
    ds_read_b128 v[44:47], v5 offset:3072
    v_exp_f32_e64 v87, v87
    v_cvt_pk_bf16_f32 v50, v84, v85
    v_cvt_pk_bf16_f32 v51, v86, v87
    v_exp_f32 v88, v88
    v_exp_f32 v89, v89
    v_mfma_f32_16x16x32_bf16 v[72:75], v[64:67], v[60:63], v[72:75]
    v_exp_f32_e64 v90, v90
    v_exp_f32_e64 v91, v91
    s_waitcnt lgkmcnt(3)
    v_mfma_f32_32x32x16_bf16 v[112:127], v[40:43], v[48:51], v[112:127]
    v_cvt_pk_bf16_f32 v52, v88, v89
    v_cvt_pk_bf16_f32 v53, v90, v91
    v_exp_f32 v92, v92
    v_exp_f32_e64 v93, v93
    v_exp_f32_e64 v94, v94
    v_mfma_f32_16x16x32_bf16 v[68:71], v[64:67], v[48:51], v[68:71]
    v_exp_f32_e64 v95, v95
    v_cvt_pk_bf16_f32 v54, v92, v93
    v_cvt_pk_bf16_f32 v55, v94, v95
    s_waitcnt lgkmcnt(1)
    v_mfma_f32_32x32x16_bf16 v[80:95], v[32:35], v[16:19], v[144:159]
    v_exp_f32 v96, v96
    v_exp_f32 v97, v97
    v_exp_f32 v98, v98
    v_exp_f32_e64 v99, v99
    v_mfma_f32_32x32x16_bf16 v[80:95], v[36:39], v[20:23], v[80:95]
    v_cvt_pk_bf16_f32 v56, v96, v97
    v_cvt_pk_bf16_f32 v57, v98, v99
    v_exp_f32 v100, v100
    v_exp_f32 v101, v101
    v_exp_f32 v102, v102
    s_waitcnt lgkmcnt(0)
    v_mfma_f32_32x32x16_bf16 v[112:127], v[44:47], v[52:55], v[112:127]
    v_exp_f32_e64 v103, v103
    v_cvt_pk_bf16_f32 v58, v100, v101
    v_cvt_pk_bf16_f32 v59, v102, v103
    v_exp_f32 v104, v104
    v_exp_f32 v105, v105
    v_mfma_f32_16x16x32_bf16 v[68:71], v[64:67], v[52:55], v[68:71]
    v_exp_f32 v106, v106
    v_exp_f32 v107, v107
    v_mfma_f32_32x32x16_bf16 v[128:143], v[40:43], v[56:59], v[128:143]
    ds_read_b128 v[40:43], v5 offset:6144
    v_cvt_pk_bf16_f32 v60, v104, v105
    v_cvt_pk_bf16_f32 v61, v106, v107
    v_exp_f32 v108, v108
    v_exp_f32 v109, v109
    v_exp_f32_e64 v110, v110
    v_mfma_f32_16x16x32_bf16 v[72:75], v[64:67], v[56:59], v[72:75]
    v_exp_f32_e64 v111, v111
    v_cvt_pk_bf16_f32 v62, v108, v109
    v_cvt_pk_bf16_f32 v63, v110, v111
    v_mfma_f32_32x32x16_bf16 v[96:111], v[32:35], v[24:27], v[160:175]
    v_exp_f32 v80, v80
    v_exp_f32 v81, v81
    v_exp_f32 v82, v82
    v_exp_f32 v83, v83
    v_mfma_f32_32x32x16_bf16 v[96:111], v[36:39], v[28:31], v[96:111]
    ds_read_b128 v[32:35], v5 offset:8192
    ds_read_b128 v[36:39], v5 offset:9216
    v_cvt_pk_bf16_f32 v48, v80, v81
    v_cvt_pk_bf16_f32 v49, v82, v83
    v_exp_f32 v84, v84
    v_exp_f32 v85, v85
    v_exp_f32_e64 v86, v86
    v_mfma_f32_32x32x16_bf16 v[128:143], v[44:47], v[60:63], v[128:143]
    ds_read_b128 v[44:47], v5 offset:7168
    v_exp_f32_e64 v87, v87
    v_cvt_pk_bf16_f32 v50, v84, v85
    v_cvt_pk_bf16_f32 v51, v86, v87
    v_exp_f32 v88, v88
    v_exp_f32 v89, v89
    v_mfma_f32_16x16x32_bf16 v[72:75], v[64:67], v[60:63], v[72:75]
    v_exp_f32_e64 v90, v90
    v_exp_f32_e64 v91, v91
    s_waitcnt lgkmcnt(3)
    v_mfma_f32_32x32x16_bf16 v[112:127], v[40:43], v[48:51], v[112:127]
    v_cvt_pk_bf16_f32 v52, v88, v89
    v_cvt_pk_bf16_f32 v53, v90, v91
    v_exp_f32 v92, v92
    v_exp_f32_e64 v93, v93
    v_exp_f32_e64 v94, v94
    v_mfma_f32_16x16x32_bf16 v[68:71], v[64:67], v[48:51], v[68:71]
    v_exp_f32_e64 v95, v95
    v_cvt_pk_bf16_f32 v54, v92, v93
    v_cvt_pk_bf16_f32 v55, v94, v95
    s_waitcnt lgkmcnt(1)
    v_mfma_f32_32x32x16_bf16 v[80:95], v[32:35], v[16:19], v[144:159]
    v_exp_f32 v96, v96
    v_exp_f32 v97, v97
    v_exp_f32 v98, v98
    v_exp_f32_e64 v99, v99
    v_mfma_f32_32x32x16_bf16 v[80:95], v[36:39], v[20:23], v[80:95]
    v_cvt_pk_bf16_f32 v56, v96, v97
    v_cvt_pk_bf16_f32 v57, v98, v99
    v_exp_f32 v100, v100
    v_exp_f32 v101, v101
    v_exp_f32 v102, v102
    s_waitcnt lgkmcnt(0)
    v_mfma_f32_32x32x16_bf16 v[112:127], v[44:47], v[52:55], v[112:127]
    v_exp_f32_e64 v103, v103
    v_cvt_pk_bf16_f32 v58, v100, v101
    v_cvt_pk_bf16_f32 v59, v102, v103
    v_exp_f32 v104, v104
    v_exp_f32 v105, v105
    v_mfma_f32_16x16x32_bf16 v[68:71], v[64:67], v[52:55], v[68:71]
    v_exp_f32 v106, v106
    v_exp_f32 v107, v107
    v_mfma_f32_32x32x16_bf16 v[128:143], v[40:43], v[56:59], v[128:143]
    ds_read_b128 v[40:43], v5 offset:10240
    v_cvt_pk_bf16_f32 v60, v104, v105
    v_cvt_pk_bf16_f32 v61, v106, v107
    v_exp_f32 v108, v108
    v_exp_f32 v109, v109
    v_exp_f32_e64 v110, v110
    v_mfma_f32_16x16x32_bf16 v[72:75], v[64:67], v[56:59], v[72:75]
    v_exp_f32_e64 v111, v111
    v_cvt_pk_bf16_f32 v62, v108, v109
    v_cvt_pk_bf16_f32 v63, v110, v111
    v_mfma_f32_32x32x16_bf16 v[96:111], v[32:35], v[24:27], v[160:175]
    v_exp_f32 v80, v80
    v_exp_f32 v81, v81
    v_exp_f32 v82, v82
    v_exp_f32 v83, v83
    v_mfma_f32_32x32x16_bf16 v[96:111], v[36:39], v[28:31], v[96:111]
    ds_read_b128 v[32:35], v5 offset:12288
    ds_read_b128 v[36:39], v5 offset:13312
    v_cvt_pk_bf16_f32 v48, v80, v81
    v_cvt_pk_bf16_f32 v49, v82, v83
    v_exp_f32 v84, v84
    v_exp_f32 v85, v85
    v_exp_f32_e64 v86, v86
    v_mfma_f32_32x32x16_bf16 v[128:143], v[44:47], v[60:63], v[128:143]
    ds_read_b128 v[44:47], v5 offset:11264
    v_exp_f32_e64 v87, v87
    v_cvt_pk_bf16_f32 v50, v84, v85
    v_cvt_pk_bf16_f32 v51, v86, v87
    v_exp_f32 v88, v88
    v_exp_f32 v89, v89
    v_mfma_f32_16x16x32_bf16 v[72:75], v[64:67], v[60:63], v[72:75]
    v_exp_f32_e64 v90, v90
    v_exp_f32_e64 v91, v91
    s_waitcnt lgkmcnt(3)
    v_mfma_f32_32x32x16_bf16 v[112:127], v[40:43], v[48:51], v[112:127]
    v_cvt_pk_bf16_f32 v52, v88, v89
    v_cvt_pk_bf16_f32 v53, v90, v91
    v_exp_f32 v92, v92
    v_exp_f32_e64 v93, v93
    v_exp_f32_e64 v94, v94
    v_mfma_f32_16x16x32_bf16 v[68:71], v[64:67], v[48:51], v[68:71]
    v_exp_f32_e64 v95, v95
    v_cvt_pk_bf16_f32 v54, v92, v93
    v_cvt_pk_bf16_f32 v55, v94, v95
    s_waitcnt lgkmcnt(1)
    v_mfma_f32_32x32x16_bf16 v[80:95], v[32:35], v[16:19], v[144:159]
    v_exp_f32 v96, v96
    v_exp_f32 v97, v97
    v_exp_f32 v98, v98
    v_exp_f32_e64 v99, v99
    v_mfma_f32_32x32x16_bf16 v[80:95], v[36:39], v[20:23], v[80:95]
    v_cvt_pk_bf16_f32 v56, v96, v97
    v_cvt_pk_bf16_f32 v57, v98, v99
    v_exp_f32 v100, v100
    v_exp_f32 v101, v101
    v_exp_f32 v102, v102
    s_waitcnt lgkmcnt(0)
    v_mfma_f32_32x32x16_bf16 v[112:127], v[44:47], v[52:55], v[112:127]
    v_exp_f32_e64 v103, v103
    v_cvt_pk_bf16_f32 v58, v100, v101
    v_cvt_pk_bf16_f32 v59, v102, v103
    v_exp_f32 v104, v104
    v_exp_f32 v105, v105
    v_mfma_f32_16x16x32_bf16 v[68:71], v[64:67], v[52:55], v[68:71]
    v_exp_f32 v106, v106
    v_exp_f32 v107, v107
    v_mfma_f32_32x32x16_bf16 v[128:143], v[40:43], v[56:59], v[128:143]
    ds_read_b128 v[40:43], v5 offset:14336
    v_cvt_pk_bf16_f32 v60, v104, v105
    v_cvt_pk_bf16_f32 v61, v106, v107
    v_exp_f32 v108, v108
    v_exp_f32 v109, v109
    v_exp_f32_e64 v110, v110
    v_mfma_f32_16x16x32_bf16 v[72:75], v[64:67], v[56:59], v[72:75]
    v_exp_f32_e64 v111, v111
    v_cvt_pk_bf16_f32 v62, v108, v109
    v_cvt_pk_bf16_f32 v63, v110, v111
    s_bitcmp1_b32 s41, s23
    s_cbranch_scc1 AT_EVB_1
AT_EBB_1:
    s_cmp_gt_u32 s23, 10
    s_cbranch_scc1 AT_NK_1
    s_nop 0
    s_mov_b32 m0, s24
    s_add_u32 s24, s24, 16384
    buffer_load_dwordx4 v4, s[12:15], s28 offen sc1 lds
    buffer_load_dwordx4 v4, s[12:15], s28 offen offset:1024 sc1 lds
    s_add_u32 s28, s28, 16384
    s_cmp_ge_u32 s24, 163840
    s_cselect_b32 s24, s27, s24
AT_NK_1:
    s_bitcmp1_b32 s40, s23
    s_cbranch_scc1 AT_EVT_1
AT_EBT_1:
    v_mfma_f32_32x32x16_bf16 v[96:111], v[32:35], v[24:27], v[160:175]
    v_exp_f32 v80, v80
    v_exp_f32 v81, v81
    v_exp_f32 v82, v82
    v_exp_f32_e64 v83, v83
    v_mfma_f32_32x32x16_bf16 v[96:111], v[36:39], v[28:31], v[96:111]
    ds_read_b128 v[32:35], v6 offset:0
    ds_read_b128 v[36:39], v6 offset:1024
    v_cvt_pk_bf16_f32 v48, v80, v81
    v_cvt_pk_bf16_f32 v49, v82, v83
    v_exp_f32 v84, v84
    v_exp_f32 v85, v85
    v_exp_f32_e64 v86, v86
    v_mfma_f32_32x32x16_bf16 v[128:143], v[44:47], v[60:63], v[128:143]
    ds_read_b128 v[44:47], v5 offset:15360
    v_exp_f32_e64 v87, v87
    v_cvt_pk_bf16_f32 v50, v84, v85
    v_cvt_pk_bf16_f32 v51, v86, v87
    v_exp_f32 v88, v88
    v_exp_f32 v89, v89
    v_mfma_f32_16x16x32_bf16 v[72:75], v[64:67], v[60:63], v[72:75]
    v_exp_f32_e64 v90, v90
    v_exp_f32_e64 v91, v91
    s_waitcnt lgkmcnt(3)
    v_mfma_f32_32x32x16_bf16 v[112:127], v[40:43], v[48:51], v[112:127]
    v_cvt_pk_bf16_f32 v52, v88, v89
    v_cvt_pk_bf16_f32 v53, v90, v91
    v_exp_f32 v92, v92
    v_exp_f32_e64 v93, v93
    v_exp_f32_e64 v94, v94
    v_mfma_f32_16x16x32_bf16 v[68:71], v[64:67], v[48:51], v[68:71]
    v_exp_f32_e64 v95, v95
    v_cvt_pk_bf16_f32 v54, v92, v93
    v_cvt_pk_bf16_f32 v55, v94, v95
    s_waitcnt lgkmcnt(1)
    v_mfma_f32_32x32x16_bf16 v[80:95], v[32:35], v[16:19], v[144:159]
    v_exp_f32 v96, v96
    v_exp_f32 v97, v97
    v_exp_f32 v98, v98
    v_exp_f32_e64 v99, v99
    v_mfma_f32_32x32x16_bf16 v[80:95], v[36:39], v[20:23], v[80:95]
    v_cvt_pk_bf16_f32 v56, v96, v97
    v_cvt_pk_bf16_f32 v57, v98, v99
    v_exp_f32 v100, v100
    v_exp_f32 v101, v101
    v_exp_f32 v102, v102
    s_waitcnt lgkmcnt(0)
    v_mfma_f32_32x32x16_bf16 v[112:127], v[44:47], v[52:55], v[112:127]
    v_exp_f32_e64 v103, v103
    v_cvt_pk_bf16_f32 v58, v100, v101
    v_cvt_pk_bf16_f32 v59, v102, v103
    v_exp_f32 v104, v104
    v_exp_f32 v105, v105
    v_mfma_f32_16x16x32_bf16 v[68:71], v[64:67], v[52:55], v[68:71]
    v_exp_f32 v106, v106
    v_exp_f32 v107, v107
    v_mfma_f32_32x32x16_bf16 v[128:143], v[40:43], v[56:59], v[128:143]
    ds_read_b128 v[40:43], v6 offset:2048
    s_add_u32 s26, s26, 16384
    s_cmp_ge_u32 s26, 163840
    s_cselect_b32 s26, 0, s26
    s_add_u32 s23, s23, 1
    v_cvt_pk_bf16_f32 v60, v104, v105
    v_cvt_pk_bf16_f32 v61, v106, v107
    v_exp_f32 v108, v108
    v_exp_f32 v109, v109
    v_exp_f32_e64 v110, v110
    v_mfma_f32_16x16x32_bf16 v[72:75], v[64:67], v[56:59], v[72:75]
    v_exp_f32_e64 v111, v111
    v_cvt_pk_bf16_f32 v62, v108, v109
    v_cvt_pk_bf16_f32 v63, v110, v111
    v_mov_b32 v5, v6
    v_add_u32 v6, s26, v4
    s_cmp_lt_u32 s23, 16
    s_cbranch_scc1 AT_ML1
AT_MEND:
    v_mfma_f32_32x32x16_bf16 v[128:143], v[44:47], v[60:63], v[128:143]
    v_mfma_f32_16x16x32_bf16 v[72:75], v[64:67], v[60:63], v[72:75]
    s_setprio 3
    s_lshl_b32 s34, s22, 18
    s_lshl_b32 s35, s21, 2
    s_lshl_b32 s33, s57, 1
    s_add_u32 s35, s35, s33
    s_lshl_b32 s35, s35, 13
    s_add_u32 s34, s34, s35
    s_lshl_b32 s36, s56, 11
    s_add_u32 s34, s34, s36
    s_add_u32 s34, s34, 12582912
    s_add_u32 s35, s34, 8192
    v_and_b32 v7, 1, v3
    v_lshlrev_b32 v7, 10, v7
    v_lshrrev_b32 v12, 1, v3
    v_lshl_add_u32 v7, v12, 8, v7
    v_lshl_add_u32 v7, v2, 4, v7
    s_lshl_b32 s33, s57, 15
    s_add_u32 s33, s33, s36
    s_add_u32 s33, s33, 81920
    v_add_u32 v8, s33, v7
    s_lshl_b32 s36, s22, 3
    s_add_u32 s36, s36, s21
    s_lshl_b32 s36, s36, 3
    s_add_u32 s36, s36, s20
    s_lshl_b32 s36, s36, 7
    s_add_u32 s36, s36, 18481152
    s_waitcnt vmcnt(0) lgkmcnt(0)
    v_rcp_f32 v12, v68
    s_nop 0
    v_mul_f32 v12, v12, v76
    v_mul_f32 v112, v112, v12
    v_mul_f32 v113, v113, v12
    v_mul_f32 v114, v114, v12
    v_mul_f32 v115, v115, v12
    v_mul_f32 v116, v116, v12
    v_mul_f32 v117, v117, v12
    v_mul_f32 v118, v118, v12
    v_mul_f32 v119, v119, v12
    v_mul_f32 v120, v120, v12
    v_mul_f32 v121, v121, v12
    v_mul_f32 v122, v122, v12
    v_mul_f32 v123, v123, v12
    v_mul_f32 v124, v124, v12
    v_mul_f32 v125, v125, v12
    v_mul_f32 v126, v126, v12
    v_mul_f32 v127, v127, v12
    v_cvt_pk_bf16_f32 v48, v112, v113
    v_cvt_pk_bf16_f32 v49, v114, v115
    v_cvt_pk_bf16_f32 v50, v120, v121
    v_cvt_pk_bf16_f32 v51, v122, v123
    buffer_store_dwordx4 v[48:51], v7, s[12:15], s34 offen offset:0 sc1
    ds_write_b128 v8, v[48:51] offset:0
    v_cvt_pk_bf16_f32 v52, v116, v117
    v_cvt_pk_bf16_f32 v53, v118, v119
    v_cvt_pk_bf16_f32 v54, v124, v125
    v_cvt_pk_bf16_f32 v55, v126, v127
    buffer_store_dwordx4 v[52:55], v7, s[12:15], s34 offen offset:512 sc1
    ds_write_b128 v8, v[52:55] offset:512
    v_rcp_f32 v12, v72
    s_nop 0
    v_mul_f32 v12, v12, v76
    v_mul_f32 v128, v128, v12
    v_mul_f32 v129, v129, v12
    v_mul_f32 v130, v130, v12
    v_mul_f32 v131, v131, v12
    v_mul_f32 v132, v132, v12
    v_mul_f32 v133, v133, v12
    v_mul_f32 v134, v134, v12
    v_mul_f32 v135, v135, v12
    v_mul_f32 v136, v136, v12
    v_mul_f32 v137, v137, v12
    v_mul_f32 v138, v138, v12
    v_mul_f32 v139, v139, v12
    v_mul_f32 v140, v140, v12
    v_mul_f32 v141, v141, v12
    v_mul_f32 v142, v142, v12
    v_mul_f32_e64 v143, v143, v12
    v_cvt_pk_bf16_f32 v56, v128, v129
    v_cvt_pk_bf16_f32 v57, v130, v131
    v_cvt_pk_bf16_f32 v58, v136, v137
    v_cvt_pk_bf16_f32 v59, v138, v139
    buffer_store_dwordx4 v[56:59], v7, s[12:15], s35 offen offset:0 sc1
    ds_write_b128 v8, v[56:59] offset:8192
    v_cvt_pk_bf16_f32 v60, v132, v133
    v_cvt_pk_bf16_f32 v61, v134, v135
    v_cvt_pk_bf16_f32 v62, v140, v141
    v_cvt_pk_bf16_f32 v63, v142, v143
    buffer_store_dwordx4 v[60:63], v7, s[12:15], s35 offen offset:512 sc1
    ds_write_b128 v8, v[60:63] offset:8704
    s_setprio 0
    s_cmp_ge_u32 s20, 4
    s_cbranch_scc1 AO_LOADER
    s_lshr_b32 s27, s20, 1
    s_and_b32 s28, s20, 1
    v_lshrrev_b32 v5, 2, v1
    v_lshlrev_b32 v6, 7, v5
    v_lshrrev_b32 v5, 1, v5
    v_and_b32_e64 v5, 3, v5
    v_lshl_add_u32 v6, v5, 5, v6
    v_and_b32_e64 v7, 3, v1
    v_lshl_add_u32 v6, v7, 3, v6
    s_lshl_b32 s60, s27, 13
    v_xor_b32 v7, 0, v6
    v_add_u32 v10, s60, v7
    v_xor_b32 v7, 32, v6
    v_add_u32 v11, s60, v7
    v_xor_b32 v7, 64, v6
    v_add_u32_e64 v12, s60, v7
    v_xor_b32 v7, 96, v6
    v_add_u32 v13, s60, v7
    s_lshl_b32 s60, s28, 12
    s_add_u32 s60, s60, 16384
    v_lshl_add_u32 v14, v1, 4, s60
    s_mov_b32 s24, 65536
    v_add_u32 v4, s24, v10
    v_add_u32 v5, s24, v11
    v_add_u32 v6, s24, v12
    v_add_u32 v7, s24, v13
    v_add_u32 v8, s24, v14
    s_mov_b32 s48, s86
    s_and_b32 s49, s87, 0xffff
    s_mov_b32 s50, 0x400000
    s_mov_b32 s51, 0x20000
    s_lshl_b32 s37, s22, 3
    s_add_u32 s37, s37, s21
    s_lshl_b32 s37, s37, 2
    s_add_u32 s37, s37, s20
    s_lshl_b32 s38, s37, 7
    s_add_u32 s38, s38, 18153472
    s_lshl_b32 s37, s37, 13
    s_add_u32 s37, s37, 33554432
    s_add_u32 s39, s37, 4096
    s_mov_b32 s33, 0
    v_lshlrev_b32 v80, 4, v1
    v_mov_b32 v82, 0
    s_lshl_b32 s29, s22, 7
    s_lshl_b32 s30, s28, 6
    s_add_u32 s29, s29, s30
    v_and_b32 v83, 7, v2
    v_add_u32 v83, s29, v83
    v_lshlrev_b32 v83, 11, v83
    s_lshl_b32 s30, s21, 8
    s_lshl_b32 s31, s27, 7
    s_add_u32 s30, s30, s31
    v_add_u32 v83, s30, v83
    v_and_b32 v81, 1, v3
    v_lshl_add_u32 v83, v81, 5, v83
    v_lshrrev_b32_e64 v81, 1, v3
    v_lshl_add_u32 v83, v81, 4, v83
    v_lshrrev_b32_e64 v81, 3, v2
    v_lshl_add_u32 v83, v81, 6, v83
    s_nop 0
    s_mov_b32 s40, 0
    s_mov_b32 s41, 16384
    s_mov_b32 s42, 32768
    s_mov_b32 s43, 49152
    s_mov_b32 s44, 65536
    s_mov_b32 s45, 81920
    s_mov_b32 s46, 98304
    s_mov_b32 s47, 114688
    s_waitcnt lgkmcnt(0)
    s_barrier
    ds_read_b128 v[16:19], v8 offset:0
    ds_read_b64_tr_b16 v[32:33], v4 offset:0
    ds_read_b64_tr_b16 v[34:35], v4 offset:2048
    ds_read_b128 v[20:23], v8 offset:1024
    ds_read_b64_tr_b16 v[36:37], v5 offset:0
    ds_read_b64_tr_b16 v[38:39], v5 offset:2048
    ds_read_b128 v[24:27], v8 offset:2048
    ds_read_b64_tr_b16 v[40:41], v6 offset:0
    ds_read_b64_tr_b16 v[42:43], v6 offset:2048
    ds_read_b128 v[28:31], v8 offset:3072
    ds_read_b64_tr_b16 v[44:45], v7 offset:0
    ds_read_b64_tr_b16 v[46:47], v7 offset:2048
    s_nop 0
    s_waitcnt lgkmcnt(0)
    v_mfma_f32_16x16x32_bf16 v[128:131], v[32:35], v[16:19], 0
    ds_read_b128 v[48:51], v8 offset:8192
    ds_read_b64_tr_b16 v[64:65], v4 offset:4096
    v_mfma_f32_16x16x32_bf16 v[132:135], v[32:35], v[20:23], 0
    ds_read_b64_tr_b16 v[66:67], v4 offset:6144
    v_mfma_f32_16x16x32_bf16 v[148:151], v[36:39], v[20:23], 0
    ds_read_b128 v[52:55], v8 offset:9216
    v_mfma_f32_16x16x32_bf16 v[144:147], v[36:39], v[16:19], 0
    ds_read_b64_tr_b16 v[68:69], v5 offset:4096
    v_mfma_f32_16x16x32_bf16 v[160:163], v[40:43], v[16:19], 0
    ds_read_b64_tr_b16 v[70:71], v5 offset:6144
    v_mfma_f32_16x16x32_bf16 v[164:167], v[40:43], v[20:23], 0
    ds_read_b128 v[56:59], v8 offset:10240
    ds_read_b64_tr_b16 v[72:73], v6 offset:4096
    v_mfma_f32_16x16x32_bf16 v[180:183], v[44:47], v[20:23], 0
    ds_read_b64_tr_b16 v[74:75], v6 offset:6144
    v_mfma_f32_16x16x32_bf16 v[176:179], v[44:47], v[16:19], 0
    ds_read_b128 v[60:63], v8 offset:11264
    v_mfma_f32_16x16x32_bf16 v[184:187], v[44:47], v[24:27], 0
    ds_read_b64_tr_b16 v[76:77], v7 offset:4096
    v_mfma_f32_16x16x32_bf16 v[188:191], v[44:47], v[28:31], 0
    ds_read_b64_tr_b16 v[78:79], v7 offset:6144
    v_mfma_f32_16x16x32_bf16 v[172:175], v[40:43], v[28:31], 0
    s_add_u32 s24, s24, 32768
    s_cmp_eq_u32 s24, 163840
    v_mfma_f32_16x16x32_bf16 v[168:171], v[40:43], v[24:27], 0
    s_cselect_b32 s24, 0, s24
    v_add_u32 v4, s24, v10
    v_mfma_f32_16x16x32_bf16 v[152:155], v[36:39], v[24:27], 0
    v_add_u32 v5, s24, v11
    v_add_u32 v6, s24, v12
    v_mfma_f32_16x16x32_bf16 v[156:159], v[36:39], v[28:31], 0
    v_add_u32 v7, s24, v13
    v_add_u32 v8, s24, v14
    v_mfma_f32_16x16x32_bf16 v[140:143], v[32:35], v[28:31], 0
    v_mfma_f32_16x16x32_bf16 v[136:139], v[32:35], v[24:27], 0
    s_waitcnt lgkmcnt(0)
    s_barrier
    v_mfma_f32_16x16x32_bf16 v[128:131], v[64:67], v[48:51], v[128:131]
    ds_read_b128 v[16:19], v8 offset:0
    ds_read_b64_tr_b16 v[32:33], v4 offset:0
    v_mfma_f32_16x16x32_bf16 v[132:135], v[64:67], v[52:55], v[132:135]
    ds_read_b64_tr_b16 v[34:35], v4 offset:2048
    v_mfma_f32_16x16x32_bf16 v[148:151], v[68:71], v[52:55], v[148:151]
    ds_read_b128 v[20:23], v8 offset:1024
    v_mfma_f32_16x16x32_bf16 v[144:147], v[68:71], v[48:51], v[144:147]
    ds_read_b64_tr_b16 v[36:37], v5 offset:0
    v_mfma_f32_16x16x32_bf16 v[160:163], v[72:75], v[48:51], v[160:163]
    ds_read_b64_tr_b16 v[38:39], v5 offset:2048
    v_mfma_f32_16x16x32_bf16 v[164:167], v[72:75], v[52:55], v[164:167]
    ds_read_b128 v[24:27], v8 offset:2048
    ds_read_b64_tr_b16 v[40:41], v6 offset:0
    v_mfma_f32_16x16x32_bf16 v[180:183], v[76:79], v[52:55], v[180:183]
    ds_read_b64_tr_b16 v[42:43], v6 offset:2048
    v_mfma_f32_16x16x32_bf16 v[176:179], v[76:79], v[48:51], v[176:179]
    ds_read_b128 v[28:31], v8 offset:3072
    v_mfma_f32_16x16x32_bf16 v[184:187], v[76:79], v[56:59], v[184:187]
    ds_read_b64_tr_b16 v[44:45], v7 offset:0
    v_mfma_f32_16x16x32_bf16 v[188:191], v[76:79], v[60:63], v[188:191]
    ds_read_b64_tr_b16 v[46:47], v7 offset:2048
    v_mfma_f32_16x16x32_bf16 v[172:175], v[72:75], v[60:63], v[172:175]
    v_mfma_f32_16x16x32_bf16 v[168:171], v[72:75], v[56:59], v[168:171]
    v_mfma_f32_16x16x32_bf16 v[152:155], v[68:71], v[56:59], v[152:155]
    v_mfma_f32_16x16x32_bf16 v[156:159], v[68:71], v[60:63], v[156:159]
    v_mfma_f32_16x16x32_bf16 v[140:143], v[64:67], v[60:63], v[140:143]
    v_mfma_f32_16x16x32_bf16 v[136:139], v[64:67], v[56:59], v[136:139]
    s_waitcnt lgkmcnt(0)
    s_waitcnt vmcnt(0)
    v_mov_b32 v15, s92
    v_lshlrev_b32_e64 v9, 2, v1
    s_mov_b32 exec_hi, 0
    buffer_store_dword v15, v9, s[12:15], s36 offen sc1
    s_nop 0
    s_mov_b32 exec_hi, -1
    v_mfma_f32_16x16x32_bf16 v[128:131], v[32:35], v[16:19], v[128:131]
    ds_read_b128 v[48:51], v8 offset:8192
    ds_read_b64_tr_b16 v[64:65], v4 offset:4096
    v_mfma_f32_16x16x32_bf16 v[132:135], v[32:35], v[20:23], v[132:135]
    ds_read_b64_tr_b16 v[66:67], v4 offset:6144
    v_mfma_f32_16x16x32_bf16 v[148:151], v[36:39], v[20:23], v[148:151]
    ds_read_b128 v[52:55], v8 offset:9216
    v_mfma_f32_16x16x32_bf16 v[144:147], v[36:39], v[16:19], v[144:147]
    ds_read_b64_tr_b16 v[68:69], v5 offset:4096
    v_mfma_f32_16x16x32_bf16 v[160:163], v[40:43], v[16:19], v[160:163]
    ds_read_b64_tr_b16 v[70:71], v5 offset:6144
    v_mfma_f32_16x16x32_bf16 v[164:167], v[40:43], v[20:23], v[164:167]
    ds_read_b128 v[56:59], v8 offset:10240
    ds_read_b64_tr_b16 v[72:73], v6 offset:4096
    v_mfma_f32_16x16x32_bf16 v[180:183], v[44:47], v[20:23], v[180:183]
    ds_read_b64_tr_b16 v[74:75], v6 offset:6144
    v_mfma_f32_16x16x32_bf16 v[176:179], v[44:47], v[16:19], v[176:179]
    ds_read_b128 v[60:63], v8 offset:11264
    v_mfma_f32_16x16x32_bf16 v[184:187], v[44:47], v[24:27], v[184:187]
    ds_read_b64_tr_b16 v[76:77], v7 offset:4096
    v_mfma_f32_16x16x32_bf16 v[188:191], v[44:47], v[28:31], v[188:191]
    ds_read_b64_tr_b16 v[78:79], v7 offset:6144
    v_mfma_f32_16x16x32_bf16 v[172:175], v[40:43], v[28:31], v[172:175]
    s_add_u32 s24, s24, 32768
    s_cmp_eq_u32 s24, 163840
    v_mfma_f32_16x16x32_bf16 v[168:171], v[40:43], v[24:27], v[168:171]
    s_cselect_b32 s24, 0, s24
    v_add_u32 v4, s24, v10
    v_mfma_f32_16x16x32_bf16 v[152:155], v[36:39], v[24:27], v[152:155]
    v_add_u32 v5, s24, v11
    v_add_u32 v6, s24, v12
    v_mfma_f32_16x16x32_bf16 v[156:159], v[36:39], v[28:31], v[156:159]
    v_add_u32 v7, s24, v13
    v_add_u32 v8, s24, v14
    v_mfma_f32_16x16x32_bf16 v[140:143], v[32:35], v[28:31], v[140:143]
    v_mfma_f32_16x16x32_bf16 v[136:139], v[32:35], v[24:27], v[136:139]
    s_waitcnt lgkmcnt(0)
    s_barrier
    v_mfma_f32_16x16x32_bf16 v[128:131], v[64:67], v[48:51], v[128:131]
    ds_read_b128 v[16:19], v8 offset:0
    ds_read_b64_tr_b16 v[32:33], v4 offset:0
    v_mfma_f32_16x16x32_bf16 v[132:135], v[64:67], v[52:55], v[132:135]
    ds_read_b64_tr_b16 v[34:35], v4 offset:2048
    v_mfma_f32_16x16x32_bf16 v[148:151], v[68:71], v[52:55], v[148:151]
    ds_read_b128 v[20:23], v8 offset:1024
    v_mfma_f32_16x16x32_bf16 v[144:147], v[68:71], v[48:51], v[144:147]
    ds_read_b64_tr_b16 v[36:37], v5 offset:0
    v_mfma_f32_16x16x32_bf16 v[160:163], v[72:75], v[48:51], v[160:163]
    ds_read_b64_tr_b16 v[38:39], v5 offset:2048
    v_mfma_f32_16x16x32_bf16 v[164:167], v[72:75], v[52:55], v[164:167]
    ds_read_b128 v[24:27], v8 offset:2048
    ds_read_b64_tr_b16 v[40:41], v6 offset:0
    v_mfma_f32_16x16x32_bf16 v[180:183], v[76:79], v[52:55], v[180:183]
    ds_read_b64_tr_b16 v[42:43], v6 offset:2048
    v_mfma_f32_16x16x32_bf16 v[176:179], v[76:79], v[48:51], v[176:179]
    ds_read_b128 v[28:31], v8 offset:3072
    v_mfma_f32_16x16x32_bf16 v[184:187], v[76:79], v[56:59], v[184:187]
    ds_read_b64_tr_b16 v[44:45], v7 offset:0
    v_mfma_f32_16x16x32_bf16 v[188:191], v[76:79], v[60:63], v[188:191]
    ds_read_b64_tr_b16 v[46:47], v7 offset:2048
    v_mfma_f32_16x16x32_bf16 v[172:175], v[72:75], v[60:63], v[172:175]
    v_mfma_f32_16x16x32_bf16 v[168:171], v[72:75], v[56:59], v[168:171]
    v_mfma_f32_16x16x32_bf16 v[152:155], v[68:71], v[56:59], v[152:155]
    v_mfma_f32_16x16x32_bf16 v[156:159], v[68:71], v[60:63], v[156:159]
    v_mfma_f32_16x16x32_bf16 v[140:143], v[64:67], v[60:63], v[140:143]
    v_mfma_f32_16x16x32_bf16 v[136:139], v[64:67], v[56:59], v[136:139]
    s_waitcnt lgkmcnt(0)
    s_mov_b32 s23, 5
.p2align 6
C2_LOOP1:
    v_mfma_f32_16x16x32_bf16 v[128:131], v[32:35], v[16:19], v[128:131]
    ds_read_b128 v[48:51], v8 offset:8192
    ds_read_b64_tr_b16 v[64:65], v4 offset:4096
    v_mfma_f32_16x16x32_bf16 v[132:135], v[32:35], v[20:23], v[132:135]
    ds_read_b64_tr_b16 v[66:67], v4 offset:6144
    v_mfma_f32_16x16x32_bf16 v[148:151], v[36:39], v[20:23], v[148:151]
    ds_read_b128 v[52:55], v8 offset:9216
    v_mfma_f32_16x16x32_bf16 v[144:147], v[36:39], v[16:19], v[144:147]
    ds_read_b64_tr_b16 v[68:69], v5 offset:4096
    v_mfma_f32_16x16x32_bf16 v[160:163], v[40:43], v[16:19], v[160:163]
    ds_read_b64_tr_b16 v[70:71], v5 offset:6144
    v_mfma_f32_16x16x32_bf16 v[164:167], v[40:43], v[20:23], v[164:167]
    ds_read_b128 v[56:59], v8 offset:10240
    ds_read_b64_tr_b16 v[72:73], v6 offset:4096
    v_mfma_f32_16x16x32_bf16 v[180:183], v[44:47], v[20:23], v[180:183]
    ds_read_b64_tr_b16 v[74:75], v6 offset:6144
    v_mfma_f32_16x16x32_bf16 v[176:179], v[44:47], v[16:19], v[176:179]
    ds_read_b128 v[60:63], v8 offset:11264
    v_mfma_f32_16x16x32_bf16 v[184:187], v[44:47], v[24:27], v[184:187]
    ds_read_b64_tr_b16 v[76:77], v7 offset:4096
    v_mfma_f32_16x16x32_bf16 v[188:191], v[44:47], v[28:31], v[188:191]
    ds_read_b64_tr_b16 v[78:79], v7 offset:6144
    v_mfma_f32_16x16x32_bf16 v[172:175], v[40:43], v[28:31], v[172:175]
    s_add_u32 s24, s24, 32768
    s_cmp_eq_u32 s24, 163840
    v_mfma_f32_16x16x32_bf16 v[168:171], v[40:43], v[24:27], v[168:171]
    s_cselect_b32 s24, 0, s24
    v_add_u32 v4, s24, v10
    v_mfma_f32_16x16x32_bf16 v[152:155], v[36:39], v[24:27], v[152:155]
    v_add_u32 v5, s24, v11
    v_add_u32 v6, s24, v12
    v_mfma_f32_16x16x32_bf16 v[156:159], v[36:39], v[28:31], v[156:159]
    v_add_u32 v7, s24, v13
    v_add_u32 v8, s24, v14
    v_mfma_f32_16x16x32_bf16 v[140:143], v[32:35], v[28:31], v[140:143]
    v_mfma_f32_16x16x32_bf16 v[136:139], v[32:35], v[24:27], v[136:139]
    s_waitcnt lgkmcnt(0)
    s_barrier
    v_mfma_f32_16x16x32_bf16 v[128:131], v[64:67], v[48:51], v[128:131]
    ds_read_b128 v[16:19], v8 offset:0
    ds_read_b64_tr_b16 v[32:33], v4 offset:0
    v_mfma_f32_16x16x32_bf16 v[132:135], v[64:67], v[52:55], v[132:135]
    ds_read_b64_tr_b16 v[34:35], v4 offset:2048
    v_mfma_f32_16x16x32_bf16 v[148:151], v[68:71], v[52:55], v[148:151]
    ds_read_b128 v[20:23], v8 offset:1024
    v_mfma_f32_16x16x32_bf16 v[144:147], v[68:71], v[48:51], v[144:147]
    ds_read_b64_tr_b16 v[36:37], v5 offset:0
    v_mfma_f32_16x16x32_bf16 v[160:163], v[72:75], v[48:51], v[160:163]
    ds_read_b64_tr_b16 v[38:39], v5 offset:2048
    v_mfma_f32_16x16x32_bf16 v[164:167], v[72:75], v[52:55], v[164:167]
    ds_read_b128 v[24:27], v8 offset:2048
    ds_read_b64_tr_b16 v[40:41], v6 offset:0
    v_mfma_f32_16x16x32_bf16 v[180:183], v[76:79], v[52:55], v[180:183]
    ds_read_b64_tr_b16 v[42:43], v6 offset:2048
    v_mfma_f32_16x16x32_bf16 v[176:179], v[76:79], v[48:51], v[176:179]
    ds_read_b128 v[28:31], v8 offset:3072
    v_mfma_f32_16x16x32_bf16 v[184:187], v[76:79], v[56:59], v[184:187]
    ds_read_b64_tr_b16 v[44:45], v7 offset:0
    v_mfma_f32_16x16x32_bf16 v[188:191], v[76:79], v[60:63], v[188:191]
    ds_read_b64_tr_b16 v[46:47], v7 offset:2048
    v_mfma_f32_16x16x32_bf16 v[172:175], v[72:75], v[60:63], v[172:175]
    v_mfma_f32_16x16x32_bf16 v[168:171], v[72:75], v[56:59], v[168:171]
    v_mfma_f32_16x16x32_bf16 v[152:155], v[68:71], v[56:59], v[152:155]
    v_mfma_f32_16x16x32_bf16 v[156:159], v[68:71], v[60:63], v[156:159]
    v_mfma_f32_16x16x32_bf16 v[140:143], v[64:67], v[60:63], v[140:143]
    v_mfma_f32_16x16x32_bf16 v[136:139], v[64:67], v[56:59], v[136:139]
    s_nop 0
    s_waitcnt lgkmcnt(0)
    v_mfma_f32_16x16x32_bf16 v[128:131], v[32:35], v[16:19], v[128:131]
    ds_read_b128 v[48:51], v8 offset:8192
    ds_read_b64_tr_b16 v[64:65], v4 offset:4096
    v_mfma_f32_16x16x32_bf16 v[132:135], v[32:35], v[20:23], v[132:135]
    ds_read_b64_tr_b16 v[66:67], v4 offset:6144
    v_mfma_f32_16x16x32_bf16 v[148:151], v[36:39], v[20:23], v[148:151]
    ds_read_b128 v[52:55], v8 offset:9216
    v_mfma_f32_16x16x32_bf16 v[144:147], v[36:39], v[16:19], v[144:147]
    ds_read_b64_tr_b16 v[68:69], v5 offset:4096
    v_mfma_f32_16x16x32_bf16 v[160:163], v[40:43], v[16:19], v[160:163]
    ds_read_b64_tr_b16 v[70:71], v5 offset:6144
    v_mfma_f32_16x16x32_bf16 v[164:167], v[40:43], v[20:23], v[164:167]
    ds_read_b128 v[56:59], v8 offset:10240
    ds_read_b64_tr_b16 v[72:73], v6 offset:4096
    v_mfma_f32_16x16x32_bf16 v[180:183], v[44:47], v[20:23], v[180:183]
    ds_read_b64_tr_b16 v[74:75], v6 offset:6144
    v_mfma_f32_16x16x32_bf16 v[176:179], v[44:47], v[16:19], v[176:179]
    ds_read_b128 v[60:63], v8 offset:11264
    v_mfma_f32_16x16x32_bf16 v[184:187], v[44:47], v[24:27], v[184:187]
    ds_read_b64_tr_b16 v[76:77], v7 offset:4096
    v_mfma_f32_16x16x32_bf16 v[188:191], v[44:47], v[28:31], v[188:191]
    ds_read_b64_tr_b16 v[78:79], v7 offset:6144
    v_mfma_f32_16x16x32_bf16 v[172:175], v[40:43], v[28:31], v[172:175]
    s_add_u32 s24, s24, 32768
    s_cmp_eq_u32 s24, 163840
    v_mfma_f32_16x16x32_bf16 v[168:171], v[40:43], v[24:27], v[168:171]
    s_cselect_b32 s24, 0, s24
    v_add_u32 v4, s24, v10
    v_mfma_f32_16x16x32_bf16 v[152:155], v[36:39], v[24:27], v[152:155]
    v_add_u32 v5, s24, v11
    v_add_u32 v6, s24, v12
    v_mfma_f32_16x16x32_bf16 v[156:159], v[36:39], v[28:31], v[156:159]
    v_add_u32 v7, s24, v13
    v_add_u32 v8, s24, v14
    v_mfma_f32_16x16x32_bf16 v[140:143], v[32:35], v[28:31], v[140:143]
    v_mfma_f32_16x16x32_bf16 v[136:139], v[32:35], v[24:27], v[136:139]
    s_waitcnt lgkmcnt(0)
    s_barrier
    v_mfma_f32_16x16x32_bf16 v[128:131], v[64:67], v[48:51], v[128:131]
    ds_read_b128 v[16:19], v8 offset:0
    ds_read_b64_tr_b16 v[32:33], v4 offset:0
    v_mfma_f32_16x16x32_bf16 v[132:135], v[64:67], v[52:55], v[132:135]
    ds_read_b64_tr_b16 v[34:35], v4 offset:2048
    v_mfma_f32_16x16x32_bf16 v[148:151], v[68:71], v[52:55], v[148:151]
    ds_read_b128 v[20:23], v8 offset:1024
    v_mfma_f32_16x16x32_bf16 v[144:147], v[68:71], v[48:51], v[144:147]
    ds_read_b64_tr_b16 v[36:37], v5 offset:0
    v_mfma_f32_16x16x32_bf16 v[160:163], v[72:75], v[48:51], v[160:163]
    ds_read_b64_tr_b16 v[38:39], v5 offset:2048
    v_mfma_f32_16x16x32_bf16 v[164:167], v[72:75], v[52:55], v[164:167]
    ds_read_b128 v[24:27], v8 offset:2048
    ds_read_b64_tr_b16 v[40:41], v6 offset:0
    v_mfma_f32_16x16x32_bf16 v[180:183], v[76:79], v[52:55], v[180:183]
    ds_read_b64_tr_b16 v[42:43], v6 offset:2048
    v_mfma_f32_16x16x32_bf16 v[176:179], v[76:79], v[48:51], v[176:179]
    ds_read_b128 v[28:31], v8 offset:3072
    v_mfma_f32_16x16x32_bf16 v[184:187], v[76:79], v[56:59], v[184:187]
    ds_read_b64_tr_b16 v[44:45], v7 offset:0
    v_mfma_f32_16x16x32_bf16 v[188:191], v[76:79], v[60:63], v[188:191]
    ds_read_b64_tr_b16 v[46:47], v7 offset:2048
    v_mfma_f32_16x16x32_bf16 v[172:175], v[72:75], v[60:63], v[172:175]
    v_mfma_f32_16x16x32_bf16 v[168:171], v[72:75], v[56:59], v[168:171]
    v_mfma_f32_16x16x32_bf16 v[152:155], v[68:71], v[56:59], v[152:155]
    v_mfma_f32_16x16x32_bf16 v[156:159], v[68:71], v[60:63], v[156:159]
    v_mfma_f32_16x16x32_bf16 v[140:143], v[64:67], v[60:63], v[140:143]
    v_mfma_f32_16x16x32_bf16 v[136:139], v[64:67], v[56:59], v[136:139]
    s_waitcnt lgkmcnt(0)
    s_sub_u32 s23, s23, 1
    s_cmp_lg_u32 s23, 0
    s_cbranch_scc1 C2_LOOP1
    buffer_load_dword v81, v82, s[12:15], s38 offen sc1
    v_mfma_f32_16x16x32_bf16 v[128:131], v[32:35], v[16:19], v[128:131]
    ds_read_b128 v[48:51], v8 offset:8192
    ds_read_b64_tr_b16 v[64:65], v4 offset:4096
    v_mfma_f32_16x16x32_bf16 v[132:135], v[32:35], v[20:23], v[132:135]
    ds_read_b64_tr_b16 v[66:67], v4 offset:6144
    v_mfma_f32_16x16x32_bf16 v[148:151], v[36:39], v[20:23], v[148:151]
    ds_read_b128 v[52:55], v8 offset:9216
    v_mfma_f32_16x16x32_bf16 v[144:147], v[36:39], v[16:19], v[144:147]
    ds_read_b64_tr_b16 v[68:69], v5 offset:4096
    v_mfma_f32_16x16x32_bf16 v[160:163], v[40:43], v[16:19], v[160:163]
    ds_read_b64_tr_b16 v[70:71], v5 offset:6144
    v_mfma_f32_16x16x32_bf16 v[164:167], v[40:43], v[20:23], v[164:167]
    ds_read_b128 v[56:59], v8 offset:10240
    ds_read_b64_tr_b16 v[72:73], v6 offset:4096
    v_mfma_f32_16x16x32_bf16 v[180:183], v[44:47], v[20:23], v[180:183]
    ds_read_b64_tr_b16 v[74:75], v6 offset:6144
    v_mfma_f32_16x16x32_bf16 v[176:179], v[44:47], v[16:19], v[176:179]
    ds_read_b128 v[60:63], v8 offset:11264
    v_mfma_f32_16x16x32_bf16 v[184:187], v[44:47], v[24:27], v[184:187]
    ds_read_b64_tr_b16 v[76:77], v7 offset:4096
    v_mfma_f32_16x16x32_bf16 v[188:191], v[44:47], v[28:31], v[188:191]
    ds_read_b64_tr_b16 v[78:79], v7 offset:6144
    v_mfma_f32_16x16x32_bf16 v[172:175], v[40:43], v[28:31], v[172:175]
    s_add_u32 s24, s24, 32768
    s_cmp_eq_u32 s24, 163840
    v_mfma_f32_16x16x32_bf16 v[168:171], v[40:43], v[24:27], v[168:171]
    s_cselect_b32 s24, 0, s24
    v_add_u32 v4, s24, v10
    v_mfma_f32_16x16x32_bf16 v[152:155], v[36:39], v[24:27], v[152:155]
    v_add_u32 v5, s24, v11
    v_add_u32 v6, s24, v12
    v_mfma_f32_16x16x32_bf16 v[156:159], v[36:39], v[28:31], v[156:159]
    v_add_u32 v7, s24, v13
    v_add_u32 v8, s24, v14
    v_mfma_f32_16x16x32_bf16 v[140:143], v[32:35], v[28:31], v[140:143]
    v_mfma_f32_16x16x32_bf16 v[136:139], v[32:35], v[24:27], v[136:139]
    s_waitcnt lgkmcnt(0)
    s_barrier
    v_mfma_f32_16x16x32_bf16 v[128:131], v[64:67], v[48:51], v[128:131]
    ds_read_b128 v[16:19], v8 offset:0
    ds_read_b64_tr_b16 v[32:33], v4 offset:0
    v_mfma_f32_16x16x32_bf16 v[132:135], v[64:67], v[52:55], v[132:135]
    ds_read_b64_tr_b16 v[34:35], v4 offset:2048
    v_mfma_f32_16x16x32_bf16 v[148:151], v[68:71], v[52:55], v[148:151]
    ds_read_b128 v[20:23], v8 offset:1024
    v_mfma_f32_16x16x32_bf16 v[144:147], v[68:71], v[48:51], v[144:147]
    ds_read_b64_tr_b16 v[36:37], v5 offset:0
    v_mfma_f32_16x16x32_bf16 v[160:163], v[72:75], v[48:51], v[160:163]
    ds_read_b64_tr_b16 v[38:39], v5 offset:2048
    v_mfma_f32_16x16x32_bf16 v[164:167], v[72:75], v[52:55], v[164:167]
    ds_read_b128 v[24:27], v8 offset:2048
    ds_read_b64_tr_b16 v[40:41], v6 offset:0
    v_mfma_f32_16x16x32_bf16 v[180:183], v[76:79], v[52:55], v[180:183]
    ds_read_b64_tr_b16 v[42:43], v6 offset:2048
    v_mfma_f32_16x16x32_bf16 v[176:179], v[76:79], v[48:51], v[176:179]
    ds_read_b128 v[28:31], v8 offset:3072
    v_mfma_f32_16x16x32_bf16 v[184:187], v[76:79], v[56:59], v[184:187]
    ds_read_b64_tr_b16 v[44:45], v7 offset:0
    v_mfma_f32_16x16x32_bf16 v[188:191], v[76:79], v[60:63], v[188:191]
    ds_read_b64_tr_b16 v[46:47], v7 offset:2048
    v_mfma_f32_16x16x32_bf16 v[172:175], v[72:75], v[60:63], v[172:175]
    v_mfma_f32_16x16x32_bf16 v[168:171], v[72:75], v[56:59], v[168:171]
    v_mfma_f32_16x16x32_bf16 v[152:155], v[68:71], v[56:59], v[152:155]
    v_mfma_f32_16x16x32_bf16 v[156:159], v[68:71], v[60:63], v[156:159]
    v_mfma_f32_16x16x32_bf16 v[140:143], v[64:67], v[60:63], v[140:143]
    v_mfma_f32_16x16x32_bf16 v[136:139], v[64:67], v[56:59], v[136:139]
    s_nop 0
    s_waitcnt lgkmcnt(0)
    v_mfma_f32_16x16x32_bf16 v[128:131], v[32:35], v[16:19], v[128:131]
    ds_read_b128 v[48:51], v8 offset:8192
    ds_read_b64_tr_b16 v[64:65], v4 offset:4096
    v_mfma_f32_16x16x32_bf16 v[132:135], v[32:35], v[20:23], v[132:135]
    ds_read_b64_tr_b16 v[66:67], v4 offset:6144
    v_mfma_f32_16x16x32_bf16 v[148:151], v[36:39], v[20:23], v[148:151]
    ds_read_b128 v[52:55], v8 offset:9216
    v_mfma_f32_16x16x32_bf16 v[144:147], v[36:39], v[16:19], v[144:147]
    ds_read_b64_tr_b16 v[68:69], v5 offset:4096
    v_mfma_f32_16x16x32_bf16 v[160:163], v[40:43], v[16:19], v[160:163]
    ds_read_b64_tr_b16 v[70:71], v5 offset:6144
    v_mfma_f32_16x16x32_bf16 v[164:167], v[40:43], v[20:23], v[164:167]
    ds_read_b128 v[56:59], v8 offset:10240
    ds_read_b64_tr_b16 v[72:73], v6 offset:4096
    v_mfma_f32_16x16x32_bf16 v[180:183], v[44:47], v[20:23], v[180:183]
    ds_read_b64_tr_b16 v[74:75], v6 offset:6144
    v_mfma_f32_16x16x32_bf16 v[176:179], v[44:47], v[16:19], v[176:179]
    ds_read_b128 v[60:63], v8 offset:11264
    v_mfma_f32_16x16x32_bf16 v[184:187], v[44:47], v[24:27], v[184:187]
    ds_read_b64_tr_b16 v[76:77], v7 offset:4096
    v_mfma_f32_16x16x32_bf16 v[188:191], v[44:47], v[28:31], v[188:191]
    ds_read_b64_tr_b16 v[78:79], v7 offset:6144
    v_mfma_f32_16x16x32_bf16 v[172:175], v[40:43], v[28:31], v[172:175]
    s_add_u32 s24, s24, 32768
    s_cmp_eq_u32 s24, 163840
    v_mfma_f32_16x16x32_bf16 v[168:171], v[40:43], v[24:27], v[168:171]
    s_cselect_b32 s24, 0, s24
    v_add_u32 v4, s24, v10
    v_mfma_f32_16x16x32_bf16 v[152:155], v[36:39], v[24:27], v[152:155]
    v_add_u32 v5, s24, v11
    v_add_u32 v6, s24, v12
    v_mfma_f32_16x16x32_bf16 v[156:159], v[36:39], v[28:31], v[156:159]
    v_add_u32 v7, s24, v13
    v_add_u32 v8, s24, v14
    v_mfma_f32_16x16x32_bf16 v[140:143], v[32:35], v[28:31], v[140:143]
    v_mfma_f32_16x16x32_bf16 v[136:139], v[32:35], v[24:27], v[136:139]
    s_waitcnt lgkmcnt(0)
    s_barrier
    v_mfma_f32_16x16x32_bf16 v[128:131], v[64:67], v[48:51], v[128:131]
    ds_read_b128 v[16:19], v8 offset:0
    ds_read_b64_tr_b16 v[32:33], v4 offset:0
    v_mfma_f32_16x16x32_bf16 v[132:135], v[64:67], v[52:55], v[132:135]
    ds_read_b64_tr_b16 v[34:35], v4 offset:2048
    v_mfma_f32_16x16x32_bf16 v[148:151], v[68:71], v[52:55], v[148:151]
    ds_read_b128 v[20:23], v8 offset:1024
    v_mfma_f32_16x16x32_bf16 v[144:147], v[68:71], v[48:51], v[144:147]
    ds_read_b64_tr_b16 v[36:37], v5 offset:0
    v_mfma_f32_16x16x32_bf16 v[160:163], v[72:75], v[48:51], v[160:163]
    ds_read_b64_tr_b16 v[38:39], v5 offset:2048
    v_mfma_f32_16x16x32_bf16 v[164:167], v[72:75], v[52:55], v[164:167]
    ds_read_b128 v[24:27], v8 offset:2048
    ds_read_b64_tr_b16 v[40:41], v6 offset:0
    v_mfma_f32_16x16x32_bf16 v[180:183], v[76:79], v[52:55], v[180:183]
    ds_read_b64_tr_b16 v[42:43], v6 offset:2048
    v_mfma_f32_16x16x32_bf16 v[176:179], v[76:79], v[48:51], v[176:179]
    ds_read_b128 v[28:31], v8 offset:3072
    v_mfma_f32_16x16x32_bf16 v[184:187], v[76:79], v[56:59], v[184:187]
    ds_read_b64_tr_b16 v[44:45], v7 offset:0
    v_mfma_f32_16x16x32_bf16 v[188:191], v[76:79], v[60:63], v[188:191]
    ds_read_b64_tr_b16 v[46:47], v7 offset:2048
    v_mfma_f32_16x16x32_bf16 v[172:175], v[72:75], v[60:63], v[172:175]
    v_mfma_f32_16x16x32_bf16 v[168:171], v[72:75], v[56:59], v[168:171]
    v_mfma_f32_16x16x32_bf16 v[152:155], v[68:71], v[56:59], v[152:155]
    v_mfma_f32_16x16x32_bf16 v[156:159], v[68:71], v[60:63], v[156:159]
    v_mfma_f32_16x16x32_bf16 v[140:143], v[64:67], v[60:63], v[140:143]
    v_mfma_f32_16x16x32_bf16 v[136:139], v[64:67], v[56:59], v[136:139]
    s_waitcnt lgkmcnt(0)
    s_waitcnt vmcnt(0)
    v_cmp_ne_u32_e64 vcc, s92, v81
    s_nop 1
    s_cbranch_vccnz AO_NY
    buffer_load_dwordx4 v[84:87], v80, s[12:15], s37 offen offset:0 sc1
    buffer_load_dwordx4 v[88:91], v80, s[12:15], s37 offen offset:1024 sc1
    buffer_load_dwordx4 v[92:95], v80, s[12:15], s37 offen offset:2048 sc1
    buffer_load_dwordx4 v[96:99], v80, s[12:15], s37 offen offset:3072 sc1
    buffer_load_dwordx4 v[100:103], v80, s[12:15], s39 offen offset:0 sc1
    buffer_load_dwordx4 v[104:107], v80, s[12:15], s39 offen offset:1024 sc1
    buffer_load_dwordx4 v[108:111], v80, s[12:15], s39 offen offset:2048 sc1
    buffer_load_dwordx4 v[112:115], v80, s[12:15], s39 offen offset:3072 sc1
    s_mov_b32 s33, 1
AO_NY:
    s_nop 0
    v_mfma_f32_16x16x32_bf16 v[128:131], v[32:35], v[16:19], v[128:131]
    ds_read_b128 v[48:51], v8 offset:8192
    ds_read_b64_tr_b16 v[64:65], v4 offset:4096
    v_mfma_f32_16x16x32_bf16 v[132:135], v[32:35], v[20:23], v[132:135]
    ds_read_b64_tr_b16 v[66:67], v4 offset:6144
    v_mfma_f32_16x16x32_bf16 v[148:151], v[36:39], v[20:23], v[148:151]
    ds_read_b128 v[52:55], v8 offset:9216
    v_mfma_f32_16x16x32_bf16 v[144:147], v[36:39], v[16:19], v[144:147]
    ds_read_b64_tr_b16 v[68:69], v5 offset:4096
    v_mfma_f32_16x16x32_bf16 v[160:163], v[40:43], v[16:19], v[160:163]
    ds_read_b64_tr_b16 v[70:71], v5 offset:6144
    v_mfma_f32_16x16x32_bf16 v[164:167], v[40:43], v[20:23], v[164:167]
    ds_read_b128 v[56:59], v8 offset:10240
    ds_read_b64_tr_b16 v[72:73], v6 offset:4096
    v_mfma_f32_16x16x32_bf16 v[180:183], v[44:47], v[20:23], v[180:183]
    ds_read_b64_tr_b16 v[74:75], v6 offset:6144
    v_mfma_f32_16x16x32_bf16 v[176:179], v[44:47], v[16:19], v[176:179]
    ds_read_b128 v[60:63], v8 offset:11264
    v_mfma_f32_16x16x32_bf16 v[184:187], v[44:47], v[24:27], v[184:187]
    ds_read_b64_tr_b16 v[76:77], v7 offset:4096
    v_mfma_f32_16x16x32_bf16 v[188:191], v[44:47], v[28:31], v[188:191]
    ds_read_b64_tr_b16 v[78:79], v7 offset:6144
    v_mfma_f32_16x16x32_bf16 v[172:175], v[40:43], v[28:31], v[172:175]
    s_add_u32 s24, s24, 32768
    s_cmp_eq_u32 s24, 163840
    v_mfma_f32_16x16x32_bf16 v[168:171], v[40:43], v[24:27], v[168:171]
    s_cselect_b32 s24, 0, s24
    v_add_u32 v4, s24, v10
    v_mfma_f32_16x16x32_bf16 v[152:155], v[36:39], v[24:27], v[152:155]
    v_add_u32 v5, s24, v11
    v_add_u32 v6, s24, v12
    v_mfma_f32_16x16x32_bf16 v[156:159], v[36:39], v[28:31], v[156:159]
    v_add_u32 v7, s24, v13
    v_add_u32 v8, s24, v14
    v_mfma_f32_16x16x32_bf16 v[140:143], v[32:35], v[28:31], v[140:143]
    v_mfma_f32_16x16x32_bf16 v[136:139], v[32:35], v[24:27], v[136:139]
    s_waitcnt lgkmcnt(0)
    s_barrier
    v_mfma_f32_16x16x32_bf16 v[128:131], v[64:67], v[48:51], v[128:131]
    ds_read_b128 v[16:19], v8 offset:0
    ds_read_b64_tr_b16 v[32:33], v4 offset:0
    v_mfma_f32_16x16x32_bf16 v[132:135], v[64:67], v[52:55], v[132:135]
    ds_read_b64_tr_b16 v[34:35], v4 offset:2048
    v_mfma_f32_16x16x32_bf16 v[148:151], v[68:71], v[52:55], v[148:151]
    ds_read_b128 v[20:23], v8 offset:1024
    v_mfma_f32_16x16x32_bf16 v[144:147], v[68:71], v[48:51], v[144:147]
    ds_read_b64_tr_b16 v[36:37], v5 offset:0
    v_mfma_f32_16x16x32_bf16 v[160:163], v[72:75], v[48:51], v[160:163]
    ds_read_b64_tr_b16 v[38:39], v5 offset:2048
    v_mfma_f32_16x16x32_bf16 v[164:167], v[72:75], v[52:55], v[164:167]
    ds_read_b128 v[24:27], v8 offset:2048
    ds_read_b64_tr_b16 v[40:41], v6 offset:0
    v_mfma_f32_16x16x32_bf16 v[180:183], v[76:79], v[52:55], v[180:183]
    ds_read_b64_tr_b16 v[42:43], v6 offset:2048
    v_mfma_f32_16x16x32_bf16 v[176:179], v[76:79], v[48:51], v[176:179]
    ds_read_b128 v[28:31], v8 offset:3072
    v_mfma_f32_16x16x32_bf16 v[184:187], v[76:79], v[56:59], v[184:187]
    ds_read_b64_tr_b16 v[44:45], v7 offset:0
    v_mfma_f32_16x16x32_bf16 v[188:191], v[76:79], v[60:63], v[188:191]
    ds_read_b64_tr_b16 v[46:47], v7 offset:2048
    v_mfma_f32_16x16x32_bf16 v[172:175], v[72:75], v[60:63], v[172:175]
    v_mfma_f32_16x16x32_bf16 v[168:171], v[72:75], v[56:59], v[168:171]
    v_mfma_f32_16x16x32_bf16 v[152:155], v[68:71], v[56:59], v[152:155]
    v_mfma_f32_16x16x32_bf16 v[156:159], v[68:71], v[60:63], v[156:159]
    v_mfma_f32_16x16x32_bf16 v[140:143], v[64:67], v[60:63], v[140:143]
    v_mfma_f32_16x16x32_bf16 v[136:139], v[64:67], v[56:59], v[136:139]
    s_nop 0
    s_waitcnt lgkmcnt(0)
    v_mfma_f32_16x16x32_bf16 v[128:131], v[32:35], v[16:19], v[128:131]
    ds_read_b128 v[48:51], v8 offset:8192
    ds_read_b64_tr_b16 v[64:65], v4 offset:4096
    v_mfma_f32_16x16x32_bf16 v[132:135], v[32:35], v[20:23], v[132:135]
    ds_read_b64_tr_b16 v[66:67], v4 offset:6144
    v_mfma_f32_16x16x32_bf16 v[148:151], v[36:39], v[20:23], v[148:151]
    ds_read_b128 v[52:55], v8 offset:9216
    v_mfma_f32_16x16x32_bf16 v[144:147], v[36:39], v[16:19], v[144:147]
    ds_read_b64_tr_b16 v[68:69], v5 offset:4096
    v_mfma_f32_16x16x32_bf16 v[160:163], v[40:43], v[16:19], v[160:163]
    ds_read_b64_tr_b16 v[70:71], v5 offset:6144
    v_mfma_f32_16x16x32_bf16 v[164:167], v[40:43], v[20:23], v[164:167]
    ds_read_b128 v[56:59], v8 offset:10240
    ds_read_b64_tr_b16 v[72:73], v6 offset:4096
    v_mfma_f32_16x16x32_bf16 v[180:183], v[44:47], v[20:23], v[180:183]
    ds_read_b64_tr_b16 v[74:75], v6 offset:6144
    v_mfma_f32_16x16x32_bf16 v[176:179], v[44:47], v[16:19], v[176:179]
    ds_read_b128 v[60:63], v8 offset:11264
    v_mfma_f32_16x16x32_bf16 v[184:187], v[44:47], v[24:27], v[184:187]
    ds_read_b64_tr_b16 v[76:77], v7 offset:4096
    v_mfma_f32_16x16x32_bf16 v[188:191], v[44:47], v[28:31], v[188:191]
    ds_read_b64_tr_b16 v[78:79], v7 offset:6144
    v_mfma_f32_16x16x32_bf16 v[172:175], v[40:43], v[28:31], v[172:175]
    v_mfma_f32_16x16x32_bf16 v[168:171], v[40:43], v[24:27], v[168:171]
    v_mfma_f32_16x16x32_bf16 v[152:155], v[36:39], v[24:27], v[152:155]
    v_mfma_f32_16x16x32_bf16 v[156:159], v[36:39], v[28:31], v[156:159]
    v_mfma_f32_16x16x32_bf16 v[140:143], v[32:35], v[28:31], v[140:143]
    v_mfma_f32_16x16x32_bf16 v[136:139], v[32:35], v[24:27], v[136:139]
    s_nop 0
    s_waitcnt lgkmcnt(0)
    v_mfma_f32_16x16x32_bf16 v[128:131], v[64:67], v[48:51], v[128:131]
    v_mfma_f32_16x16x32_bf16 v[132:135], v[64:67], v[52:55], v[132:135]
    v_mfma_f32_16x16x32_bf16 v[148:151], v[68:71], v[52:55], v[148:151]
    v_mfma_f32_16x16x32_bf16 v[144:147], v[68:71], v[48:51], v[144:147]
    v_mfma_f32_16x16x32_bf16 v[160:163], v[72:75], v[48:51], v[160:163]
    v_mfma_f32_16x16x32_bf16 v[164:167], v[72:75], v[52:55], v[164:167]
    v_mfma_f32_16x16x32_bf16 v[180:183], v[76:79], v[52:55], v[180:183]
    v_mfma_f32_16x16x32_bf16 v[176:179], v[76:79], v[48:51], v[176:179]
    v_mfma_f32_16x16x32_bf16 v[184:187], v[76:79], v[56:59], v[184:187]
    v_mfma_f32_16x16x32_bf16 v[188:191], v[76:79], v[60:63], v[188:191]
    v_mfma_f32_16x16x32_bf16 v[172:175], v[72:75], v[60:63], v[172:175]
    v_mfma_f32_16x16x32_bf16 v[168:171], v[72:75], v[56:59], v[168:171]
    v_mfma_f32_16x16x32_bf16 v[152:155], v[68:71], v[56:59], v[152:155]
    v_mfma_f32_16x16x32_bf16 v[156:159], v[68:71], v[60:63], v[156:159]
    v_mfma_f32_16x16x32_bf16 v[140:143], v[64:67], v[60:63], v[140:143]
    v_mfma_f32_16x16x32_bf16 v[136:139], v[64:67], v[56:59], v[136:139]
    s_cmp_eq_u32 s33, 1
    s_cbranch_scc1 AO_HY
    s_mov_b32 s99, 0x40000
YP_4_P:
    buffer_load_dword v81, v82, s[12:15], s38 offen offset:0 sc1
    s_waitcnt vmcnt(0)
    v_xor_b32 v81, s92, v81
    v_cmp_ne_u32 vcc, 0, v81
    s_sub_u32 s99, s99, 1
    s_cbranch_vccz YP_4_D
    s_sleep 4
    s_cmp_lg_u32 s99, 0
    s_cbranch_scc1 YP_4_P
YP_4_D:
    buffer_load_dwordx4 v[84:87], v80, s[12:15], s37 offen offset:0 sc1
    buffer_load_dwordx4 v[88:91], v80, s[12:15], s37 offen offset:1024 sc1
    buffer_load_dwordx4 v[92:95], v80, s[12:15], s37 offen offset:2048 sc1
    buffer_load_dwordx4 v[96:99], v80, s[12:15], s37 offen offset:3072 sc1
    buffer_load_dwordx4 v[100:103], v80, s[12:15], s39 offen offset:0 sc1
    buffer_load_dwordx4 v[104:107], v80, s[12:15], s39 offen offset:1024 sc1
    buffer_load_dwordx4 v[108:111], v80, s[12:15], s39 offen offset:2048 sc1
    buffer_load_dwordx4 v[112:115], v80, s[12:15], s39 offen offset:3072 sc1
AO_HY:
    s_waitcnt vmcnt(6)
    v_lshlrev_b32 v48, 16, v84
    v_and_b32 v49, 0xffff0000, v84
    v_lshlrev_b32_e64 v50, 16, v85
    v_and_b32 v51, 0xffff0000, v85
    v_pk_add_f32 v[128:129], v[128:129], v[48:49]
    v_pk_add_f32 v[130:131], v[130:131], v[50:51]
    v_cvt_pk_bf16_f32 v16, v128, v129
    v_cvt_pk_bf16_f32 v17, v130, v131
    v_lshlrev_b32_e64 v52, 16, v86
    v_and_b32 v53, 0xffff0000, v86
    v_lshlrev_b32_e64 v54, 16, v87
    v_and_b32 v55, 0xffff0000, v87
    v_pk_add_f32 v[144:145], v[144:145], v[52:53]
    v_pk_add_f32 v[146:147], v[146:147], v[54:55]
    v_cvt_pk_bf16_f32 v18, v144, v145
    v_cvt_pk_bf16_f32 v19, v146, v147
    v_lshlrev_b32_e64 v48, 16, v88
    v_and_b32 v49, 0xffff0000, v88
    v_lshlrev_b32_e64 v50, 16, v89
    v_and_b32 v51, 0xffff0000, v89
    v_pk_add_f32 v[160:161], v[160:161], v[48:49]
    v_pk_add_f32 v[162:163], v[162:163], v[50:51]
    v_cvt_pk_bf16_f32 v20, v160, v161
    v_cvt_pk_bf16_f32 v21, v162, v163
    v_lshlrev_b32_e64 v52, 16, v90
    v_and_b32 v53, 0xffff0000, v90
    v_lshlrev_b32_e64 v54, 16, v91
    v_and_b32 v55, 0xffff0000, v91
    v_pk_add_f32 v[176:177], v[176:177], v[52:53]
    v_pk_add_f32 v[178:179], v[178:179], v[54:55]
    v_cvt_pk_bf16_f32 v22, v176, v177
    v_cvt_pk_bf16_f32 v23, v178, v179
    v_permlane16_swap_b32 v16, v18
    v_permlane16_swap_b32 v17, v19
    v_permlane16_swap_b32 v20, v22
    v_permlane16_swap_b32 v21, v23
    v_mov_b32 v56, v16
    v_mov_b32 v57, v17
    v_mov_b32 v58, v18
    v_mov_b32 v59, v19
    v_mov_b32_dpp v16, v20 row_ror:8 row_mask:0xf bank_mask:0xc
    v_mov_b32_dpp v17, v21 row_ror:8 row_mask:0xf bank_mask:0xc
    v_mov_b32_dpp v18, v22 row_ror:8 row_mask:0xf bank_mask:0xc
    v_mov_b32_dpp v19, v23 row_ror:8 row_mask:0xf bank_mask:0xc
    v_mov_b32_dpp v20, v56 row_ror:8 row_mask:0xf bank_mask:0x3
    v_mov_b32_dpp v21, v57 row_ror:8 row_mask:0xf bank_mask:0x3
    v_mov_b32_dpp v22, v58 row_ror:8 row_mask:0xf bank_mask:0x3
    v_mov_b32_dpp v23, v59 row_ror:8 row_mask:0xf bank_mask:0x3
    buffer_store_dwordx4 v[16:19], v83, s[48:51], s40 offen sc1
    buffer_store_dwordx4 v[20:23], v83, s[48:51], s41 offen sc1
    s_waitcnt vmcnt(6)
    v_lshlrev_b32 v48, 16, v92
    v_and_b32 v49, 0xffff0000, v92
    v_lshlrev_b32_e64 v50, 16, v93
    v_and_b32 v51, 0xffff0000, v93
    v_pk_add_f32 v[132:133], v[132:133], v[48:49]
    v_pk_add_f32 v[134:135], v[134:135], v[50:51]
    v_cvt_pk_bf16_f32 v24, v132, v133
    v_cvt_pk_bf16_f32 v25, v134, v135
    v_lshlrev_b32_e64 v52, 16, v94
    v_and_b32 v53, 0xffff0000, v94
    v_lshlrev_b32_e64 v54, 16, v95
    v_and_b32 v55, 0xffff0000, v95
    v_pk_add_f32 v[148:149], v[148:149], v[52:53]
    v_pk_add_f32 v[150:151], v[150:151], v[54:55]
    v_cvt_pk_bf16_f32 v26, v148, v149
    v_cvt_pk_bf16_f32 v27, v150, v151
    v_lshlrev_b32_e64 v48, 16, v96
    v_and_b32 v49, 0xffff0000, v96
    v_lshlrev_b32_e64 v50, 16, v97
    v_and_b32 v51, 0xffff0000, v97
    v_pk_add_f32 v[164:165], v[164:165], v[48:49]
    v_pk_add_f32 v[166:167], v[166:167], v[50:51]
    v_cvt_pk_bf16_f32 v28, v164, v165
    v_cvt_pk_bf16_f32 v29, v166, v167
    v_lshlrev_b32_e64 v52, 16, v98
    v_and_b32 v53, 0xffff0000, v98
    v_lshlrev_b32_e64 v54, 16, v99
    v_and_b32 v55, 0xffff0000, v99
    v_pk_add_f32 v[180:181], v[180:181], v[52:53]
    v_pk_add_f32 v[182:183], v[182:183], v[54:55]
    v_cvt_pk_bf16_f32 v30, v180, v181
    v_cvt_pk_bf16_f32 v31, v182, v183
    v_permlane16_swap_b32 v24, v26
    v_permlane16_swap_b32 v25, v27
    v_permlane16_swap_b32 v28, v30
    v_permlane16_swap_b32 v29, v31
    v_mov_b32 v56, v24
    v_mov_b32 v57, v25
    v_mov_b32 v58, v26
    v_mov_b32 v59, v27
    v_mov_b32_dpp v24, v28 row_ror:8 row_mask:0xf bank_mask:0xc
    v_mov_b32_dpp v25, v29 row_ror:8 row_mask:0xf bank_mask:0xc
    v_mov_b32_dpp v26, v30 row_ror:8 row_mask:0xf bank_mask:0xc
    v_mov_b32_dpp v27, v31 row_ror:8 row_mask:0xf bank_mask:0xc
    v_mov_b32_dpp v28, v56 row_ror:8 row_mask:0xf bank_mask:0x3
    v_mov_b32_dpp v29, v57 row_ror:8 row_mask:0xf bank_mask:0x3
    v_mov_b32_dpp v30, v58 row_ror:8 row_mask:0xf bank_mask:0x3
    v_mov_b32_dpp v31, v59 row_ror:8 row_mask:0xf bank_mask:0x3
    buffer_store_dwordx4 v[24:27], v83, s[48:51], s42 offen sc1
    buffer_store_dwordx4 v[28:31], v83, s[48:51], s43 offen sc1
    s_waitcnt vmcnt(6)
    v_lshlrev_b32 v48, 16, v100
    v_and_b32 v49, 0xffff0000, v100
    v_lshlrev_b32_e64 v50, 16, v101
    v_and_b32 v51, 0xffff0000, v101
    v_pk_add_f32 v[136:137], v[136:137], v[48:49]
    v_pk_add_f32 v[138:139], v[138:139], v[50:51]
    v_cvt_pk_bf16_f32 v32, v136, v137
    v_cvt_pk_bf16_f32 v33, v138, v139
    v_lshlrev_b32_e64 v52, 16, v102
    v_and_b32 v53, 0xffff0000, v102
    v_lshlrev_b32_e64 v54, 16, v103
    v_and_b32 v55, 0xffff0000, v103
    v_pk_add_f32 v[152:153], v[152:153], v[52:53]
    v_pk_add_f32 v[154:155], v[154:155], v[54:55]
    v_cvt_pk_bf16_f32 v34, v152, v153
    v_cvt_pk_bf16_f32 v35, v154, v155
    v_lshlrev_b32_e64 v48, 16, v104
    v_and_b32 v49, 0xffff0000, v104
    v_lshlrev_b32_e64 v50, 16, v105
    v_and_b32 v51, 0xffff0000, v105
    v_pk_add_f32 v[168:169], v[168:169], v[48:49]
    v_pk_add_f32 v[170:171], v[170:171], v[50:51]
    v_cvt_pk_bf16_f32 v36, v168, v169
    v_cvt_pk_bf16_f32 v37, v170, v171
    v_lshlrev_b32_e64 v52, 16, v106
    v_and_b32 v53, 0xffff0000, v106
    v_lshlrev_b32_e64 v54, 16, v107
    v_and_b32 v55, 0xffff0000, v107
    v_pk_add_f32 v[184:185], v[184:185], v[52:53]
    v_pk_add_f32 v[186:187], v[186:187], v[54:55]
    v_cvt_pk_bf16_f32 v38, v184, v185
    v_cvt_pk_bf16_f32 v39, v186, v187
    v_permlane16_swap_b32 v32, v34
    v_permlane16_swap_b32 v33, v35
    v_permlane16_swap_b32 v36, v38
    v_permlane16_swap_b32 v37, v39
    v_mov_b32 v56, v32
    v_mov_b32 v57, v33
    v_mov_b32 v58, v34
    v_mov_b32 v59, v35
    v_mov_b32_dpp v32, v36 row_ror:8 row_mask:0xf bank_mask:0xc
    v_mov_b32_dpp v33, v37 row_ror:8 row_mask:0xf bank_mask:0xc
    v_mov_b32_dpp v34, v38 row_ror:8 row_mask:0xf bank_mask:0xc
    v_mov_b32_dpp v35, v39 row_ror:8 row_mask:0xf bank_mask:0xc
    v_mov_b32_dpp v36, v56 row_ror:8 row_mask:0xf bank_mask:0x3
    v_mov_b32_dpp v37, v57 row_ror:8 row_mask:0xf bank_mask:0x3
    v_mov_b32_dpp v38, v58 row_ror:8 row_mask:0xf bank_mask:0x3
    v_mov_b32_dpp v39, v59 row_ror:8 row_mask:0xf bank_mask:0x3
    buffer_store_dwordx4 v[32:35], v83, s[48:51], s44 offen sc1
    buffer_store_dwordx4 v[36:39], v83, s[48:51], s45 offen sc1
    s_waitcnt vmcnt(6)
    v_lshlrev_b32 v48, 16, v108
    v_and_b32 v49, 0xffff0000, v108
    v_lshlrev_b32_e64 v50, 16, v109
    v_and_b32 v51, 0xffff0000, v109
    v_pk_add_f32 v[140:141], v[140:141], v[48:49]
    v_pk_add_f32 v[142:143], v[142:143], v[50:51]
    v_cvt_pk_bf16_f32 v40, v140, v141
    v_cvt_pk_bf16_f32 v41, v142, v143
    v_lshlrev_b32_e64 v52, 16, v110
    v_and_b32 v53, 0xffff0000, v110
    v_lshlrev_b32_e64 v54, 16, v111
    v_and_b32 v55, 0xffff0000, v111
    v_pk_add_f32 v[156:157], v[156:157], v[52:53]
    v_pk_add_f32 v[158:159], v[158:159], v[54:55]
    v_cvt_pk_bf16_f32 v42, v156, v157
    v_cvt_pk_bf16_f32 v43, v158, v159
    v_lshlrev_b32_e64 v48, 16, v112
    v_and_b32 v49, 0xffff0000, v112
    v_lshlrev_b32_e64 v50, 16, v113
    v_and_b32 v51, 0xffff0000, v113
    v_pk_add_f32 v[172:173], v[172:173], v[48:49]
    v_pk_add_f32 v[174:175], v[174:175], v[50:51]
    v_cvt_pk_bf16_f32 v44, v172, v173
    v_cvt_pk_bf16_f32 v45, v174, v175
    v_lshlrev_b32_e64 v52, 16, v114
    v_and_b32 v53, 0xffff0000, v114
    v_lshlrev_b32_e64 v54, 16, v115
    v_and_b32 v55, 0xffff0000, v115
    v_pk_add_f32 v[188:189], v[188:189], v[52:53]
    v_pk_add_f32 v[190:191], v[190:191], v[54:55]
    v_cvt_pk_bf16_f32 v46, v188, v189
    v_cvt_pk_bf16_f32 v47, v190, v191
    v_permlane16_swap_b32 v40, v42
    v_permlane16_swap_b32 v41, v43
    v_permlane16_swap_b32 v44, v46
    v_permlane16_swap_b32 v45, v47
    v_mov_b32 v56, v40
    v_mov_b32 v57, v41
    v_mov_b32 v58, v42
    v_mov_b32 v59, v43
    v_mov_b32_dpp v40, v44 row_ror:8 row_mask:0xf bank_mask:0xc
    v_mov_b32_dpp v41, v45 row_ror:8 row_mask:0xf bank_mask:0xc
    v_mov_b32_dpp v42, v46 row_ror:8 row_mask:0xf bank_mask:0xc
    v_mov_b32_dpp v43, v47 row_ror:8 row_mask:0xf bank_mask:0xc
    v_mov_b32_dpp v44, v56 row_ror:8 row_mask:0xf bank_mask:0x3
    v_mov_b32_dpp v45, v57 row_ror:8 row_mask:0xf bank_mask:0x3
    v_mov_b32_dpp v46, v58 row_ror:8 row_mask:0xf bank_mask:0x3
    v_mov_b32_dpp v47, v59 row_ror:8 row_mask:0xf bank_mask:0x3
    buffer_store_dwordx4 v[40:43], v83, s[48:51], s46 offen sc1
    buffer_store_dwordx4 v[44:47], v83, s[48:51], s47 offen sc1
    s_endpgm
AO_LOADER:
    s_mov_b32 s8, s72
    s_and_b32 s9, s73, 0xffff
    s_mov_b32 s10, 0x200000
    s_mov_b32 s11, 0x20000
    s_and_b32 s27, s20, 3
    s_lshr_b32 s28, s27, 1
    s_and_b32 s29, s27, 1
    v_mov_b32 v8, v244
    v_mov_b32 v9, v245
    v_mov_b32 v10, v246
    v_mov_b32 v11, v247
    v_mov_b32_e64 v12, 0
    s_lshl_b32 s32, s29, 12
    s_lshl_b32 s31, s22, 18
    s_add_u32 s31, s31, s32
    s_add_u32 s31, s31, 12582912
    v_lshl_add_u32 v7, v1, 4, s31
    s_lshl_b32 s30, s29, 13
    s_lshl_b32 s31, s28, 12
    s_add_u32 s30, s30, s31
    s_lshl_b32 s31, s27, 12
    s_add_u32 s31, s31, 16384
    s_mov_b32 s24, 131072
    s_lshl_b32 s33, s21, 1
    s_add_u32 s49, s33, 17
    s_add_u32 s33, s33, 3
    s_lshl_b32 s34, s22, 13
    s_add_u32 s34, s34, 18481152
    v_lshlrev_b32 v16, 7, v1
    s_lshl_b32 s35, s29, 1
    s_mov_b32 s46, 0x33333333
    s_lshl_b32 s46, s46, s35
    s_and_b32 s44, s46, 0xf0f0f0f0
    s_mov_b32 s45, s44
    s_lshl_b32 s47, s21, 3
    s_lshl_b64 s[40:41], 0xff, s47
    s_mov_b64 s[52:53], 0
    s_and_b32 s47, s33, 15
    s_lshl_b32 s48, s47, 1
    s_add_u32 s48, s48, s28
    s_lshl_b32 s47, s47, 2
    s_add_u32 s47, s47, s35
    s_lshl_b64 s[38:39], 3, s47
    s_add_u32 s50, s24, s31
    s_waitcnt vmcnt(0) lgkmcnt(0)
    v_mov_b32 v13, s92
    v_lshlrev_b32_e64 v12, 2, v1
    s_mov_b32 exec_hi, 0
    buffer_store_dword v13, v12, s[12:15], s36 offen sc1
    s_mov_b32 exec_hi, -1
    s_sleep 20
    s_lshl_b32 s25, s48, 16
    s_andn2_b64 s[42:43], s[38:39], s[40:41]
    s_cbranch_scc1 L2G1_P
L2G1_D:
    s_add_u32 m0, s24, s30
    s_lshl_b32 s26, s48, 13
    s_add_u32 s33, s33, 2
    s_cmp_eq_u32 s33, s49
    s_addc_u32 s33, s33, 0
    s_and_b32 s47, s33, 15
    s_lshl_b32 s48, s47, 1
    s_add_u32 s48, s48, s28
    s_lshl_b32 s47, s47, 2
    s_add_u32 s47, s47, s35
    s_lshl_b64 s[38:39], 3, s47
    s_mov_b32 m0, s50
    s_nop 0
    buffer_load_dwordx4 v7, s[12:15], s26 offen offset:0 sc1 lds
    s_add_u32 s24, s24, 32768
    s_cmp_eq_u32 s24, 163840
    s_cselect_b32 s24, 0, s24
    s_add_u32 s50, s24, s31
    buffer_load_dwordx4 v7, s[12:15], s26 offen offset:1024 sc1 lds
    s_lshl_b32 s25, s48, 16
    s_andn2_b64 s[42:43], s[38:39], s[40:41]
    s_cbranch_scc1 L2G2_P
L2G2_D:
    buffer_load_dwordx4 v7, s[12:15], s26 offen offset:2048 sc1 lds
    buffer_load_dwordx4 v7, s[12:15], s26 offen offset:3072 sc1 lds
    s_add_u32 m0, s24, s30
    s_lshl_b32 s26, s48, 13
    s_barrier
    s_add_u32 s33, s33, 2
    s_cmp_eq_u32 s33, s49
    s_addc_u32 s33, s33, 0
    s_and_b32 s47, s33, 15
    s_lshl_b32 s48, s47, 1
    s_add_u32 s48, s48, s28
    s_lshl_b32 s47, s47, 2
    s_add_u32 s47, s47, s35
    s_lshl_b64 s[38:39], 3, s47
    s_mov_b32 m0, s50
    s_nop 0
    buffer_load_dwordx4 v7, s[12:15], s26 offen offset:0 sc1 lds
    s_add_u32 s24, s24, 32768
    s_cmp_eq_u32 s24, 163840
    s_cselect_b32 s24, 0, s24
    s_add_u32 s50, s24, s31
    buffer_load_dwordx4 v7, s[12:15], s26 offen offset:1024 sc1 lds
    s_lshl_b32 s25, s48, 16
    s_andn2_b64 s[42:43], s[38:39], s[40:41]
    s_cbranch_scc1 L2G3_P
L2G3_D:
    buffer_load_dwordx4 v7, s[12:15], s26 offen offset:2048 sc1 lds
    buffer_load_dwordx4 v7, s[12:15], s26 offen offset:3072 sc1 lds
    s_add_u32 m0, s24, s30
    s_lshl_b32 s26, s48, 13
    s_barrier
    buffer_load_dwordx4 v8, s[8:11], s25 offen offset:0 lds
    s_add_u32 s33, s33, 2
    s_cmp_eq_u32 s33, s49
    s_addc_u32 s33, s33, 0
    buffer_load_dwordx4 v9, s[8:11], s25 offen offset:1024 lds
    s_and_b32 s47, s33, 15
    s_lshl_b32 s48, s47, 1
    s_add_u32 s48, s48, s28
    buffer_load_dwordx4 v10, s[8:11], s25 offen offset:2048 lds
    s_lshl_b32 s47, s47, 2
    s_add_u32 s47, s47, s35
    s_lshl_b64 s[38:39], 3, s47
    buffer_load_dwordx4 v11, s[8:11], s25 offen offset:3072 lds
    s_mov_b32 m0, s50
    s_nop 0
    s_waitcnt vmcnt(8)
    s_barrier
    buffer_load_dwordx4 v7, s[12:15], s26 offen offset:0 sc1 lds
    s_add_u32 s24, s24, 32768
    s_cmp_eq_u32 s24, 163840
    s_cselect_b32 s24, 0, s24
    s_add_u32 s50, s24, s31
    buffer_load_dwordx4 v7, s[12:15], s26 offen offset:1024 sc1 lds
    s_lshl_b32 s25, s48, 16
    s_andn2_b64 s[42:43], s[38:39], s[40:41]
    s_cbranch_scc1 L2G4_P
L2G4_D:
    buffer_load_dwordx4 v7, s[12:15], s26 offen offset:2048 sc1 lds
    buffer_load_dwordx4 v7, s[12:15], s26 offen offset:3072 sc1 lds
    s_add_u32 m0, s24, s30
    s_lshl_b32 s26, s48, 13
    buffer_load_dwordx4 v8, s[8:11], s25 offen offset:0 lds
    s_add_u32 s33, s33, 2
    s_cmp_eq_u32 s33, s49
    s_addc_u32 s33, s33, 0
    buffer_load_dwordx4 v9, s[8:11], s25 offen offset:1024 lds
    s_and_b32 s47, s33, 15
    s_lshl_b32 s48, s47, 1
    s_add_u32 s48, s48, s28
    buffer_load_dwordx4 v10, s[8:11], s25 offen offset:2048 lds
    s_lshl_b32 s47, s47, 2
    s_add_u32 s47, s47, s35
    s_lshl_b64 s[38:39], 3, s47
    buffer_load_dwordx4 v11, s[8:11], s25 offen offset:3072 lds
    s_mov_b32 m0, s50
    s_nop 0
    s_waitcnt vmcnt(12)
    s_barrier
    buffer_load_dwordx4 v7, s[12:15], s26 offen offset:0 sc1 lds
    s_add_u32 s24, s24, 32768
    s_cmp_eq_u32 s24, 163840
    s_cselect_b32 s24, 0, s24
    s_add_u32 s50, s24, s31
    buffer_load_dwordx4 v7, s[12:15], s26 offen offset:1024 sc1 lds
    s_lshl_b32 s25, s48, 16
    s_andn2_b64 s[42:43], s[38:39], s[40:41]
    s_cbranch_scc1 L2G5_P
L2G5_D:
    buffer_load_dwordx4 v7, s[12:15], s26 offen offset:2048 sc1 lds
    buffer_load_dwordx4 v7, s[12:15], s26 offen offset:3072 sc1 lds
    s_add_u32 m0, s24, s30
    s_lshl_b32 s26, s48, 13
    buffer_load_dwordx4 v8, s[8:11], s25 offen offset:0 lds
    s_add_u32 s33, s33, 2
    s_cmp_eq_u32 s33, s49
    s_addc_u32 s33, s33, 0
    buffer_load_dwordx4 v9, s[8:11], s25 offen offset:1024 lds
    s_and_b32 s47, s33, 15
    s_lshl_b32 s48, s47, 1
    s_add_u32 s48, s48, s28
    buffer_load_dwordx4 v10, s[8:11], s25 offen offset:2048 lds
    s_lshl_b32 s47, s47, 2
    s_add_u32 s47, s47, s35
    s_lshl_b64 s[38:39], 3, s47
    buffer_load_dwordx4 v11, s[8:11], s25 offen offset:3072 lds
    s_mov_b32 m0, s50
    s_nop 0
    s_waitcnt vmcnt(12)
    s_barrier
    buffer_load_dwordx4 v7, s[12:15], s26 offen offset:0 sc1 lds
    s_add_u32 s24, s24, 32768
    s_cmp_eq_u32 s24, 163840
    s_cselect_b32 s24, 0, s24
    s_add_u32 s50, s24, s31
    buffer_load_dwordx4 v7, s[12:15], s26 offen offset:1024 sc1 lds
    s_lshl_b32 s25, s48, 16
    s_andn2_b64 s[42:43], s[38:39], s[40:41]
    s_cbranch_scc1 L2G6_P
L2G6_D:
    buffer_load_dwordx4 v7, s[12:15], s26 offen offset:2048 sc1 lds
    buffer_load_dwordx4 v7, s[12:15], s26 offen offset:3072 sc1 lds
    s_add_u32 m0, s24, s30
    s_lshl_b32 s26, s48, 13
    s_mov_b32 s44, s46
    s_mov_b32 s45, s46
    s_mov_b32 s23, 4
.p2align 6
L2_LOOP:
    s_waitcnt vmcnt(8)
    s_andn2_b64 s[52:53], s[44:45], s[40:41]
    s_cbranch_scc1 L2R7_P
L2R7_D:
    s_barrier
    buffer_load_dwordx4 v8, s[8:11], s25 offen offset:0 lds
    s_add_u32 s33, s33, 2
    s_cmp_eq_u32 s33, s49
    s_addc_u32 s33, s33, 0
    buffer_load_dwordx4 v9, s[8:11], s25 offen offset:1024 lds
    s_and_b32 s47, s33, 15
    s_lshl_b32 s48, s47, 1
    s_add_u32 s48, s48, s28
    buffer_load_dwordx4 v10, s[8:11], s25 offen offset:2048 lds
    s_lshl_b32 s47, s47, 2
    s_add_u32 s47, s47, s35
    s_lshl_b64 s[38:39], 3, s47
    buffer_load_dwordx4 v11, s[8:11], s25 offen offset:3072 lds
    s_mov_b32 m0, s50
    s_nop 0
    buffer_load_dwordx4 v7, s[12:15], s26 offen offset:0 sc1 lds
    s_add_u32 s24, s24, 32768
    s_cmp_eq_u32 s24, 163840
    s_cselect_b32 s24, 0, s24
    s_add_u32 s50, s24, s31
    buffer_load_dwordx4 v7, s[12:15], s26 offen offset:1024 sc1 lds
    s_lshl_b32 s25, s48, 16
    s_andn2_b64 s[42:43], s[38:39], s[40:41]
    s_cbranch_scc1 L2G8_P
L2G8_D:
    buffer_load_dwordx4 v7, s[12:15], s26 offen offset:2048 sc1 lds
    buffer_load_dwordx4 v7, s[12:15], s26 offen offset:3072 sc1 lds
    s_add_u32 m0, s24, s30
    s_lshl_b32 s26, s48, 13
    s_waitcnt vmcnt(8)
    s_cmp_lg_u64 s[52:53], 0
    s_cbranch_scc1 L2R9_P
L2R9_D:
    s_barrier
    buffer_load_dwordx4 v8, s[8:11], s25 offen offset:0 lds
    s_add_u32 s33, s33, 2
    s_cmp_eq_u32 s33, s49
    s_addc_u32 s33, s33, 0
    buffer_load_dwordx4 v9, s[8:11], s25 offen offset:1024 lds
    s_and_b32 s47, s33, 15
    s_lshl_b32 s48, s47, 1
    s_add_u32 s48, s48, s28
    buffer_load_dwordx4 v10, s[8:11], s25 offen offset:2048 lds
    s_lshl_b32 s47, s47, 2
    s_add_u32 s47, s47, s35
    s_lshl_b64 s[38:39], 3, s47
    buffer_load_dwordx4 v11, s[8:11], s25 offen offset:3072 lds
    s_mov_b32 m0, s50
    s_nop 0
    buffer_load_dwordx4 v7, s[12:15], s26 offen offset:0 sc1 lds
    s_add_u32 s24, s24, 32768
    s_cmp_eq_u32 s24, 163840
    s_cselect_b32 s24, 0, s24
    s_add_u32 s50, s24, s31
    buffer_load_dwordx4 v7, s[12:15], s26 offen offset:1024 sc1 lds
    s_lshl_b32 s25, s48, 16
    s_andn2_b64 s[42:43], s[38:39], s[40:41]
    s_cbranch_scc1 L2G10_P
L2G10_D:
    buffer_load_dwordx4 v7, s[12:15], s26 offen offset:2048 sc1 lds
    buffer_load_dwordx4 v7, s[12:15], s26 offen offset:3072 sc1 lds
    s_add_u32 m0, s24, s30
    s_lshl_b32 s26, s48, 13
    s_mov_b32 s44, s46
    s_mov_b32 s45, s46
    s_sub_u32 s23, s23, 1
    s_cmp_lg_u32 s23, 0
    s_cbranch_scc1 L2_LOOP
    s_nop 0
    s_waitcnt vmcnt(8)
    s_barrier
    buffer_load_dwordx4 v8, s[8:11], s25 offen offset:0 lds
    buffer_load_dwordx4 v9, s[8:11], s25 offen offset:1024 lds
    buffer_load_dwordx4 v10, s[8:11], s25 offen offset:2048 lds
    buffer_load_dwordx4 v11, s[8:11], s25 offen offset:3072 lds
    s_mov_b32 m0, s50
    s_nop 0
    buffer_load_dwordx4 v7, s[12:15], s26 offen offset:0 sc1 lds
    buffer_load_dwordx4 v7, s[12:15], s26 offen offset:1024 sc1 lds
    buffer_load_dwordx4 v7, s[12:15], s26 offen offset:2048 sc1 lds
    buffer_load_dwordx4 v7, s[12:15], s26 offen offset:3072 sc1 lds
    s_waitcnt vmcnt(8)
    s_barrier
    s_waitcnt vmcnt(0)
    s_barrier
    s_branch L2_GEND
L2G1_P:
    s_mov_b32 s99, 0x40000
L2G1_C:
    s_andn2_b64 exec, s[44:45], s[40:41]
    buffer_load_dword v17, v16, s[12:15], s34 offen sc1
    s_waitcnt vmcnt(0)
    v_cmp_eq_u32_e64 vcc, s92, v17
    s_mov_b64 exec, -1
    s_or_b64 s[40:41], s[40:41], vcc
    s_andn2_b64 s[42:43], s[38:39], s[40:41]
    s_cbranch_scc0 L2G1_D
    s_sleep 3
    s_sub_u32 s99, s99, 1
    s_cmp_lg_u32 s99, 0
    s_cbranch_scc1 L2G1_C
    s_branch L2G1_D
L2G2_P:
    s_mov_b32 s99, 0x40000
L2G2_C:
    s_andn2_b64 exec, s[44:45], s[40:41]
    buffer_load_dword v17, v16, s[12:15], s34 offen sc1
    s_waitcnt vmcnt(0)
    v_cmp_eq_u32 vcc, s92, v17
    s_mov_b64 exec, -1
    s_or_b64 s[40:41], s[40:41], vcc
    s_andn2_b64 s[42:43], s[38:39], s[40:41]
    s_cbranch_scc0 L2G2_D
    s_sleep 3
    s_sub_u32 s99, s99, 1
    s_cmp_lg_u32 s99, 0
    s_cbranch_scc1 L2G2_C
    s_branch L2G2_D
L2G3_P:
    s_mov_b32 s99, 0x40000
L2G3_C:
    s_andn2_b64 exec, s[44:45], s[40:41]
    buffer_load_dword v17, v16, s[12:15], s34 offen sc1
    s_waitcnt vmcnt(0)
    v_cmp_eq_u32 vcc, s92, v17
    s_mov_b64 exec, -1
    s_or_b64 s[40:41], s[40:41], vcc
    s_andn2_b64 s[42:43], s[38:39], s[40:41]
    s_cbranch_scc0 L2G3_D
    s_sleep 3
    s_sub_u32 s99, s99, 1
    s_cmp_lg_u32 s99, 0
    s_cbranch_scc1 L2G3_C
    s_branch L2G3_D
L2G4_P:
    s_mov_b32 s99, 0x40000
L2G4_C:
    s_andn2_b64 exec, s[44:45], s[40:41]
    buffer_load_dword v17, v16, s[12:15], s34 offen sc1
    s_waitcnt vmcnt(0)
    v_cmp_eq_u32 vcc, s92, v17
    s_mov_b64 exec, -1
    s_or_b64 s[40:41], s[40:41], vcc
    s_andn2_b64 s[42:43], s[38:39], s[40:41]
    s_cbranch_scc0 L2G4_D
    s_sleep 3
    s_sub_u32 s99, s99, 1
    s_cmp_lg_u32 s99, 0
    s_cbranch_scc1 L2G4_C
    s_branch L2G4_D
L2G5_P:
    s_mov_b32 s99, 0x40000
L2G5_C:
    s_andn2_b64 exec, s[44:45], s[40:41]
    buffer_load_dword v17, v16, s[12:15], s34 offen sc1
    s_waitcnt vmcnt(0)
    v_cmp_eq_u32 vcc, s92, v17
    s_mov_b64 exec, -1
    s_or_b64 s[40:41], s[40:41], vcc
    s_andn2_b64 s[42:43], s[38:39], s[40:41]
    s_cbranch_scc0 L2G5_D
    s_sleep 3
    s_sub_u32 s99, s99, 1
    s_cmp_lg_u32 s99, 0
    s_cbranch_scc1 L2G5_C
    s_branch L2G5_D
L2G6_P:
    s_mov_b32 s99, 0x40000
L2G6_C:
    s_andn2_b64 exec, s[44:45], s[40:41]
    buffer_load_dword v17, v16, s[12:15], s34 offen sc1
    s_waitcnt vmcnt(0)
    v_cmp_eq_u32_e64 vcc, s92, v17
    s_mov_b64 exec, -1
    s_or_b64 s[40:41], s[40:41], vcc
    s_andn2_b64 s[42:43], s[38:39], s[40:41]
    s_cbranch_scc0 L2G6_D
    s_sleep 3
    s_sub_u32 s99, s99, 1
    s_cmp_lg_u32 s99, 0
    s_cbranch_scc1 L2G6_C
    s_branch L2G6_D
L2R7_P:
    s_mov_b64 exec, s[52:53]
    buffer_load_dword v18, v16, s[12:15], s34 offen sc1
    s_mov_b64 exec, -1
    s_branch L2R7_D
L2G8_P:
    s_mov_b32 s99, 0x40000
L2G8_C:
    s_andn2_b64 exec, s[44:45], s[40:41]
    buffer_load_dword v17, v16, s[12:15], s34 offen sc1
    s_waitcnt vmcnt(0)
    v_cmp_eq_u32 vcc, s92, v17
    s_mov_b64 exec, -1
    s_or_b64 s[40:41], s[40:41], vcc
    s_andn2_b64 s[42:43], s[38:39], s[40:41]
    s_cbranch_scc0 L2G8_D
    s_sleep 3
    s_sub_u32 s99, s99, 1
    s_cmp_lg_u32 s99, 0
    s_cbranch_scc1 L2G8_C
    s_branch L2G8_D
L2R9_P:
    s_mov_b64 exec, s[52:53]
    v_cmp_eq_u32_e64 vcc, s92, v18
    s_mov_b64 exec, -1
    s_or_b64 s[40:41], s[40:41], vcc
    s_branch L2R9_D
L2G10_P:
    s_mov_b32 s99, 0x40000
L2G10_C:
    s_andn2_b64 exec, s[44:45], s[40:41]
    buffer_load_dword v17, v16, s[12:15], s34 offen sc1
    s_waitcnt vmcnt(0)
    v_cmp_eq_u32 vcc, s92, v17
    s_mov_b64 exec, -1
    s_or_b64 s[40:41], s[40:41], vcc
    s_andn2_b64 s[42:43], s[38:39], s[40:41]
    s_cbranch_scc0 L2G10_D
    s_sleep 3
    s_sub_u32 s99, s99, 1
    s_cmp_lg_u32 s99, 0
    s_cbranch_scc1 L2G10_C
    s_branch L2G10_D
L2_GEND:
    s_cmp_eq_u32 s2, 128
    s_cbranch_scc0 A_LEND
    s_cmp_eq_u32 s20, 4
    s_cbranch_scc0 A_LEND
    v_lshlrev_b32 v16, 10, v1
    s_mov_b32 s28, 18481152
    s_mov_b32 s29, 18546688
    s_mov_b32 s99, 0x40000
EP_5_P:
    buffer_load_dword v17, v16, s[12:15], s28 offen offset:0 sc1
    buffer_load_dword v18, v16, s[12:15], s29 offen offset:0 sc1
    s_waitcnt vmcnt(0)
    v_xor_b32 v17, s92, v17
    v_xor_b32 v18, s92, v18
    v_or_b32 v17, v17, v18
    v_cmp_ne_u32 vcc, 0, v17
    s_sub_u32 s99, s99, 1
    s_cbranch_vccz EP_5_D
    s_sleep 1
    s_cmp_lg_u32 s99, 0
    s_cbranch_scc1 EP_5_P
EP_5_D:
    s_mov_b32 s28, 17825792
    v_mov_b32 v13, s92
    v_lshlrev_b32_e64 v12, 2, v1
    s_mov_b32 exec_hi, 0
    buffer_store_dword v13, v12, s[12:15], s28 offen sc1
    s_mov_b32 exec_hi, -1
A_LEND:
    s_endpgm
AT_EVB_0:
    s_waitcnt vmcnt(0)
    s_barrier
    s_cmp_ge_u32 s23, 9
    s_cbranch_scc1 AT_NG_0
    s_lshl_b32 s32, s22, 7
    s_lshl_b32 s33, s56, 5
    s_add_u32 s32, s32, s33
    s_lshl_b32 s33, s32, 3
    s_add_u32 s33, s33, 18022400
    v_and_b32 v14, 1, v1
    v_lshlrev_b32 v14, 7, v14
    s_cmp_eq_u32 s23, 5
    s_cbranch_scc1 AT_G5_0
    buffer_load_dword v79, v14, s[12:15], s33 offen sc1
    s_branch AT_EBB_0
AT_G5_0:
    v_cmp_ne_u32_e64 vcc, s92, v79
    s_lshl_b32 s32, s32, 2
    s_add_u32 s32, s32, 17039360
    s_cbranch_vccz AT_GL_0
    s_mov_b32 s99, 0x40000
GTP_6_P:
    buffer_load_dword v15, v14, s[12:15], s33 offen offset:0 sc1
    s_waitcnt vmcnt(0)
    v_xor_b32 v15, s92, v15
    v_cmp_ne_u32 vcc, 0, v15
    s_sub_u32 s99, s99, 1
    s_cbranch_vccz GTP_6_D
    s_sleep 4
    s_cmp_lg_u32 s99, 0
    s_cbranch_scc1 GTP_6_P
GTP_6_D:
AT_GL_0:
    v_and_b32 v14, 31, v1
    v_lshlrev_b32_e64 v14, 2, v14
    buffer_load_dword v76, v14, s[12:15], s32 offen sc1
    s_branch AT_EBB_0
AT_NG_0:
    s_cmp_eq_u32 s23, 13
    s_cbranch_scc0 AT_EBB_0
    s_mov_b32 s44, s72
    s_and_b32 s45, s73, 0xffff
    s_mov_b32 s46, 0x200000
    s_mov_b32 s47, 0x20000
    s_lshl_b32 s34, s21, 2
    s_lshr_b32 s35, s20, 1
    s_add_u32 s34, s34, s35
    s_lshl_b32 s34, s34, 16
    s_and_b32 s35, s20, 1
    s_lshl_b32 s35, s35, 13
    s_and_b32 s36, s20, 2
    s_lshl_b32 s36, s36, 11
    s_add_u32 s35, s35, s36
    s_add_u32 m0, s35, 65536
    s_nop 0
    buffer_load_dwordx4 v244, s[44:47], s34 offen offset:0 lds
    buffer_load_dwordx4 v245, s[44:47], s34 offen offset:1024 lds
    buffer_load_dwordx4 v246, s[44:47], s34 offen offset:2048 lds
    buffer_load_dwordx4 v247, s[44:47], s34 offen offset:3072 lds
    s_add_u32 s34, s34, 393216
    s_and_b32 s34, s34, 0x1fffff
    s_add_u32 m0, s35, 131072
    s_nop 0
    s_nop 0
    buffer_load_dwordx4 v244, s[44:47], s34 offen offset:0 lds
    buffer_load_dwordx4 v245, s[44:47], s34 offen offset:1024 lds
    buffer_load_dwordx4 v246, s[44:47], s34 offen offset:2048 lds
    buffer_load_dwordx4 v247, s[44:47], s34 offen offset:3072 lds
    s_branch AT_EBB_0
AT_EVT_0:
    s_cmp_ge_u32 s23, 10
    s_cbranch_scc1 AT_T0_10
    s_cmp_ge_u32 s23, 4
    s_cbranch_scc1 AT_T0_4
    s_cmp_ge_u32 s23, 2
    s_cbranch_scc1 AT_T0_2
    s_mov_b32 s44, s76
    s_and_b32 s45, s77, 0xffff
    s_mov_b32 s46, 0xe00000
    s_mov_b32 s47, 0x20000
    s_mov_b32 s34, 3670016
    buffer_load_dword v254, v240, s[44:47], s34 offen
    s_branch AT_EBT_0
AT_T0_2:
    s_mov_b32 s44, s76
    s_and_b32 s45, s77, 0xffff
    s_mov_b32 s46, 0xe00000
    s_mov_b32 s47, 0x20000
    s_mov_b32 s34, 7340032
    buffer_load_dword v254, v240, s[44:47], s34 offen
    s_branch AT_EBT_0
AT_T0_4:
    s_cmp_ge_u32 s23, 6
    s_cbranch_scc1 AT_T0_6
    s_mov_b32 s44, s76
    s_and_b32 s45, s77, 0xffff
    s_mov_b32 s46, 0xe00000
    s_mov_b32 s47, 0x20000
    s_mov_b32 s34, 11010048
    buffer_load_dword v254, v240, s[44:47], s34 offen
    s_branch AT_EBT_0
AT_T0_6:
    s_cmp_ge_u32 s23, 7
    s_cbranch_scc1 AT_T0_7
    s_mov_b64 exec, 63
    global_load_dword v254, v248, s[4:5]
    s_mov_b64 exec, -1
    s_branch AT_EBT_0
AT_T0_7:
    s_add_u32 s34, s59, 4
    s_and_b32 s34, s34, 15
    s_lshr_b32 s35, s58, 1
    s_add_u32 s34, s34, s35
    s_mul_i32 s34, s34, 7
    s_and_b32 s35, s58, 1
    s_lshl_b32 s35, s35, 2
    s_add_u32 s34, s34, s35
    s_add_u32 s34, s34, 0
    v_mad_u64_u32 v[14:15], s[36:37], s34, v249, v[250:251]
    s_mov_b32 exec_hi, 0
    global_load_dword v254, v[14:15], off
    s_mov_b64 exec, -1
    s_branch AT_EBT_0
AT_T0_10:
    s_cmp_ge_u32 s23, 13
    s_cbranch_scc1 AT_T0_13
    s_cmp_ge_u32 s23, 11
    s_cbranch_scc1 AT_T0_11
    s_add_u32 s34, s59, 12
    s_and_b32 s34, s34, 15
    s_lshr_b32 s35, s58, 1
    s_add_u32 s34, s34, s35
    s_mul_i32 s34, s34, 7
    s_and_b32 s35, s58, 1
    s_lshl_b32 s35, s35, 2
    s_add_u32 s34, s34, s35
    s_add_u32 s34, s34, 0
    v_mad_u64_u32 v[14:15], s[36:37], s34, v249, v[250:251]
    global_load_dword v254, v[14:15], off
    s_branch AT_EBT_0
AT_T0_11:
    s_cmp_ge_u32 s23, 12
    s_cbranch_scc1 AT_T0_12
    s_add_u32 s34, s59, 4
    s_and_b32 s34, s34, 15
    s_lshr_b32 s35, s58, 1
    s_add_u32 s34, s34, s35
    s_mul_i32 s34, s34, 7
    s_and_b32 s35, s58, 1
    s_lshl_b32 s35, s35, 2
    s_add_u32 s34, s34, s35
    s_add_u32 s34, s34, 1
    v_mad_u64_u32 v[14:15], s[36:37], s34, v249, v[250:251]
    global_load_dword v254, v[14:15], off
    s_branch AT_EBT_0
AT_T0_12:
    s_add_u32 s34, s59, 12
    s_and_b32 s34, s34, 15
    s_lshr_b32 s35, s58, 1
    s_add_u32 s34, s34, s35
    s_mul_i32 s34, s34, 7
    s_and_b32 s35, s58, 1
    s_lshl_b32 s35, s35, 2
    s_add_u32 s34, s34, s35
    s_add_u32 s34, s34, 1
    v_mad_u64_u32 v[14:15], s[36:37], s34, v249, v[250:251]
    global_load_dword v254, v[14:15], off
    s_branch AT_EBT_0
AT_T0_13:
    s_cmp_ge_u32 s23, 14
    s_cbranch_scc1 AT_T0_14
    s_add_u32 s34, s59, 4
    s_and_b32 s34, s34, 15
    s_lshr_b32 s35, s58, 1
    s_add_u32 s34, s34, s35
    s_mul_i32 s34, s34, 7
    s_and_b32 s35, s58, 1
    s_lshl_b32 s35, s35, 2
    s_add_u32 s34, s34, s35
    s_add_u32 s34, s34, 2
    v_mad_u64_u32 v[14:15], s[36:37], s34, v249, v[250:251]
    global_load_dword v254, v[14:15], off
    s_branch AT_EBT_0
AT_T0_14:
    s_cmp_ge_u32 s23, 15
    s_cbranch_scc1 AT_T0_15
    s_add_u32 s34, s59, 12
    s_and_b32 s34, s34, 15
    s_lshr_b32 s35, s58, 1
    s_add_u32 s34, s34, s35
    s_mul_i32 s34, s34, 7
    s_and_b32 s35, s58, 1
    s_lshl_b32 s35, s35, 2
    s_add_u32 s34, s34, s35
    s_add_u32 s34, s34, 2
    v_mad_u64_u32 v[14:15], s[36:37], s34, v249, v[250:251]
    global_load_dword v254, v[14:15], off
    s_mov_b64 exec, 63
    global_load_dword v254, v248, s[4:5]
    s_mov_b64 exec, -1
    s_branch AT_EBT_0
AT_T0_15:
    s_add_u32 s34, s59, s58
    s_add_u32 s34, s34, 8
    s_and_b32 s34, s34, 15
    s_mul_i32 s34, s34, 7
    s_add_u32 s34, s34, 3
    v_mad_u64_u32 v[14:15], s[36:37], s34, v249, v[250:251]
    global_load_dword v254, v[14:15], off
    s_branch AT_EBT_0
AT_EVB_1:
    s_waitcnt vmcnt(0)
    s_barrier
    s_cmp_ge_u32 s23, 9
    s_cbranch_scc1 AT_NG_1
    s_lshl_b32 s32, s22, 7
    s_lshl_b32 s33, s56, 5
    s_add_u32 s32, s32, s33
    s_lshl_b32 s33, s32, 3
    s_add_u32 s33, s33, 18022400
    v_and_b32 v14, 1, v1
    v_lshlrev_b32 v14, 7, v14
    s_cmp_eq_u32 s23, 5
    s_cbranch_scc1 AT_G5_1
    buffer_load_dword v79, v14, s[12:15], s33 offen sc1
    s_branch AT_EBB_1
AT_G5_1:
    v_cmp_ne_u32_e64 vcc, s92, v79
    s_lshl_b32 s32, s32, 2
    s_add_u32 s32, s32, 17039360
    s_cbranch_vccz AT_GL_1
    s_mov_b32 s99, 0x40000
GTP_7_P:
    buffer_load_dword v15, v14, s[12:15], s33 offen offset:0 sc1
    s_waitcnt vmcnt(0)
    v_xor_b32 v15, s92, v15
    v_cmp_ne_u32 vcc, 0, v15
    s_sub_u32 s99, s99, 1
    s_cbranch_vccz GTP_7_D
    s_sleep 4
    s_cmp_lg_u32 s99, 0
    s_cbranch_scc1 GTP_7_P
GTP_7_D:
AT_GL_1:
    v_and_b32 v14, 31, v1
    v_lshlrev_b32_e64 v14, 2, v14
    buffer_load_dword v76, v14, s[12:15], s32 offen sc1
    s_branch AT_EBB_1
AT_NG_1:
    s_cmp_eq_u32 s23, 13
    s_cbranch_scc0 AT_EBB_1
    s_setprio 3
    s_mov_b32 s44, s72
    s_and_b32 s45, s73, 0xffff
    s_mov_b32 s46, 0x200000
    s_mov_b32 s47, 0x20000
    s_lshl_b32 s34, s21, 2
    s_lshr_b32 s35, s20, 1
    s_add_u32 s34, s34, s35
    s_lshl_b32 s34, s34, 16
    s_and_b32 s35, s20, 1
    s_lshl_b32 s35, s35, 13
    s_and_b32 s36, s20, 2
    s_lshl_b32 s36, s36, 11
    s_add_u32 s35, s35, s36
    s_add_u32 m0, s35, 98304
    s_nop 0
    s_nop 0
    buffer_load_dwordx4 v244, s[44:47], s34 offen offset:0 lds
    buffer_load_dwordx4 v245, s[44:47], s34 offen offset:1024 lds
    buffer_load_dwordx4 v246, s[44:47], s34 offen offset:2048 lds
    buffer_load_dwordx4 v247, s[44:47], s34 offen offset:3072 lds
    s_add_u32 s34, s34, 524288
    s_and_b32 s34, s34, 0x1fffff
    s_add_u32 m0, s35, 0
    s_nop 0
    buffer_load_dwordx4 v244, s[44:47], s34 offen offset:0 lds
    buffer_load_dwordx4 v245, s[44:47], s34 offen offset:1024 lds
    buffer_load_dwordx4 v246, s[44:47], s34 offen offset:2048 lds
    buffer_load_dwordx4 v247, s[44:47], s34 offen offset:3072 lds
    s_branch AT_EBB_1
AT_EVT_1:
    s_cmp_ge_u32 s23, 9
    s_cbranch_scc1 AT_T1_9
    s_cmp_ge_u32 s23, 5
    s_cbranch_scc1 AT_T1_5
    s_cmp_ge_u32 s23, 2
    s_cbranch_scc1 AT_T1_2
    s_mov_b32 s44, s76
    s_and_b32 s45, s77, 0xffff
    s_mov_b32 s46, 0xe00000
    s_mov_b32 s47, 0x20000
    s_mov_b32 s34, 5505024
    buffer_load_dword v254, v240, s[44:47], s34 offen
    s_branch AT_EBT_1
AT_T1_2:
    s_cmp_ge_u32 s23, 4
    s_cbranch_scc1 AT_T1_4
    s_mov_b32 s44, s76
    s_and_b32 s45, s77, 0xffff
    s_mov_b32 s46, 0xe00000
    s_mov_b32 s47, 0x20000
    s_mov_b32 s34, 9175040
    buffer_load_dword v254, v240, s[44:47], s34 offen
    s_branch AT_EBT_1
AT_T1_4:
    s_mov_b32 s44, s76
    s_and_b32 s45, s77, 0xffff
    s_mov_b32 s46, 0xe00000
    s_mov_b32 s47, 0x20000
    s_mov_b32 s34, 12845056
    buffer_load_dword v254, v240, s[44:47], s34 offen
    s_branch AT_EBT_1
AT_T1_5:
    s_cmp_ge_u32 s23, 6
    s_cbranch_scc1 AT_T1_6
    s_mov_b32 s44, s72
    s_and_b32 s45, s73, 0xffff
    s_mov_b32 s46, 0x200000
    s_mov_b32 s47, 0x20000
    s_sub_u32 s34, s2, 128
    s_lshl_b32 s34, s34, 2
    s_add_u32 s34, s34, s56
    s_lshl_b32 s34, s34, 12
    v_lshlrev_b32_e64 v14, 7, v1
    s_mov_b32 exec_hi, 0
    buffer_load_dword v254, v14, s[44:47], s34 offen
    s_mov_b32 exec_hi, -1
    s_branch AT_EBT_1
AT_T1_6:
    s_cmp_ge_u32 s23, 7
    s_cbranch_scc1 AT_T1_7
    s_add_u32 s34, s59, 0
    s_and_b32 s34, s34, 15
    s_lshr_b32 s35, s58, 1
    s_add_u32 s34, s34, s35
    s_mul_i32 s34, s34, 7
    s_and_b32 s35, s58, 1
    s_lshl_b32 s35, s35, 2
    s_add_u32 s34, s34, s35
    s_add_u32 s34, s34, 0
    v_mad_u64_u32 v[14:15], s[36:37], s34, v249, v[250:251]
    s_mov_b32 exec_hi, 0
    global_load_dword v254, v[14:15], off
    s_mov_b64 exec, -1
    s_branch AT_EBT_1
AT_T1_7:
    s_add_u32 s34, s59, 8
    s_and_b32 s34, s34, 15
    s_lshr_b32 s35, s58, 1
    s_add_u32 s34, s34, s35
    s_mul_i32 s34, s34, 7
    s_and_b32 s35, s58, 1
    s_lshl_b32 s35, s35, 2
    s_add_u32 s34, s34, s35
    s_add_u32 s34, s34, 0
    v_mad_u64_u32 v[14:15], s[36:37], s34, v249, v[250:251]
    s_mov_b32 exec_hi, 0
    global_load_dword v254, v[14:15], off
    s_mov_b64 exec, -1
    s_branch AT_EBT_1
AT_T1_9:
    s_cmp_ge_u32 s23, 12
    s_cbranch_scc1 AT_T1_12
    s_cmp_ge_u32 s23, 10
    s_cbranch_scc1 AT_T1_10
    s_add_u32 s34, s59, 8
    s_and_b32 s34, s34, 15
    s_lshr_b32 s35, s58, 1
    s_add_u32 s34, s34, s35
    s_mul_i32 s34, s34, 7
    s_and_b32 s35, s58, 1
    s_lshl_b32 s35, s35, 2
    s_add_u32 s34, s34, s35
    s_add_u32 s34, s34, 0
    v_mad_u64_u32 v[14:15], s[36:37], s34, v249, v[250:251]
    s_mov_b32 exec_lo, 0
    global_load_dword v254, v[14:15], off
    s_mov_b64 exec, -1
    s_branch AT_EBT_1
AT_T1_10:
    s_cmp_ge_u32 s23, 11
    s_cbranch_scc1 AT_T1_11
    s_add_u32 s34, s59, 0
    s_and_b32 s34, s34, 15
    s_lshr_b32 s35, s58, 1
    s_add_u32 s34, s34, s35
    s_mul_i32 s34, s34, 7
    s_and_b32 s35, s58, 1
    s_lshl_b32 s35, s35, 2
    s_add_u32 s34, s34, s35
    s_add_u32 s34, s34, 1
    v_mad_u64_u32 v[14:15], s[36:37], s34, v249, v[250:251]
    global_load_dword v254, v[14:15], off
    s_branch AT_EBT_1
AT_T1_11:
    s_add_u32 s34, s59, 8
    s_and_b32 s34, s34, 15
    s_lshr_b32 s35, s58, 1
    s_add_u32 s34, s34, s35
    s_mul_i32 s34, s34, 7
    s_and_b32 s35, s58, 1
    s_lshl_b32 s35, s35, 2
    s_add_u32 s34, s34, s35
    s_add_u32 s34, s34, 1
    v_mad_u64_u32 v[14:15], s[36:37], s34, v249, v[250:251]
    global_load_dword v254, v[14:15], off
    s_branch AT_EBT_1
AT_T1_12:
    s_cmp_ge_u32 s23, 13
    s_cbranch_scc1 AT_T1_13
    s_add_u32 s34, s59, 0
    s_and_b32 s34, s34, 15
    s_lshr_b32 s35, s58, 1
    s_add_u32 s34, s34, s35
    s_mul_i32 s34, s34, 7
    s_and_b32 s35, s58, 1
    s_lshl_b32 s35, s35, 2
    s_add_u32 s34, s34, s35
    s_add_u32 s34, s34, 2
    v_mad_u64_u32 v[14:15], s[36:37], s34, v249, v[250:251]
    global_load_dword v254, v[14:15], off
    s_branch AT_EBT_1
AT_T1_13:
    s_cmp_ge_u32 s23, 14
    s_cbranch_scc1 AT_T1_14
    s_add_u32 s34, s59, 8
    s_and_b32 s34, s34, 15
    s_lshr_b32 s35, s58, 1
    s_add_u32 s34, s34, s35
    s_mul_i32 s34, s34, 7
    s_and_b32 s35, s58, 1
    s_lshl_b32 s35, s35, 2
    s_add_u32 s34, s34, s35
    s_add_u32 s34, s34, 2
    v_mad_u64_u32 v[14:15], s[36:37], s34, v249, v[250:251]
    global_load_dword v254, v[14:15], off
    s_branch AT_EBT_1
AT_T1_14:
    s_add_u32 s34, s59, s58
    s_add_u32 s34, s34, 0
    s_and_b32 s34, s34, 15
    s_mul_i32 s34, s34, 7
    s_add_u32 s34, s34, 3
    v_mad_u64_u32 v[14:15], s[36:37], s34, v249, v[250:251]
    global_load_dword v254, v[14:15], off
    s_branch AT_EBT_1
AT_EXACT:
    s_mov_b32 s34, 16777216
    v_mov_b32 v12, 0xff800000
    v_mov_b32 v13, 0xff800000
    s_mov_b32 s23, 64
AT_MX:
    buffer_load_dwordx4 v[48:51], v4, s[12:15], s34 offen sc1
    buffer_load_dwordx4 v[52:55], v4, s[12:15], s34 offen offset:1024 sc1
    s_add_u32 s34, s34, 4096
    s_waitcnt vmcnt(0)
    v_mfma_f32_32x32x16_bf16 v[80:95], v[48:51], v[16:19], 0
    v_mfma_f32_32x32x16_bf16 v[96:111], v[48:51], v[24:27], 0
    v_mfma_f32_32x32x16_bf16 v[80:95], v[52:55], v[20:23], v[80:95]
    v_mfma_f32_32x32x16_bf16 v[96:111], v[52:55], v[28:31], v[96:111]
    s_nop 0
    s_nop 15
    v_max3_f32 v12, v12, v80, v81
    v_max3_f32 v12, v12, v82, v83
    v_max3_f32 v12, v12, v84, v85
    v_max3_f32 v12, v12, v86, v87
    v_max3_f32 v12, v12, v88, v89
    v_max3_f32 v12, v12, v90, v91
    v_max3_f32 v12, v12, v92, v93
    v_max3_f32 v12, v12, v94, v95
    v_max3_f32 v13, v13, v96, v97
    v_max3_f32 v13, v13, v98, v99
    v_max3_f32 v13, v13, v100, v101
    v_max3_f32 v13, v13, v102, v103
    v_max3_f32 v13, v13, v104, v105
    v_max3_f32 v13, v13, v106, v107
    v_max3_f32 v13, v13, v108, v109
    v_max3_f32 v13, v13, v110, v111
    s_sub_u32 s23, s23, 1
    s_cmp_lg_u32 s23, 0
    s_cbranch_scc1 AT_MX
    v_mov_b32 v14, v12
    v_mov_b32 v15, v13
    s_nop 1
    v_permlane32_swap_b32 v12, v14
    v_permlane32_swap_b32 v13, v15
    v_max_f32 v12, v12, v14
    v_max_f32 v13, v13, v15
    s_branch AT_FAST
MK_END:
    s_endpgm
.section .rodata,"a"
.p2align 6
.amdhsa_kernel gated_mix__grouped_kv_mqa__mixer_token_mlp__prompt_kernel
  .amdhsa_next_free_vgpr 256
  .amdhsa_next_free_sgpr 102
  .amdhsa_accum_offset 256
  .amdhsa_group_segment_fixed_size 0
  .amdhsa_kernarg_size 112
  .amdhsa_user_sgpr_count 2
  .amdhsa_user_sgpr_kernarg_segment_ptr 1
  .amdhsa_system_sgpr_workgroup_id_x 1
.end_amdhsa_kernel
```
